```python
import torch

def _softmax(x, axis=-1):
    return torch.softmax(x, dim=axis)

def _gelu(x):
    return torch.nn.functional.gelu(x, approximate='tanh')

def _silu(x):
    return torch.nn.functional.silu(x)

def _sigmoid(x):
    return torch.sigmoid(x)

def _layernorm(x, axis=-1, eps=1e-05):
    m = x.mean(dim=axis, keepdim=True)
    v = x.var(dim=axis, keepdim=True, unbiased=False)
    return (x - m) / torch.sqrt(v + eps)

def _scatter_add(tgt, idx, src, axis=0):
    return tgt.clone().index_add_(axis, idx, src)

def _segment_sum(src, seg, n):
    out = torch.zeros((n,) + src.shape[1:], dtype=src.dtype)
    return out.index_add_(0, seg, src)

def _pad(x, pw):
    flat = tuple((v for pair in reversed(pw) for v in pair))
    return torch.nn.functional.pad(x, flat)
kernel_name = 'standalone__window_attn_davit__vision'

def setup_inputs():

    _w = lambda a: (lambda t: t.to(torch.bfloat16) if t.is_floating_point() else t)(torch.as_tensor(a))
    HW = 512
    C0 = 96
    ws = 7
    nh = 4
    H = W = max(HW // ws * ws, ws)
    C = max(C0 // nh * nh, nh)
    k = 3
    return {'x': _w((lambda *s: torch.randn(*s, dtype=torch.bfloat16) * 1.6)(1, H, W, C)), 'dw_pe': _w((lambda *s: torch.randn(*s, dtype=torch.bfloat16) * 1.6)(k, k, C) * 0.1), 'w_qkv': _w((lambda *s: torch.randn(*s, dtype=torch.bfloat16) * 1.6)(C, 3 * C) * C ** (-0.5)), 'w_o': _w((lambda *s: torch.randn(*s, dtype=torch.bfloat16) * 0.4)(C, C) * C ** (-0.5))}

def reference(x, dw_pe, w_qkv, w_o):
    B, H, W, C = x.shape
    ws = 7
    nh = 4
    dh = C // nh
    kk = dw_pe.shape[0]
    pad = kk // 2
    xp = _pad(x, ((0, 0), (pad, pad), (pad, pad), (0, 0)))
    pe = torch.zeros_like(x)
    for i in range(kk):
        for j in range(kk):
            pe = pe + xp[:, i:i + H, j:j + W, :] * dw_pe[i, j][None, None, None, :]
    x0 = x + pe
    h = _layernorm(x0, axis=-1)
    hw = h.reshape(B, H // ws, ws, W // ws, ws, C)
    hw = (lambda x, *d: x.permute(*d))(hw, 0, 1, 3, 2, 4, 5)
    hw = hw.reshape(-1, ws * ws, C)
    qkv = (hw @ w_qkv).reshape(-1, ws * ws, 3, nh, dh)
    q = qkv[:, :, 0].clone()
    k = qkv[:, :, 1].clone()
    v = qkv[:, :, 2].clone()
    scale = dh ** (-0.5)
    attn = torch.einsum('wnhd,wmhd->whnm', q, k) * scale
    attn = _softmax(attn, axis=-1)
    out = torch.einsum('whnm,wmhd->wnhd', attn, v)
    out = out.reshape(-1, ws * ws, C) @ w_o
    out = out.reshape(B, H // ws, W // ws, ws, ws, C)
    out = (lambda x, *d: x.permute(*d))(out, 0, 1, 3, 2, 4, 5)
    out = out.reshape(B, H, W, C)
    return x0 + out
```

```asm
; @launch grid=(256,1,1) block=(512,1,1) lds=159936
.amdgcn_target "amdgcn-amd-amdhsa--gfx950"
.text
.globl standalone__window_attn_davit__vision_kernel
.p2align 8
.type standalone__window_attn_davit__vision_kernel,@function
standalone__window_attn_davit__vision_kernel:
    s_load_dwordx8 s[16:23], s[0:1], 0
    s_load_dwordx4 s[24:27], s[0:1], 32
    s_and_b32 s40, s2, 7
    s_lshl_b32 s40, s40, 5
    s_lshr_b32 s41, s2, 3
    s_add_u32 s31, s40, s41
    s_cmp_ge_u32 s2, 0x100
    s_cselect_b32 s31, 0x3e7, s31
    s_cmp_ge_u32 s31, 0x100
    s_cbranch_scc1 L_end
    v_lshrrev_b32 v253, 6, v0
    v_and_b32 v255, 63, v0
    v_readfirstlane_b32 s30, v253
    s_mov_b32 s36, 0
    s_mov_b32 s95, 0
    s_mov_b32 s15, 0x20000
    s_cmp_ge_u32 s30, 4
    s_cbranch_scc1 L_T
    v_lshlrev_b32 v200, 4, v255
    s_mul_i32 s41, s30, 48
    s_add_u32 s41, s41, 0x168c0
    v_lshrrev_b32 v201, 4, v255
    v_and_b32 v202, 15, v255
    v_lshrrev_b32 v203, 2, v202
    v_and_b32 v204, 3, v255
    v_lshrrev_b32 v209, 1, v201
    v_lshlrev_b32 v209, 4, v209
    v_and_b32 v210, 1, v201
    v_lshlrev_b32 v210, 2, v210
    v_add3_u32 v209, v209, v210, v203
    v_mul_u32_u24 v209, 0x240, v209
    v_add_u32 v209, s41, v209
    v_lshl_add_u32 v205, v204, 3, v209
    v_lshrrev_b32 v210, 1, v204
    v_lshl_add_u32 v208, v210, 3, v209
    v_add_u32 v208, 32, v208
    v_and_b32 v210, 1, v204
    v_mul_u32_u24 v210, 0xc0, v210
    v_add_u32 v206, v208, v210
    v_sub_u32 v207, v208, v210
    v_add_u32 v207, 0xc0, v207
    v_add_u32 v148, 0xe4c0, v200
    s_lshr_b32 s40, s30, 1
    s_mul_i32 s40, s40, 0x400
    s_and_b32 s42, s30, 1
    s_lshl_b32 s42, s42, 3
    s_add_u32 s40, s40, s42
    s_add_u32 s40, s40, 0x1e0c0
    v_add_u32 v178, s40, v200
    s_lshl_b32 s40, s30, 2
    s_add_u32 s40, s40, 0x1e8c0
    v_add_u32 v196, s40, v200
    s_mov_b32 s60, 0x10001
    s_mov_b32 s61, s60
    s_mov_b32 s62, 0x100010
    s_mov_b32 s63, s62
    s_mov_b32 s64, 0x1000100
    s_mov_b32 s65, s64
    s_mov_b32 s66, 0xcccccccc
    s_mov_b32 s67, s66
    s_mov_b32 s68, 0xffff
    s_mov_b32 s69, 0
    s_mov_b32 s70, 0xffff0000
    s_mov_b32 s71, 0
    s_mov_b32 s72, 0
    s_mov_b32 s73, 0xffff
    s_mov_b32 s74, 0xf0000f
    s_mov_b32 s75, 0xf0000f00
    s_mov_b32 s76, 0xf0f0f0f
    s_mov_b32 s77, s76
    s_mov_b32 s78, 0xc3c3c3c3
    s_mov_b32 s79, s78
    s_mov_b32 s51, 0x53800000
    v_mov_b32 v209, 0x3f800000
    v_cndmask_b32 v166, 0, v209, s[66:67]
    v_cndmask_b32 v167, 0, v209, s[66:67]
    v_cndmask_b32 v168, 0, v209, s[66:67]
    v_cndmask_b32 v169, 0, v209, s[66:67]
    v_mov_b32 v209, 0xff800000
    v_cndmask_b32 v170, v209, 0, s[68:69]
    v_cndmask_b32 v172, v209, 0, s[70:71]
    v_cndmask_b32 v174, v209, 0, s[72:73]
    v_cndmask_b32 v176, v209, 0, s[74:75]
    v_mov_b32 v111, 0
    v_mov_b32 v115, 0
    v_mov_b32 v119, 0
    v_mov_b32 v123, 0
    v_mov_b32 v127, 0
    v_mov_b32 v136, 0
    v_mov_b32 v137, 0
    v_mov_b32 v138, 0
    v_mov_b32 v139, 0
    v_mov_b32 v64, 0
    v_mov_b32 v72, 0
    v_mov_b32 v131, 0
    v_mov_b32 v140, 0
    v_mov_b32 v141, 0
    v_mov_b32 v142, 0
    v_mov_b32 v143, 0
    v_mov_b32 v80, 0
    v_mov_b32 v88, 0
    v_mov_b32 v135, 0
    v_mov_b32 v144, 0
    v_mov_b32 v145, 0
    v_mov_b32 v146, 0
    v_mov_b32 v147, 0
    v_mov_b32 v96, 0
    v_mov_b32 v104, 0
    v_mov_b32 v171, 0
    v_mov_b32 v210, 0xe480
    ds_write_b32 v210, v171
    ds_write_b32 v210, v171 offset:4
    ds_write_b32 v210, v171 offset:8
    ds_write_b32 v210, v171 offset:16
    ds_write_b32 v210, v171 offset:20
    s_mov_b64 s[88:89], 1
    v_mov_b32 v209, 0xf00000
    v_mov_b32 v127, 0xe480
    v_cndmask_b32 v127, v209, v127, s[88:89]
    s_lshl_b32 s40, s30, 3
    s_lshl_b32 s40, 1, s40
    v_mov_b32 v131, s40
    s_waitcnt lgkmcnt(0)
    s_barrier
    s_mov_b32 s12, s20
    s_mov_b32 s13, s21
    s_mov_b32 s14, 0xd800
    s_and_b32 s40, s31, 31
    s_mul_i32 s40, s40, 13
    s_add_u32 s40, s40, s30
    s_mul_i32 s45, s40, 0x4be
    s_lshr_b32 s45, s45, 16
    s_mul_i32 s45, s45, 54
    s_sub_u32 s40, s40, s45
    s_lshl_b32 s44, s40, 10
    s_add_u32 m0, s44, 0x168c0
    s_nop 0
    buffer_load_dwordx4 v200, s[12:15], s44 offen lds
    s_add_u32 s44, s44, 0x1000
    s_cmp_ge_u32 s44, 0xd800
    s_cselect_b32 s45, 0xd800, 0
    s_sub_u32 s44, s44, s45
    s_add_u32 m0, s44, 0x168c0
    s_nop 0
    buffer_load_dwordx4 v200, s[12:15], s44 offen lds
    s_add_u32 s44, s44, 0x1000
    s_cmp_ge_u32 s44, 0xd800
    s_cselect_b32 s45, 0xd800, 0
    s_sub_u32 s44, s44, s45
    s_add_u32 m0, s44, 0x168c0
    s_nop 0
    buffer_load_dwordx4 v200, s[12:15], s44 offen lds
    s_add_u32 s44, s44, 0x1000
    s_cmp_ge_u32 s44, 0xd800
    s_cselect_b32 s45, 0xd800, 0
    s_sub_u32 s44, s44, s45
    s_add_u32 m0, s44, 0x168c0
    s_nop 0
    buffer_load_dwordx4 v200, s[12:15], s44 offen lds
    s_add_u32 s44, s44, 0x1000
    s_cmp_ge_u32 s44, 0xd800
    s_cselect_b32 s45, 0xd800, 0
    s_sub_u32 s44, s44, s45
    s_add_u32 m0, s44, 0x168c0
    s_nop 0
    buffer_load_dwordx4 v200, s[12:15], s44 offen lds
    s_add_u32 s44, s44, 0x1000
    s_cmp_ge_u32 s44, 0xd800
    s_cselect_b32 s45, 0xd800, 0
    s_sub_u32 s44, s44, s45
    s_add_u32 m0, s44, 0x168c0
    s_nop 0
    buffer_load_dwordx4 v200, s[12:15], s44 offen lds
    s_add_u32 s44, s44, 0x1000
    s_cmp_ge_u32 s44, 0xd800
    s_cselect_b32 s45, 0xd800, 0
    s_sub_u32 s44, s44, s45
    s_add_u32 m0, s44, 0x168c0
    s_nop 0
    buffer_load_dwordx4 v200, s[12:15], s44 offen lds
    s_add_u32 s44, s44, 0x1000
    s_cmp_ge_u32 s44, 0xd800
    s_cselect_b32 s45, 0xd800, 0
    s_sub_u32 s44, s44, s45
    s_add_u32 m0, s44, 0x168c0
    s_nop 0
    buffer_load_dwordx4 v200, s[12:15], s44 offen lds
    s_add_u32 s44, s44, 0x1000
    s_cmp_ge_u32 s44, 0xd800
    s_cselect_b32 s45, 0xd800, 0
    s_sub_u32 s44, s44, s45
    s_add_u32 m0, s44, 0x168c0
    s_nop 0
    buffer_load_dwordx4 v200, s[12:15], s44 offen lds
    s_add_u32 s44, s44, 0x1000
    s_cmp_ge_u32 s44, 0xd800
    s_cselect_b32 s45, 0xd800, 0
    s_sub_u32 s44, s44, s45
    s_add_u32 m0, s44, 0x168c0
    s_nop 0
    buffer_load_dwordx4 v200, s[12:15], s44 offen lds
    s_add_u32 s44, s44, 0x1000
    s_cmp_ge_u32 s44, 0xd800
    s_cselect_b32 s45, 0xd800, 0
    s_sub_u32 s44, s44, s45
    s_add_u32 m0, s44, 0x168c0
    s_nop 0
    buffer_load_dwordx4 v200, s[12:15], s44 offen lds
    s_add_u32 s44, s44, 0x1000
    s_cmp_ge_u32 s44, 0xd800
    s_cselect_b32 s45, 0xd800, 0
    s_sub_u32 s44, s44, s45
    s_add_u32 m0, s44, 0x168c0
    s_nop 0
    buffer_load_dwordx4 v200, s[12:15], s44 offen lds
    s_add_u32 s44, s44, 0x1000
    s_cmp_ge_u32 s44, 0xd800
    s_cselect_b32 s45, 0xd800, 0
    s_sub_u32 s44, s44, s45
    s_add_u32 m0, s44, 0x168c0
    s_nop 0
    buffer_load_dwordx4 v200, s[12:15], s44 offen lds
    s_add_u32 s44, s44, 0x1000
    s_cmp_ge_u32 s44, 0xd800
    s_cselect_b32 s45, 0xd800, 0
    s_sub_u32 s44, s44, s45
    s_add_u32 m0, s44, 0x168c0
    s_nop 0
    buffer_load_dwordx4 v200, s[12:15], s44 offen lds
    s_mov_b64 vcc, s[78:79]
    s_waitcnt vmcnt(0)
    v_mov_b32 v209, 0xe488
    v_mov_b32 v210, 1
    s_mov_b64 exec, 1
    ds_add_u32 v209, v210
    s_mov_b64 exec, -1
    s_waitcnt lgkmcnt(0)
L_spinA:
    ds_read_b32 v210, v209
    s_waitcnt lgkmcnt(0)
    v_readfirstlane_b32 s40, v210
    s_nop 1
    s_cmp_lt_u32 s40, 4
    s_nop 0
    s_cbranch_scc1 L_spinA
    s_setprio 0
    ds_read_b64_tr_b16 v[12:13], v206
    ds_read_b64_tr_b16 v[212:213], v207
    ds_read_b64_tr_b16 v[48:49], v208 offset:384
    ds_read_b64_tr_b16 v[14:15], v206 offset:4608
    ds_read_b64_tr_b16 v[214:215], v207 offset:4608
    ds_read_b64_tr_b16 v[50:51], v208 offset:4992
    ds_read_b64_tr_b16 v[16:17], v206 offset:18432
    ds_read_b64_tr_b16 v[216:217], v207 offset:18432
    ds_read_b64_tr_b16 v[52:53], v208 offset:18816
    ds_read_b64_tr_b16 v[18:19], v206 offset:23040
    ds_read_b64_tr_b16 v[218:219], v207 offset:23040
    ds_read_b64_tr_b16 v[54:55], v208 offset:23424
    ds_read_b64_tr_b16 v[20:21], v206 offset:36864
    ds_read_b64_tr_b16 v[220:221], v207 offset:36864
    ds_read_b64_tr_b16 v[56:57], v208 offset:37248
    s_waitcnt lgkmcnt(13)
    ds_read_b64_tr_b16 v[22:23], v206 offset:41472
    ds_read_b64_tr_b16 v[222:223], v207 offset:41472
    s_waitcnt lgkmcnt(13)
    ds_read_b64_tr_b16 v[58:59], v208 offset:41856
    ds_read_b64_tr_b16 v[0:1], v205
    s_waitcnt lgkmcnt(13)
    ds_read_b64_tr_b16 v[24:25], v205 offset:192
    ds_read_b64_tr_b16 v[36:37], v205 offset:384
    s_waitcnt lgkmcnt(13)
    ds_read_b64_tr_b16 v[2:3], v205 offset:4608
    ds_read_b64_tr_b16 v[26:27], v205 offset:4800
    s_waitcnt lgkmcnt(13)
    ds_read_b64_tr_b16 v[38:39], v205 offset:4992
    v_cndmask_b32_dpp v12, v212, v12, vcc quad_perm:[2,3,0,1] row_mask:0xf bank_mask:0xf
    v_cndmask_b32_dpp v13, v213, v13, vcc quad_perm:[2,3,0,1] row_mask:0xf bank_mask:0xf
    v_cndmask_b32_dpp v14, v214, v14, vcc quad_perm:[2,3,0,1] row_mask:0xf bank_mask:0xf
    v_cndmask_b32_dpp v15, v215, v15, vcc quad_perm:[2,3,0,1] row_mask:0xf bank_mask:0xf
    v_cndmask_b32_dpp v16, v216, v16, vcc quad_perm:[2,3,0,1] row_mask:0xf bank_mask:0xf
    v_cndmask_b32_dpp v17, v217, v17, vcc quad_perm:[2,3,0,1] row_mask:0xf bank_mask:0xf
    s_waitcnt lgkmcnt(9)
    v_cndmask_b32_dpp v18, v218, v18, vcc quad_perm:[2,3,0,1] row_mask:0xf bank_mask:0xf
    v_cndmask_b32_dpp v19, v219, v19, vcc quad_perm:[2,3,0,1] row_mask:0xf bank_mask:0xf
    ds_read_b64_tr_b16 v[4:5], v205 offset:18432
    ds_read_b64_tr_b16 v[28:29], v205 offset:18624
    ds_read_b64_tr_b16 v[40:41], v205 offset:18816
    ds_read_b64_tr_b16 v[6:7], v205 offset:23040
    ds_read_b64_tr_b16 v[30:31], v205 offset:23232
    ds_read_b64_tr_b16 v[42:43], v205 offset:23424
    s_waitcnt lgkmcnt(13)
    ds_read_b64_tr_b16 v[8:9], v205 offset:36864
    ds_read_b64_tr_b16 v[32:33], v205 offset:37056
    s_waitcnt lgkmcnt(13)
    ds_read_b64_tr_b16 v[44:45], v205 offset:37248
    ds_read_b64_tr_b16 v[10:11], v205 offset:41472
    s_waitcnt lgkmcnt(13)
    ds_read_b64_tr_b16 v[34:35], v205 offset:41664
    ds_read_b64_tr_b16 v[46:47], v205 offset:41856
    v_cndmask_b32_dpp v20, v220, v20, vcc quad_perm:[2,3,0,1] row_mask:0xf bank_mask:0xf
    v_cndmask_b32_dpp v21, v221, v21, vcc quad_perm:[2,3,0,1] row_mask:0xf bank_mask:0xf
    v_cndmask_b32_dpp v22, v222, v22, vcc quad_perm:[2,3,0,1] row_mask:0xf bank_mask:0xf
    v_cndmask_b32_dpp v23, v223, v23, vcc quad_perm:[2,3,0,1] row_mask:0xf bank_mask:0xf
    s_mov_b64 vcc, s[76:77]
    v_cndmask_b32_dpp v224, v48, v48, vcc quad_perm:[2,3,0,1] row_mask:0xf bank_mask:0xf
    v_cndmask_b32_dpp v225, v49, v49, vcc quad_perm:[2,3,0,1] row_mask:0xf bank_mask:0xf
    v_cndmask_b32_dpp v226, v50, v50, vcc quad_perm:[2,3,0,1] row_mask:0xf bank_mask:0xf
    v_cndmask_b32_dpp v227, v51, v51, vcc quad_perm:[2,3,0,1] row_mask:0xf bank_mask:0xf
    v_cndmask_b32_dpp v228, v52, v52, vcc quad_perm:[2,3,0,1] row_mask:0xf bank_mask:0xf
    v_cndmask_b32_dpp v229, v53, v53, vcc quad_perm:[2,3,0,1] row_mask:0xf bank_mask:0xf
    v_cndmask_b32_dpp v230, v54, v54, vcc quad_perm:[2,3,0,1] row_mask:0xf bank_mask:0xf
    v_cndmask_b32_dpp v231, v55, v55, vcc quad_perm:[2,3,0,1] row_mask:0xf bank_mask:0xf
    v_cndmask_b32_dpp v232, v56, v56, vcc quad_perm:[2,3,0,1] row_mask:0xf bank_mask:0xf
    v_cndmask_b32_dpp v233, v57, v57, vcc quad_perm:[2,3,0,1] row_mask:0xf bank_mask:0xf
    v_cndmask_b32_dpp v234, v58, v58, vcc quad_perm:[2,3,0,1] row_mask:0xf bank_mask:0xf
    v_cndmask_b32_dpp v235, v59, v59, vcc quad_perm:[2,3,0,1] row_mask:0xf bank_mask:0xf
    v_cndmask_b32 v48, v224, 0, s[66:67]
    v_cndmask_b32 v49, v225, 0, s[66:67]
    v_cndmask_b32 v50, v226, 0, s[66:67]
    v_cndmask_b32 v51, v227, 0, s[66:67]
    v_cndmask_b32 v52, v228, 0, s[66:67]
    v_cndmask_b32 v53, v229, 0, s[66:67]
    v_cndmask_b32 v54, v230, 0, s[66:67]
    v_cndmask_b32 v55, v231, 0, s[66:67]
    v_cndmask_b32 v56, v232, 0, s[66:67]
    v_cndmask_b32 v57, v233, 0, s[66:67]
    v_cndmask_b32 v58, v234, 0, s[66:67]
    v_cndmask_b32 v59, v235, 0, s[66:67]
    s_setprio 0
    s_waitcnt lgkmcnt(0)
    s_barrier
    s_setprio 2
    ds_read_b128 v[214:217], v148
    ds_read_b128 v[218:221], v148 offset:1024
    ds_read_b128 v[222:225], v148 offset:2048
    ds_read_b128 v[226:229], v148 offset:6144
    ds_read_b128 v[230:233], v148 offset:7168
    ds_read_b128 v[234:237], v148 offset:8192
    s_mov_b32 s92, 0
    s_mov_b32 s37, 0
    s_waitcnt lgkmcnt(5)
    v_mfma_f32_16x16x32_bf16 v[238:241], v[0:3], v[214:217], 0
    s_setprio 0
    s_waitcnt lgkmcnt(4)
    v_mfma_f32_16x16x32_bf16 v[238:241], v[4:7], v[218:221], v[238:241]
    s_waitcnt lgkmcnt(3)
    v_mfma_f32_16x16x32_bf16 v[238:241], v[8:11], v[222:225], v[238:241]
    v_mfma_f32_16x16x32_bf16 v[242:245], v[12:15], v[214:217], 0
    v_mfma_f32_16x16x32_bf16 v[242:245], v[16:19], v[218:221], v[242:245]
    v_cvt_pk_bf16_f32 v238, v238, v239
    v_cndmask_b32 v136, 0, v238, s[60:61]
    v_mfma_f32_16x16x32_bf16 v[242:245], v[20:23], v[222:225], v[242:245]
    v_cndmask_b32 v140, 0, v238, s[62:63]
    v_cndmask_b32 v144, 0, v238, s[64:65]
    v_mfma_f32_16x16x32_bf16 v[246:249], v[24:27], v[214:217], 0
    v_cvt_pk_bf16_f32 v240, v240, v241
    v_cndmask_b32 v137, 0, v240, s[60:61]
    v_mfma_f32_16x16x32_bf16 v[246:249], v[28:31], v[218:221], v[246:249]
    v_cndmask_b32 v141, 0, v240, s[62:63]
    v_cndmask_b32 v145, 0, v240, s[64:65]
    v_mfma_f32_16x16x32_bf16 v[246:249], v[32:35], v[222:225], v[246:249]
    v_cvt_pk_bf16_f32 v122, v244, v245
    v_cvt_pk_bf16_f32 v242, v242, v243
    v_mfma_f32_16x16x32_bf16 v[250:253], v[214:217], v[36:39], 0
    v_cndmask_b32 v138, 0, v242, s[60:61]
    v_cndmask_b32 v142, 0, v242, s[62:63]
    v_mfma_f32_16x16x32_bf16 v[250:253], v[218:221], v[40:43], v[250:253]
    v_cndmask_b32 v146, 0, v242, s[64:65]
    v_cvt_pk_bf16_f32 v120, v246, v247
    v_mfma_f32_16x16x32_bf16 v[250:253], v[222:225], v[44:47], v[250:253]
    s_setprio 2
    v_cvt_pk_bf16_f32 v121, v248, v249
    v_mfma_f32_16x16x32_bf16 v[238:241], v[214:217], v[48:51], v[166:169]
    ds_read_b128 v[214:217], v148 offset:9216
    v_mfma_f32_16x16x32_bf16 v[238:241], v[218:221], v[52:55], v[238:241]
    v_cvt_pk_bf16_f32 v65, v250, v251
    v_cvt_pk_bf16_f32 v81, v250, v251
    v_mfma_f32_16x16x32_bf16 v[238:241], v[222:225], v[56:59], v[238:241]
    ds_read_b128 v[218:221], v148 offset:10240
    ds_read_b128 v[222:225], v148 offset:11264
    s_waitcnt lgkmcnt(3)
    v_mfma_f32_16x16x32_bf16 v[242:245], v[0:3], v[226:229], 0
    s_setprio 0
    v_mfma_f32_16x16x32_bf16 v[242:245], v[4:7], v[230:233], v[242:245]
    v_cvt_pk_bf16_f32 v73, v238, v239
    v_cvt_pk_bf16_f32 v89, v238, v239
    v_mfma_f32_16x16x32_bf16 v[242:245], v[8:11], v[234:237], v[242:245]
    v_mfma_f32_16x16x32_bf16 v[246:249], v[12:15], v[226:229], 0
    v_mfma_f32_16x16x32_bf16 v[246:249], v[16:19], v[230:233], v[246:249]
    v_cvt_pk_bf16_f32 v124, v242, v243
    v_cvt_pk_bf16_f32 v125, v244, v245
    v_mfma_f32_16x16x32_bf16 v[246:249], v[20:23], v[234:237], v[246:249]
    v_mfma_f32_16x16x32_bf16 v[250:253], v[24:27], v[226:229], 0
    v_mfma_f32_16x16x32_bf16 v[250:253], v[28:31], v[230:233], v[250:253]
    v_cvt_pk_bf16_f32 v110, v248, v249
    v_cvt_pk_bf16_f32 v126, v246, v247
    v_mfma_f32_16x16x32_bf16 v[250:253], v[32:35], v[234:237], v[250:253]
    v_mfma_f32_16x16x32_bf16 v[238:241], v[226:229], v[36:39], 0
    v_mfma_f32_16x16x32_bf16 v[238:241], v[230:233], v[40:43], v[238:241]
    v_cvt_pk_bf16_f32 v108, v250, v251
    v_cvt_pk_bf16_f32 v109, v252, v253
    v_mfma_f32_16x16x32_bf16 v[238:241], v[234:237], v[44:47], v[238:241]
    s_setprio 2
    v_mfma_f32_16x16x32_bf16 v[242:245], v[226:229], v[48:51], v[166:169]
    ds_read_b128 v[226:229], v148 offset:12288
    v_mfma_f32_16x16x32_bf16 v[242:245], v[230:233], v[52:55], v[242:245]
    v_cvt_pk_bf16_f32 v60, v238, v239
    v_cvt_pk_bf16_f32 v61, v240, v241
    v_mfma_f32_16x16x32_bf16 v[242:245], v[234:237], v[56:59], v[242:245]
    ds_read_b128 v[230:233], v148 offset:13312
    ds_read_b128 v[234:237], v148 offset:14336
    s_waitcnt lgkmcnt(3)
    v_mfma_f32_16x16x32_bf16 v[246:249], v[0:3], v[214:217], 0
    s_setprio 0
    v_mfma_f32_16x16x32_bf16 v[246:249], v[4:7], v[218:221], v[246:249]
    v_cvt_pk_bf16_f32 v68, v242, v243
    v_cvt_pk_bf16_f32 v69, v244, v245
    v_mfma_f32_16x16x32_bf16 v[246:249], v[8:11], v[222:225], v[246:249]
    v_mfma_f32_16x16x32_bf16 v[250:253], v[12:15], v[214:217], 0
    v_mfma_f32_16x16x32_bf16 v[250:253], v[16:19], v[218:221], v[250:253]
    v_cvt_pk_bf16_f32 v128, v246, v247
    v_cvt_pk_bf16_f32 v129, v248, v249
    v_mfma_f32_16x16x32_bf16 v[250:253], v[20:23], v[222:225], v[250:253]
    v_mfma_f32_16x16x32_bf16 v[238:241], v[24:27], v[214:217], 0
    v_mfma_f32_16x16x32_bf16 v[238:241], v[28:31], v[218:221], v[238:241]
    v_cvt_pk_bf16_f32 v114, v252, v253
    v_cvt_pk_bf16_f32 v130, v250, v251
    v_mfma_f32_16x16x32_bf16 v[238:241], v[32:35], v[222:225], v[238:241]
    v_mfma_f32_16x16x32_bf16 v[242:245], v[214:217], v[36:39], 0
    v_mfma_f32_16x16x32_bf16 v[242:245], v[218:221], v[40:43], v[242:245]
    v_cvt_pk_bf16_f32 v112, v238, v239
    v_cvt_pk_bf16_f32 v113, v240, v241
    v_mfma_f32_16x16x32_bf16 v[242:245], v[222:225], v[44:47], v[242:245]
    v_mfma_f32_16x16x32_bf16 v[246:249], v[214:217], v[48:51], v[166:169]
    v_mfma_f32_16x16x32_bf16 v[246:249], v[218:221], v[52:55], v[246:249]
    v_cvt_pk_bf16_f32 v62, v242, v243
    v_cvt_pk_bf16_f32 v63, v244, v245
    v_mfma_f32_16x16x32_bf16 v[246:249], v[222:225], v[56:59], v[246:249]
    s_waitcnt lgkmcnt(0)
    v_mfma_f32_16x16x32_bf16 v[250:253], v[0:3], v[226:229], 0
    v_mfma_f32_16x16x32_bf16 v[250:253], v[4:7], v[230:233], v[250:253]
    v_cvt_pk_bf16_f32 v70, v246, v247
    v_cvt_pk_bf16_f32 v71, v248, v249
    v_mfma_f32_16x16x32_bf16 v[250:253], v[8:11], v[234:237], v[250:253]
    v_mfma_f32_16x16x32_bf16 v[238:241], v[12:15], v[226:229], 0
    v_mfma_f32_16x16x32_bf16 v[238:241], v[16:19], v[230:233], v[238:241]
    v_cvt_pk_bf16_f32 v132, v250, v251
    v_cvt_pk_bf16_f32 v133, v252, v253
    v_mfma_f32_16x16x32_bf16 v[238:241], v[20:23], v[234:237], v[238:241]
    v_mfma_f32_16x16x32_bf16 v[242:245], v[24:27], v[226:229], 0
    v_mfma_f32_16x16x32_bf16 v[242:245], v[28:31], v[230:233], v[242:245]
    v_cvt_pk_bf16_f32 v118, v240, v241
    v_cvt_pk_bf16_f32 v134, v238, v239
    v_mfma_f32_16x16x32_bf16 v[242:245], v[32:35], v[234:237], v[242:245]
    v_mfma_f32_16x16x32_bf16 v[246:249], v[226:229], v[36:39], 0
    v_mfma_f32_16x16x32_bf16 v[246:249], v[230:233], v[40:43], v[246:249]
    v_cvt_pk_bf16_f32 v116, v242, v243
    v_cvt_pk_bf16_f32 v117, v244, v245
    v_mfma_f32_16x16x32_bf16 v[246:249], v[234:237], v[44:47], v[246:249]
    v_mfma_f32_16x16x32_bf16 v[250:253], v[226:229], v[48:51], v[166:169]
    v_mfma_f32_16x16x32_bf16 v[250:253], v[230:233], v[52:55], v[250:253]
    v_cvt_pk_bf16_f32 v66, v246, v247
    v_cvt_pk_bf16_f32 v67, v248, v249
    v_mfma_f32_16x16x32_bf16 v[250:253], v[234:237], v[56:59], v[250:253]
    s_nop 7
    v_cvt_pk_bf16_f32 v74, v250, v251
    v_cvt_pk_bf16_f32 v75, v252, v253
    s_waitcnt lgkmcnt(0)
    s_nop 0
L_Afloop:
    s_setprio 2
    v_mfma_f32_16x16x32_bf16 v[184:187], v[108:111], v[124:127], 0
    ds_read_b32 v255, v127 offset:16
    s_add_u32 s92, s92, 0x39200
    v_mfma_f32_16x16x32_bf16 v[188:191], v[112:115], v[124:127], 0
    s_setprio 0
    v_mov_b32 v97, v65
    v_mov_b32 v105, v73
    v_mfma_f32_16x16x32_bf16 v[180:183], v[116:119], v[124:127], 0
    v_exp_f32 v184, v184
    v_mfma_f32_16x16x32_bf16 v[192:195], v[120:123], v[124:127], v[170:173]
    v_exp_f32 v185, v185
    v_mfma_f32_16x16x32_bf16 v[202:205], v[108:111], v[128:131], 0
    v_exp_f32 v186, v186
    v_mfma_f32_16x16x32_bf16 v[206:209], v[112:115], v[128:131], 0
    v_exp_f32 v187, v187
    v_mfma_f32_16x16x32_bf16 v[198:201], v[116:119], v[128:131], 0
    s_waitcnt lgkmcnt(0)
    v_readfirstlane_b32 s91, v255
    v_cvt_pk_bf16_f32 v184, v184, v185
    v_mfma_f32_16x16x32_bf16 v[210:213], v[120:123], v[128:131], v[170:173]
    v_exp_f32 v188, v188
    v_mfma_f32_16x16x32_bf16 v[154:157], v[108:111], v[136:139], 0
    s_setprio 2
    s_cmp_lt_u32 s91, s92
    s_cbranch_scc1 L_sw1
L_sb1:
    v_cvt_pk_bf16_f32 v185, v186, v187
    v_mfma_f32_16x16x32_bf16 v[158:161], v[112:115], v[136:139], 0
    ds_read_b128 v[214:217], v148 offset:24576
    ds_read_b128 v[218:221], v148 offset:25600
    v_mfma_f32_16x16x32_bf16 v[150:153], v[116:119], v[136:139], 0
    ds_read_b128 v[222:225], v148 offset:26624
    ds_read_b128 v[226:229], v148 offset:27648
    v_mfma_f32_16x16x32_bf16 v[162:165], v[120:123], v[136:139], v[176:179]
    ds_read_b128 v[230:233], v148 offset:28672
    ds_read_b128 v[234:237], v148 offset:29696
    v_exp_f32 v189, v189
    v_exp_f32 v190, v190
    v_exp_f32 v191, v191
    v_cvt_pk_bf16_f32 v186, v188, v189
    v_cvt_pk_bf16_f32 v187, v190, v191
    v_exp_f32 v180, v180
    s_nop 0
    v_mfma_f32_16x16x32_bf16 v[188:191], v[60:63], v[184:187], 0
    s_setprio 0
    v_exp_f32 v181, v181
    s_waitcnt lgkmcnt(5)
    v_mfma_f32_16x16x32_bf16 v[238:241], v[214:217], v[36:39], 0
    s_waitcnt lgkmcnt(4)
    v_exp_f32 v182, v182
    v_mfma_f32_16x16x32_bf16 v[238:241], v[218:221], v[40:43], v[238:241]
    s_waitcnt lgkmcnt(3)
    v_exp_f32 v183, v183
    v_mfma_f32_16x16x32_bf16 v[238:241], v[222:225], v[44:47], v[238:241]
    v_cvt_pk_bf16_f32 v180, v180, v181
    v_cvt_pk_bf16_f32 v181, v182, v183
    v_mfma_f32_16x16x32_bf16 v[242:245], v[214:217], v[48:51], v[166:169]
    v_exp_f32 v192, v192
    v_mfma_f32_16x16x32_bf16 v[242:245], v[218:221], v[52:55], v[242:245]
    v_cvt_pk_bf16_f32 v76, v238, v239
    v_cvt_pk_bf16_f32 v77, v240, v241
    v_mfma_f32_16x16x32_bf16 v[242:245], v[222:225], v[56:59], v[242:245]
    v_exp_f32 v202, v202
    v_mfma_f32_16x16x32_bf16 v[246:249], v[0:3], v[214:217], 0
    v_exp_f32 v203, v203
    v_mfma_f32_16x16x32_bf16 v[246:249], v[4:7], v[218:221], v[246:249]
    v_cvt_pk_bf16_f32 v84, v242, v243
    v_cvt_pk_bf16_f32 v85, v244, v245
    v_mfma_f32_16x16x32_bf16 v[246:249], v[8:11], v[222:225], v[246:249]
    v_cvt_pk_bf16_f32 v179, v192, 0
    v_cvt_pk_bf16_f32 v202, v202, v203
    v_mfma_f32_16x16x32_bf16 v[192:195], v[68:71], v[184:187], 0
    v_exp_f32 v204, v204
    v_mfma_f32_16x16x32_bf16 v[192:195], v[72:75], v[178:181], v[192:195]
    v_cvt_pk_bf16_f32 v124, v246, v247
    v_cvt_pk_bf16_f32 v125, v248, v249
    v_mfma_f32_16x16x32_bf16 v[188:191], v[64:67], v[178:181], v[188:191]
    s_waitcnt lgkmcnt(0)
    v_exp_f32 v205, v205
    v_mfma_f32_16x16x32_bf16 v[250:253], v[226:229], v[36:39], 0
    v_rcp_f32 v195, v194
    v_mfma_f32_16x16x32_bf16 v[250:253], v[230:233], v[40:43], v[250:253]
    v_max3_f32 v171, v171, v194, v195
    v_mul_f32 v195, 0x3febdf1c, v195
    v_mfma_f32_16x16x32_bf16 v[250:253], v[234:237], v[44:47], v[250:253]
    v_mul_f32 v188, v188, v195
    v_mul_f32 v189, v189, v195
    v_mfma_f32_16x16x32_bf16 v[238:241], v[226:229], v[48:51], v[166:169]
    v_mul_f32 v190, v190, v195
    v_mul_f32 v191, v191, v195
    v_mfma_f32_16x16x32_bf16 v[238:241], v[230:233], v[52:55], v[238:241]
    v_mul_f32 v192, v192, v195
    v_mul_f32 v193, v193, v195
    v_mfma_f32_16x16x32_bf16 v[238:241], v[234:237], v[56:59], v[238:241]
    s_setprio 2
    v_cvt_pk_bf16_f32 v188, v188, v189
    v_cvt_pk_bf16_f32 v189, v190, v191
    v_mfma_f32_16x16x32_bf16 v[242:245], v[0:3], v[226:229], 0
    ds_write_b64 v178, v[188:189]
    v_mfma_f32_16x16x32_bf16 v[242:245], v[4:7], v[230:233], v[242:245]
    v_cvt_pk_bf16_f32 v192, v192, v193
    v_cvt_pk_bf16_f32 v78, v250, v251
    v_mfma_f32_16x16x32_bf16 v[242:245], v[8:11], v[234:237], v[242:245]
    ds_write_b32 v196, v192
    v_mfma_f32_16x16x32_bf16 v[184:187], v[108:111], v[132:135], 0
    s_setprio 0
    v_cvt_pk_bf16_f32 v79, v252, v253
    v_cvt_pk_bf16_f32 v86, v238, v239
    v_mfma_f32_16x16x32_bf16 v[188:191], v[112:115], v[132:135], 0
    v_cvt_pk_bf16_f32 v87, v240, v241
    v_cvt_pk_bf16_f32 v128, v242, v243
    v_mfma_f32_16x16x32_bf16 v[180:183], v[116:119], v[132:135], 0
    v_cvt_pk_bf16_f32 v129, v244, v245
    v_cvt_pk_bf16_f32 v203, v204, v205
    v_mfma_f32_16x16x32_bf16 v[192:195], v[120:123], v[132:135], v[170:173]
    v_exp_f32 v206, v206
    v_mfma_f32_16x16x32_bf16 v[246:249], v[12:15], v[214:217], 0
    v_exp_f32 v207, v207
    v_mfma_f32_16x16x32_bf16 v[246:249], v[16:19], v[218:221], v[246:249]
    v_exp_f32 v208, v208
    v_mfma_f32_16x16x32_bf16 v[246:249], v[20:23], v[222:225], v[246:249]
    v_exp_f32 v209, v209
    v_mfma_f32_16x16x32_bf16 v[250:253], v[24:27], v[214:217], 0
    s_setprio 2
    v_cvt_pk_bf16_f32 v204, v206, v207
    v_cvt_pk_bf16_f32 v205, v208, v209
    v_mfma_f32_16x16x32_bf16 v[250:253], v[28:31], v[218:221], v[250:253]
    ds_read_b128 v[214:217], v148 offset:30720
    ds_read_b128 v[218:221], v148 offset:31744
    v_mfma_f32_16x16x32_bf16 v[250:253], v[32:35], v[222:225], v[250:253]
    v_cvt_pk_bf16_f32 v110, v248, v249
    v_cvt_pk_bf16_f32 v126, v246, v247
    v_mfma_f32_16x16x32_bf16 v[206:209], v[60:63], v[202:205], 0
    ds_read_b128 v[222:225], v148 offset:32768
    v_mfma_f32_16x16x32_bf16 v[238:241], v[12:15], v[226:229], 0
    s_setprio 0
    v_cvt_pk_bf16_f32 v108, v250, v251
    v_cvt_pk_bf16_f32 v109, v252, v253
    v_mfma_f32_16x16x32_bf16 v[238:241], v[16:19], v[230:233], v[238:241]
    v_exp_f32 v198, v198
    v_mfma_f32_16x16x32_bf16 v[238:241], v[20:23], v[234:237], v[238:241]
    v_exp_f32 v199, v199
    v_mfma_f32_16x16x32_bf16 v[242:245], v[24:27], v[226:229], 0
    v_exp_f32 v200, v200
    v_mfma_f32_16x16x32_bf16 v[242:245], v[28:31], v[230:233], v[242:245]
    v_exp_f32 v201, v201
    v_mfma_f32_16x16x32_bf16 v[242:245], v[32:35], v[234:237], v[242:245]
    s_waitcnt lgkmcnt(1)
    v_cvt_pk_bf16_f32 v198, v198, v199
    v_cvt_pk_bf16_f32 v199, v200, v201
    v_mfma_f32_16x16x32_bf16 v[246:249], v[0:3], v[214:217], 0
    v_exp_f32 v210, v210
    v_mfma_f32_16x16x32_bf16 v[246:249], v[4:7], v[218:221], v[246:249]
    v_cvt_pk_bf16_f32 v197, v210, 0
    v_cvt_pk_bf16_f32 v114, v240, v241
    v_mfma_f32_16x16x32_bf16 v[210:213], v[68:71], v[202:205], 0
    v_cvt_pk_bf16_f32 v130, v238, v239
    v_cvt_pk_bf16_f32 v112, v242, v243
    v_mfma_f32_16x16x32_bf16 v[210:213], v[72:75], v[196:199], v[210:213]
    v_exp_f32 v184, v184
    v_mfma_f32_16x16x32_bf16 v[206:209], v[64:67], v[196:199], v[206:209]
    s_waitcnt lgkmcnt(0)
    v_exp_f32 v185, v185
    v_mfma_f32_16x16x32_bf16 v[246:249], v[8:11], v[222:225], v[246:249]
    v_rcp_f32 v213, v212
    v_mfma_f32_16x16x32_bf16 v[250:253], v[12:15], v[214:217], 0
    v_max3_f32 v171, v171, v212, v213
    v_mul_f32 v213, 0x3febdf1c, v213
    v_mfma_f32_16x16x32_bf16 v[250:253], v[16:19], v[218:221], v[250:253]
    v_mul_f32 v206, v206, v213
    v_mul_f32 v207, v207, v213
    v_mfma_f32_16x16x32_bf16 v[250:253], v[20:23], v[222:225], v[250:253]
    v_mul_f32 v208, v208, v213
    v_mul_f32 v209, v209, v213
    v_mfma_f32_16x16x32_bf16 v[238:241], v[24:27], v[214:217], 0
    v_mul_f32 v210, v210, v213
    v_mul_f32 v211, v211, v213
    v_mfma_f32_16x16x32_bf16 v[238:241], v[28:31], v[218:221], v[238:241]
    v_cvt_pk_bf16_f32 v206, v206, v207
    v_cvt_pk_bf16_f32 v207, v208, v209
    v_mfma_f32_16x16x32_bf16 v[238:241], v[32:35], v[222:225], v[238:241]
    s_setprio 2
    v_cvt_pk_bf16_f32 v210, v210, v211
    v_cvt_pk_bf16_f32 v113, v244, v245
    v_mfma_f32_16x16x32_bf16 v[242:245], v[214:217], v[36:39], 0
    ds_write_b64 v178, v[206:207] offset:3072
    v_mfma_f32_16x16x32_bf16 v[242:245], v[218:221], v[40:43], v[242:245]
    ds_write_b32 v196, v210 offset:3072
    v_mfma_f32_16x16x32_bf16 v[242:245], v[222:225], v[44:47], v[242:245]
    s_setprio 0
    v_exp_f32 v186, v186
    v_exp_f32 v187, v187
    v_cvt_pk_bf16_f32 v184, v184, v185
    v_cvt_pk_bf16_f32 v185, v186, v187
    v_exp_f32 v188, v188
    v_exp_f32 v189, v189
    v_exp_f32 v190, v190
    v_exp_f32 v191, v191
    v_cvt_pk_bf16_f32 v186, v188, v189
    v_cvt_pk_bf16_f32 v187, v190, v191
    v_exp_f32 v180, v180
    s_nop 0
    v_mfma_f32_16x16x32_bf16 v[188:191], v[60:63], v[184:187], 0
    v_exp_f32 v181, v181
    v_exp_f32 v182, v182
    v_exp_f32 v183, v183
    v_cvt_pk_bf16_f32 v180, v180, v181
    v_cvt_pk_bf16_f32 v181, v182, v183
    v_exp_f32 v192, v192
    v_cvt_pk_bf16_f32 v132, v246, v247
    v_cvt_pk_bf16_f32 v179, v192, 0
    v_mfma_f32_16x16x32_bf16 v[192:195], v[68:71], v[184:187], 0
    v_cvt_pk_bf16_f32 v133, v248, v249
    v_cvt_pk_bf16_f32 v118, v252, v253
    v_mfma_f32_16x16x32_bf16 v[192:195], v[72:75], v[178:181], v[192:195]
    v_cvt_pk_bf16_f32 v134, v250, v251
    v_cvt_pk_bf16_f32 v116, v238, v239
    v_mfma_f32_16x16x32_bf16 v[188:191], v[64:67], v[178:181], v[188:191]
    v_cvt_pk_bf16_f32 v117, v240, v241
    v_cvt_pk_bf16_f32 v82, v242, v243
    v_mfma_f32_16x16x32_bf16 v[246:249], v[214:217], v[48:51], v[166:169]
    v_rcp_f32 v195, v194
    v_mfma_f32_16x16x32_bf16 v[246:249], v[218:221], v[52:55], v[246:249]
    s_setprio 2
    v_max3_f32 v171, v171, v194, v195
    v_mul_f32 v195, 0x3febdf1c, v195
    v_mfma_f32_16x16x32_bf16 v[246:249], v[222:225], v[56:59], v[246:249]
    v_mul_f32 v188, v188, v195
    v_mul_f32 v189, v189, v195
    v_mul_f32 v190, v190, v195
    v_mul_f32 v191, v191, v195
    v_mul_f32 v192, v192, v195
    v_mul_f32 v193, v193, v195
    v_cvt_pk_bf16_f32 v188, v188, v189
    v_cvt_pk_bf16_f32 v189, v190, v191
    v_cvt_pk_bf16_f32 v192, v192, v193
    v_cvt_pk_bf16_f32 v83, v244, v245
    v_cvt_pk_bf16_f32 v90, v246, v247
    v_cvt_pk_bf16_f32 v91, v248, v249
    ds_write_b64 v178, v[188:189] offset:6144
    ds_write_b32 v196, v192 offset:6144
    ds_add_u32 v127, v131 offset:20
    s_setprio 0
    s_setprio 2
    v_mfma_f32_16x16x32_bf16 v[184:187], v[108:111], v[124:127], 0
    ds_read_b32 v255, v127 offset:16
    s_add_u32 s92, s92, 0x39200
    v_mfma_f32_16x16x32_bf16 v[188:191], v[112:115], v[124:127], 0
    s_setprio 0
    v_mfma_f32_16x16x32_bf16 v[180:183], v[116:119], v[124:127], 0
    v_exp_f32 v184, v184
    v_mfma_f32_16x16x32_bf16 v[192:195], v[120:123], v[124:127], v[172:175]
    v_exp_f32 v185, v185
    v_mfma_f32_16x16x32_bf16 v[202:205], v[108:111], v[128:131], 0
    v_exp_f32 v186, v186
    v_mfma_f32_16x16x32_bf16 v[206:209], v[112:115], v[128:131], 0
    v_exp_f32 v187, v187
    v_mfma_f32_16x16x32_bf16 v[198:201], v[116:119], v[128:131], 0
    s_waitcnt lgkmcnt(0)
    v_readfirstlane_b32 s91, v255
    v_cvt_pk_bf16_f32 v184, v184, v185
    v_mfma_f32_16x16x32_bf16 v[210:213], v[120:123], v[128:131], v[172:175]
    v_exp_f32 v188, v188
    v_mfma_f32_16x16x32_bf16 v[154:157], v[108:111], v[140:143], v[154:157]
    s_setprio 2
    s_cmp_lt_u32 s91, s92
    s_cbranch_scc1 L_sw2
L_sb2:
    v_cvt_pk_bf16_f32 v185, v186, v187
    v_mfma_f32_16x16x32_bf16 v[158:161], v[112:115], v[140:143], v[158:161]
    ds_read_b128 v[214:217], v148 offset:33792
    ds_read_b128 v[218:221], v148 offset:34816
    v_mfma_f32_16x16x32_bf16 v[150:153], v[116:119], v[140:143], v[150:153]
    ds_read_b128 v[222:225], v148 offset:35840
    ds_read_b128 v[226:229], v148 offset:36864
    v_mfma_f32_16x16x32_bf16 v[162:165], v[120:123], v[140:143], v[162:165]
    ds_read_b128 v[230:233], v148 offset:37888
    ds_read_b128 v[234:237], v148 offset:38912
    v_exp_f32 v189, v189
    v_exp_f32 v190, v190
    v_exp_f32 v191, v191
    v_cvt_pk_bf16_f32 v186, v188, v189
    v_cvt_pk_bf16_f32 v187, v190, v191
    v_exp_f32 v180, v180
    s_nop 0
    v_mfma_f32_16x16x32_bf16 v[188:191], v[76:79], v[184:187], 0
    s_setprio 0
    v_exp_f32 v181, v181
    s_waitcnt lgkmcnt(5)
    v_mfma_f32_16x16x32_bf16 v[238:241], v[214:217], v[36:39], 0
    s_waitcnt lgkmcnt(4)
    v_exp_f32 v182, v182
    v_mfma_f32_16x16x32_bf16 v[238:241], v[218:221], v[40:43], v[238:241]
    s_waitcnt lgkmcnt(3)
    v_exp_f32 v183, v183
    v_mfma_f32_16x16x32_bf16 v[238:241], v[222:225], v[44:47], v[238:241]
    v_cvt_pk_bf16_f32 v180, v180, v181
    v_cvt_pk_bf16_f32 v181, v182, v183
    v_mfma_f32_16x16x32_bf16 v[242:245], v[214:217], v[48:51], v[166:169]
    v_exp_f32 v192, v192
    v_mfma_f32_16x16x32_bf16 v[242:245], v[218:221], v[52:55], v[242:245]
    v_cvt_pk_bf16_f32 v92, v238, v239
    v_cvt_pk_bf16_f32 v93, v240, v241
    v_mfma_f32_16x16x32_bf16 v[242:245], v[222:225], v[56:59], v[242:245]
    v_exp_f32 v202, v202
    v_mfma_f32_16x16x32_bf16 v[246:249], v[0:3], v[214:217], 0
    v_exp_f32 v203, v203
    v_mfma_f32_16x16x32_bf16 v[246:249], v[4:7], v[218:221], v[246:249]
    v_cvt_pk_bf16_f32 v100, v242, v243
    v_cvt_pk_bf16_f32 v101, v244, v245
    v_mfma_f32_16x16x32_bf16 v[246:249], v[8:11], v[222:225], v[246:249]
    v_cvt_pk_bf16_f32 v179, v192, 0
    v_cvt_pk_bf16_f32 v202, v202, v203
    v_mfma_f32_16x16x32_bf16 v[192:195], v[84:87], v[184:187], 0
    v_exp_f32 v204, v204
    v_mfma_f32_16x16x32_bf16 v[192:195], v[88:91], v[178:181], v[192:195]
    v_cvt_pk_bf16_f32 v124, v246, v247
    v_cvt_pk_bf16_f32 v125, v248, v249
    v_mfma_f32_16x16x32_bf16 v[188:191], v[80:83], v[178:181], v[188:191]
    s_waitcnt lgkmcnt(0)
    v_exp_f32 v205, v205
    v_mfma_f32_16x16x32_bf16 v[250:253], v[226:229], v[36:39], 0
    v_rcp_f32 v195, v194
    v_mfma_f32_16x16x32_bf16 v[250:253], v[230:233], v[40:43], v[250:253]
    v_max3_f32 v171, v171, v194, v195
    v_mul_f32 v195, 0x3febdf1c, v195
    v_mfma_f32_16x16x32_bf16 v[250:253], v[234:237], v[44:47], v[250:253]
    v_mul_f32 v188, v188, v195
    v_mul_f32 v189, v189, v195
    v_mfma_f32_16x16x32_bf16 v[238:241], v[226:229], v[48:51], v[166:169]
    v_mul_f32 v190, v190, v195
    v_mul_f32 v191, v191, v195
    v_mfma_f32_16x16x32_bf16 v[238:241], v[230:233], v[52:55], v[238:241]
    v_mul_f32 v192, v192, v195
    v_mul_f32 v193, v193, v195
    v_mfma_f32_16x16x32_bf16 v[238:241], v[234:237], v[56:59], v[238:241]
    s_setprio 2
    v_cvt_pk_bf16_f32 v188, v188, v189
    v_cvt_pk_bf16_f32 v189, v190, v191
    v_mfma_f32_16x16x32_bf16 v[242:245], v[0:3], v[226:229], 0
    ds_write_b64 v178, v[188:189] offset:9216
    v_mfma_f32_16x16x32_bf16 v[242:245], v[4:7], v[230:233], v[242:245]
    v_cvt_pk_bf16_f32 v192, v192, v193
    v_cvt_pk_bf16_f32 v94, v250, v251
    v_mfma_f32_16x16x32_bf16 v[242:245], v[8:11], v[234:237], v[242:245]
    ds_write_b32 v196, v192 offset:9216
    v_mfma_f32_16x16x32_bf16 v[184:187], v[108:111], v[132:135], 0
    s_setprio 0
    v_cvt_pk_bf16_f32 v95, v252, v253
    v_cvt_pk_bf16_f32 v102, v238, v239
    v_mfma_f32_16x16x32_bf16 v[188:191], v[112:115], v[132:135], 0
    v_cvt_pk_bf16_f32 v103, v240, v241
    v_cvt_pk_bf16_f32 v128, v242, v243
    v_mfma_f32_16x16x32_bf16 v[180:183], v[116:119], v[132:135], 0
    v_cvt_pk_bf16_f32 v129, v244, v245
    v_cvt_pk_bf16_f32 v203, v204, v205
    v_mfma_f32_16x16x32_bf16 v[192:195], v[120:123], v[132:135], v[172:175]
    v_exp_f32 v206, v206
    v_mfma_f32_16x16x32_bf16 v[246:249], v[12:15], v[214:217], 0
    v_exp_f32 v207, v207
    v_mfma_f32_16x16x32_bf16 v[246:249], v[16:19], v[218:221], v[246:249]
    v_exp_f32 v208, v208
    v_mfma_f32_16x16x32_bf16 v[246:249], v[20:23], v[222:225], v[246:249]
    v_exp_f32 v209, v209
    v_mfma_f32_16x16x32_bf16 v[250:253], v[24:27], v[214:217], 0
    s_setprio 2
    v_cvt_pk_bf16_f32 v204, v206, v207
    v_cvt_pk_bf16_f32 v205, v208, v209
    v_mfma_f32_16x16x32_bf16 v[250:253], v[28:31], v[218:221], v[250:253]
    ds_read_b128 v[214:217], v148 offset:39936
    ds_read_b128 v[218:221], v148 offset:40960
    v_mfma_f32_16x16x32_bf16 v[250:253], v[32:35], v[222:225], v[250:253]
    v_cvt_pk_bf16_f32 v110, v248, v249
    v_cvt_pk_bf16_f32 v126, v246, v247
    v_mfma_f32_16x16x32_bf16 v[206:209], v[76:79], v[202:205], 0
    ds_read_b128 v[222:225], v148 offset:41984
    v_mfma_f32_16x16x32_bf16 v[238:241], v[12:15], v[226:229], 0
    s_setprio 0
    v_cvt_pk_bf16_f32 v108, v250, v251
    v_cvt_pk_bf16_f32 v109, v252, v253
    v_mfma_f32_16x16x32_bf16 v[238:241], v[16:19], v[230:233], v[238:241]
    v_exp_f32 v198, v198
    v_mfma_f32_16x16x32_bf16 v[238:241], v[20:23], v[234:237], v[238:241]
    v_exp_f32 v199, v199
    v_mfma_f32_16x16x32_bf16 v[242:245], v[24:27], v[226:229], 0
    v_exp_f32 v200, v200
    v_mfma_f32_16x16x32_bf16 v[242:245], v[28:31], v[230:233], v[242:245]
    v_exp_f32 v201, v201
    v_mfma_f32_16x16x32_bf16 v[242:245], v[32:35], v[234:237], v[242:245]
    s_waitcnt lgkmcnt(1)
    v_cvt_pk_bf16_f32 v198, v198, v199
    v_cvt_pk_bf16_f32 v199, v200, v201
    v_mfma_f32_16x16x32_bf16 v[246:249], v[0:3], v[214:217], 0
    v_exp_f32 v210, v210
    v_mfma_f32_16x16x32_bf16 v[246:249], v[4:7], v[218:221], v[246:249]
    v_cvt_pk_bf16_f32 v197, v210, 0
    v_cvt_pk_bf16_f32 v114, v240, v241
    v_mfma_f32_16x16x32_bf16 v[210:213], v[84:87], v[202:205], 0
    v_cvt_pk_bf16_f32 v130, v238, v239
    v_cvt_pk_bf16_f32 v112, v242, v243
    v_mfma_f32_16x16x32_bf16 v[210:213], v[88:91], v[196:199], v[210:213]
    v_exp_f32 v184, v184
    v_mfma_f32_16x16x32_bf16 v[206:209], v[80:83], v[196:199], v[206:209]
    s_waitcnt lgkmcnt(0)
    v_exp_f32 v185, v185
    v_mfma_f32_16x16x32_bf16 v[246:249], v[8:11], v[222:225], v[246:249]
    v_rcp_f32 v213, v212
    v_mfma_f32_16x16x32_bf16 v[250:253], v[12:15], v[214:217], 0
    v_max3_f32 v171, v171, v212, v213
    v_mul_f32 v213, 0x3febdf1c, v213
    v_mfma_f32_16x16x32_bf16 v[250:253], v[16:19], v[218:221], v[250:253]
    v_mul_f32 v206, v206, v213
    v_mul_f32 v207, v207, v213
    v_mfma_f32_16x16x32_bf16 v[250:253], v[20:23], v[222:225], v[250:253]
    v_mul_f32 v208, v208, v213
    v_mul_f32 v209, v209, v213
    v_mfma_f32_16x16x32_bf16 v[238:241], v[24:27], v[214:217], 0
    v_mul_f32 v210, v210, v213
    v_mul_f32 v211, v211, v213
    v_mfma_f32_16x16x32_bf16 v[238:241], v[28:31], v[218:221], v[238:241]
    v_cvt_pk_bf16_f32 v206, v206, v207
    v_cvt_pk_bf16_f32 v207, v208, v209
    v_mfma_f32_16x16x32_bf16 v[238:241], v[32:35], v[222:225], v[238:241]
    s_setprio 2
    v_cvt_pk_bf16_f32 v210, v210, v211
    v_cvt_pk_bf16_f32 v113, v244, v245
    v_mfma_f32_16x16x32_bf16 v[242:245], v[214:217], v[36:39], 0
    ds_write_b64 v178, v[206:207] offset:12288
    v_mfma_f32_16x16x32_bf16 v[242:245], v[218:221], v[40:43], v[242:245]
    ds_write_b32 v196, v210 offset:12288
    v_mfma_f32_16x16x32_bf16 v[242:245], v[222:225], v[44:47], v[242:245]
    s_setprio 0
    v_exp_f32 v186, v186
    v_exp_f32 v187, v187
    v_cvt_pk_bf16_f32 v184, v184, v185
    v_cvt_pk_bf16_f32 v185, v186, v187
    v_exp_f32 v188, v188
    v_exp_f32 v189, v189
    v_exp_f32 v190, v190
    v_exp_f32 v191, v191
    v_cvt_pk_bf16_f32 v186, v188, v189
    v_cvt_pk_bf16_f32 v187, v190, v191
    v_exp_f32 v180, v180
    s_nop 0
    v_mfma_f32_16x16x32_bf16 v[188:191], v[76:79], v[184:187], 0
    v_exp_f32 v181, v181
    v_exp_f32 v182, v182
    v_exp_f32 v183, v183
    v_cvt_pk_bf16_f32 v180, v180, v181
    v_cvt_pk_bf16_f32 v181, v182, v183
    v_exp_f32 v192, v192
    v_cvt_pk_bf16_f32 v132, v246, v247
    v_cvt_pk_bf16_f32 v179, v192, 0
    v_mfma_f32_16x16x32_bf16 v[192:195], v[84:87], v[184:187], 0
    v_cvt_pk_bf16_f32 v133, v248, v249
    v_cvt_pk_bf16_f32 v118, v252, v253
    v_mfma_f32_16x16x32_bf16 v[192:195], v[88:91], v[178:181], v[192:195]
    v_cvt_pk_bf16_f32 v134, v250, v251
    v_cvt_pk_bf16_f32 v116, v238, v239
    v_mfma_f32_16x16x32_bf16 v[188:191], v[80:83], v[178:181], v[188:191]
    v_cvt_pk_bf16_f32 v117, v240, v241
    v_cvt_pk_bf16_f32 v98, v242, v243
    v_mfma_f32_16x16x32_bf16 v[246:249], v[214:217], v[48:51], v[166:169]
    v_rcp_f32 v195, v194
    v_mfma_f32_16x16x32_bf16 v[246:249], v[218:221], v[52:55], v[246:249]
    s_setprio 2
    v_max3_f32 v171, v171, v194, v195
    v_mul_f32 v195, 0x3febdf1c, v195
    v_mfma_f32_16x16x32_bf16 v[246:249], v[222:225], v[56:59], v[246:249]
    v_mul_f32 v188, v188, v195
    v_mul_f32 v189, v189, v195
    v_mul_f32 v190, v190, v195
    v_mul_f32 v191, v191, v195
    v_mul_f32 v192, v192, v195
    v_mul_f32 v193, v193, v195
    v_cvt_pk_bf16_f32 v188, v188, v189
    v_cvt_pk_bf16_f32 v189, v190, v191
    v_cvt_pk_bf16_f32 v192, v192, v193
    v_cvt_pk_bf16_f32 v99, v244, v245
    v_cvt_pk_bf16_f32 v106, v246, v247
    v_cvt_pk_bf16_f32 v107, v248, v249
    ds_write_b64 v178, v[188:189] offset:15360
    ds_write_b32 v196, v192 offset:15360
    ds_add_u32 v127, v131 offset:20
    s_setprio 0
    s_add_u32 s37, s37, 1
    s_cmp_eq_u32 s37, 7
    s_cbranch_scc1 L_Aflast
    s_setprio 2
    v_mfma_f32_16x16x32_bf16 v[184:187], v[108:111], v[124:127], 0
    ds_read_b32 v255, v127 offset:16
    s_add_u32 s92, s92, 0x39200
    v_mfma_f32_16x16x32_bf16 v[188:191], v[112:115], v[124:127], 0
    s_setprio 0
    v_mfma_f32_16x16x32_bf16 v[180:183], v[116:119], v[124:127], 0
    v_exp_f32 v184, v184
    v_mfma_f32_16x16x32_bf16 v[192:195], v[120:123], v[124:127], v[174:177]
    v_exp_f32 v185, v185
    v_mfma_f32_16x16x32_bf16 v[154:157], v[108:111], v[144:147], v[154:157]
    v_exp_f32 v186, v186
    v_mfma_f32_16x16x32_bf16 v[158:161], v[112:115], v[144:147], v[158:161]
    v_exp_f32 v187, v187
    v_mfma_f32_16x16x32_bf16 v[150:153], v[116:119], v[144:147], v[150:153]
    s_waitcnt lgkmcnt(0)
    v_readfirstlane_b32 s91, v255
    v_cvt_pk_bf16_f32 v184, v184, v185
    v_mfma_f32_16x16x32_bf16 v[162:165], v[120:123], v[144:147], v[162:165]
    v_exp_f32 v188, v188
    v_mfma_f32_16x16x32_bf16 v[202:205], v[108:111], v[128:131], 0
    s_setprio 2
    s_cmp_lt_u32 s91, s92
    s_cbranch_scc1 L_sw3
L_sb3:
    v_cvt_pk_bf16_f32 v185, v186, v187
    v_mfma_f32_16x16x32_bf16 v[206:209], v[112:115], v[128:131], 0
    ds_read_b128 v[214:217], v148 offset:6144
    ds_read_b128 v[218:221], v148 offset:7168
    v_mfma_f32_16x16x32_bf16 v[198:201], v[116:119], v[128:131], 0
    ds_read_b128 v[222:225], v148 offset:8192
    ds_read_b128 v[226:229], v148 offset:9216
    v_mfma_f32_16x16x32_bf16 v[210:213], v[120:123], v[128:131], v[174:177]
    ds_read_b128 v[230:233], v148 offset:10240
    ds_read_b128 v[234:237], v148 offset:11264
    v_exp_f32 v189, v189
    v_exp_f32 v190, v190
    v_exp_f32 v191, v191
    v_cvt_pk_bf16_f32 v186, v188, v189
    v_cvt_pk_bf16_f32 v187, v190, v191
    v_exp_f32 v180, v180
    s_nop 0
    v_mfma_f32_16x16x32_bf16 v[188:191], v[92:95], v[184:187], 0
    s_setprio 0
    v_exp_f32 v181, v181
    s_waitcnt lgkmcnt(5)
    v_mfma_f32_16x16x32_bf16 v[238:241], v[0:3], v[214:217], 0
    s_waitcnt lgkmcnt(4)
    v_exp_f32 v182, v182
    v_mfma_f32_16x16x32_bf16 v[238:241], v[4:7], v[218:221], v[238:241]
    s_waitcnt lgkmcnt(3)
    v_exp_f32 v183, v183
    v_mfma_f32_16x16x32_bf16 v[238:241], v[8:11], v[222:225], v[238:241]
    s_waitcnt lgkmcnt(0)
    v_cvt_pk_bf16_f32 v180, v180, v181
    v_cvt_pk_bf16_f32 v181, v182, v183
    v_mfma_f32_16x16x32_bf16 v[242:245], v[0:3], v[226:229], 0
    v_exp_f32 v192, v192
    v_mfma_f32_16x16x32_bf16 v[242:245], v[4:7], v[230:233], v[242:245]
    v_cvt_pk_bf16_f32 v124, v238, v239
    v_cvt_pk_bf16_f32 v125, v240, v241
    v_mfma_f32_16x16x32_bf16 v[242:245], v[8:11], v[234:237], v[242:245]
    v_cvt_pk_bf16_f32 v179, v192, 0
    v_mfma_f32_16x16x32_bf16 v[192:195], v[100:103], v[184:187], 0
    v_exp_f32 v154, v154
    v_mfma_f32_16x16x32_bf16 v[192:195], v[104:107], v[178:181], v[192:195]
    v_cvt_pk_bf16_f32 v128, v242, v243
    v_cvt_pk_bf16_f32 v129, v244, v245
    v_mfma_f32_16x16x32_bf16 v[188:191], v[96:99], v[178:181], v[188:191]
    v_exp_f32 v155, v155
    v_mfma_f32_16x16x32_bf16 v[184:187], v[108:111], v[132:135], 0
    v_rcp_f32 v195, v194
    v_mfma_f32_16x16x32_bf16 v[180:183], v[116:119], v[132:135], 0
    s_setprio 2
    v_max3_f32 v171, v171, v194, v195
    v_mul_f32 v195, 0x3febdf1c, v195
    v_mul_f32 v188, v188, v195
    v_mul_f32 v189, v189, v195
    v_mul_f32 v190, v190, v195
    v_mul_f32 v191, v191, v195
    v_mul_f32 v192, v192, v195
    v_mul_f32 v193, v193, v195
    v_cvt_pk_bf16_f32 v188, v188, v189
    v_cvt_pk_bf16_f32 v189, v190, v191
    v_cvt_pk_bf16_f32 v192, v192, v193
    v_exp_f32 v156, v156
    v_exp_f32 v157, v157
    v_cvt_pk_bf16_f32 v154, v154, v155
    v_cvt_pk_bf16_f32 v155, v156, v157
    v_exp_f32 v158, v158
    v_exp_f32 v159, v159
    v_exp_f32 v160, v160
    v_exp_f32 v161, v161
    v_cvt_pk_bf16_f32 v156, v158, v159
    v_cvt_pk_bf16_f32 v157, v160, v161
    v_exp_f32 v150, v150
    s_nop 0
    v_mfma_f32_16x16x32_bf16 v[158:161], v[60:63], v[154:157], 0
    ds_write_b64 v178, v[188:189] offset:18432
    v_mfma_f32_16x16x32_bf16 v[188:191], v[112:115], v[132:135], 0
    ds_write_b32 v196, v192 offset:18432
    v_mfma_f32_16x16x32_bf16 v[192:195], v[120:123], v[132:135], v[174:177]
    s_setprio 0
    v_exp_f32 v151, v151
    v_mfma_f32_16x16x32_bf16 v[246:249], v[84:87], v[154:157], 0
    v_exp_f32 v152, v152
    v_mfma_f32_16x16x32_bf16 v[250:253], v[76:79], v[154:157], 0
    v_exp_f32 v153, v153
    v_mfma_f32_16x16x32_bf16 v[238:241], v[100:103], v[154:157], 0
    v_cvt_pk_bf16_f32 v150, v150, v151
    v_cvt_pk_bf16_f32 v151, v152, v153
    v_mfma_f32_16x16x32_bf16 v[242:245], v[92:95], v[154:157], 0
    v_exp_f32 v162, v162
    v_exp_f32 v202, v202
    v_cvt_pk_bf16_f32 v149, v162, 0
    v_mfma_f32_16x16x32_bf16 v[162:165], v[68:71], v[154:157], 0
    v_exp_f32 v203, v203
    v_mfma_f32_16x16x32_bf16 v[162:165], v[72:75], v[148:151], v[162:165]
    v_exp_f32 v204, v204
    v_mfma_f32_16x16x32_bf16 v[158:161], v[64:67], v[148:151], v[158:161]
    v_exp_f32 v205, v205
    v_mfma_f32_16x16x32_bf16 v[246:249], v[88:91], v[148:151], v[246:249]
    v_cvt_pk_bf16_f32 v202, v202, v203
    v_cvt_pk_bf16_f32 v203, v204, v205
    v_mfma_f32_16x16x32_bf16 v[250:253], v[80:83], v[148:151], v[250:253]
    v_exp_f32 v206, v206
    v_mfma_f32_16x16x32_bf16 v[238:241], v[104:107], v[148:151], v[238:241]
    v_cndmask_b32 v162, v162, v246, s[62:63]
    v_cndmask_b32 v163, v163, v247, s[62:63]
    v_mfma_f32_16x16x32_bf16 v[242:245], v[96:99], v[148:151], v[242:245]
    v_cndmask_b32 v164, v164, v248, s[62:63]
    v_cndmask_b32 v158, v158, v250, s[62:63]
    v_mfma_f32_16x16x32_bf16 v[246:249], v[12:15], v[214:217], 0
    v_cndmask_b32 v159, v159, v251, s[62:63]
    v_cndmask_b32 v160, v160, v252, s[62:63]
    v_mfma_f32_16x16x32_bf16 v[246:249], v[16:19], v[218:221], v[246:249]
    v_cndmask_b32 v161, v161, v253, s[62:63]
    v_cndmask_b32 v162, v162, v238, s[64:65]
    v_mfma_f32_16x16x32_bf16 v[246:249], v[20:23], v[222:225], v[246:249]
    v_cndmask_b32 v163, v163, v239, s[64:65]
    v_cndmask_b32 v164, v164, v240, s[64:65]
    v_mfma_f32_16x16x32_bf16 v[250:253], v[24:27], v[214:217], 0
    v_cndmask_b32 v158, v158, v242, s[64:65]
    v_cndmask_b32 v159, v159, v243, s[64:65]
    v_mfma_f32_16x16x32_bf16 v[250:253], v[28:31], v[218:221], v[250:253]
    v_cndmask_b32 v160, v160, v244, s[64:65]
    v_cndmask_b32 v161, v161, v245, s[64:65]
    v_mfma_f32_16x16x32_bf16 v[250:253], v[32:35], v[222:225], v[250:253]
    v_rcp_f32 v165, v164
    v_mfma_f32_16x16x32_bf16 v[238:241], v[214:217], v[36:39], 0
    v_max3_f32 v171, v171, v164, v165
    v_mul_f32 v165, 0x3febdf1c, v165
    v_mfma_f32_16x16x32_bf16 v[238:241], v[218:221], v[40:43], v[238:241]
    v_mul_f32 v158, v158, v165
    v_mul_f32 v159, v159, v165
    v_mfma_f32_16x16x32_bf16 v[238:241], v[222:225], v[44:47], v[238:241]
    v_mul_f32 v160, v160, v165
    v_mul_f32 v161, v161, v165
    v_mfma_f32_16x16x32_bf16 v[242:245], v[214:217], v[48:51], v[166:169]
    s_setprio 2
    v_mul_f32 v162, v162, v165
    v_mul_f32 v163, v163, v165
    v_mfma_f32_16x16x32_bf16 v[242:245], v[218:221], v[52:55], v[242:245]
    ds_read_b128 v[214:217], v148 offset:12288
    ds_read_b128 v[218:221], v148 offset:13312
    v_mfma_f32_16x16x32_bf16 v[242:245], v[222:225], v[56:59], v[242:245]
    ds_read_b128 v[222:225], v148 offset:14336
    v_cvt_pk_bf16_f32 v158, v158, v159
    v_cvt_pk_bf16_f32 v159, v160, v161
    v_cvt_pk_bf16_f32 v162, v162, v163
    v_cvt_pk_bf16_f32 v110, v248, v249
    v_cvt_pk_bf16_f32 v126, v246, v247
    v_mfma_f32_16x16x32_bf16 v[246:249], v[12:15], v[226:229], 0
    ds_write_b64 v178, v[158:159] offset:27648
    v_mfma_f32_16x16x32_bf16 v[246:249], v[16:19], v[230:233], v[246:249]
    ds_write_b32 v196, v162 offset:27648
    v_mfma_f32_16x16x32_bf16 v[246:249], v[20:23], v[234:237], v[246:249]
    s_setprio 0
    v_cvt_pk_bf16_f32 v108, v250, v251
    v_cvt_pk_bf16_f32 v109, v252, v253
    v_mfma_f32_16x16x32_bf16 v[250:253], v[24:27], v[226:229], 0
    v_cvt_pk_bf16_f32 v60, v238, v239
    v_cvt_pk_bf16_f32 v61, v240, v241
    v_mfma_f32_16x16x32_bf16 v[250:253], v[28:31], v[230:233], v[250:253]
    v_cvt_pk_bf16_f32 v68, v242, v243
    v_cvt_pk_bf16_f32 v69, v244, v245
    v_mfma_f32_16x16x32_bf16 v[250:253], v[32:35], v[234:237], v[250:253]
    v_exp_f32 v207, v207
    v_mfma_f32_16x16x32_bf16 v[238:241], v[226:229], v[36:39], 0
    v_exp_f32 v208, v208
    v_mfma_f32_16x16x32_bf16 v[238:241], v[230:233], v[40:43], v[238:241]
    v_exp_f32 v209, v209
    v_mfma_f32_16x16x32_bf16 v[238:241], v[234:237], v[44:47], v[238:241]
    v_cvt_pk_bf16_f32 v204, v206, v207
    v_cvt_pk_bf16_f32 v205, v208, v209
    v_mfma_f32_16x16x32_bf16 v[242:245], v[226:229], v[48:51], v[166:169]
    s_setprio 2
    v_exp_f32 v198, v198
    v_mfma_f32_16x16x32_bf16 v[206:209], v[92:95], v[202:205], 0
    ds_read_b128 v[226:229], v148
    v_cvt_pk_bf16_f32 v114, v248, v249
    v_mfma_f32_16x16x32_bf16 v[242:245], v[230:233], v[52:55], v[242:245]
    v_exp_f32 v199, v199
    v_mfma_f32_16x16x32_bf16 v[242:245], v[234:237], v[56:59], v[242:245]
    ds_read_b128 v[230:233], v148 offset:1024
    ds_read_b128 v[234:237], v148 offset:2048
    v_exp_f32 v200, v200
    v_exp_f32 v201, v201
    v_cvt_pk_bf16_f32 v198, v198, v199
    v_cvt_pk_bf16_f32 v199, v200, v201
    v_exp_f32 v210, v210
    v_cvt_pk_bf16_f32 v130, v246, v247
    s_waitcnt lgkmcnt(3)
    v_mfma_f32_16x16x32_bf16 v[246:249], v[0:3], v[214:217], 0
    s_setprio 0
    v_cvt_pk_bf16_f32 v197, v210, 0
    v_cvt_pk_bf16_f32 v112, v250, v251
    v_mfma_f32_16x16x32_bf16 v[210:213], v[100:103], v[202:205], 0
    v_cvt_pk_bf16_f32 v113, v252, v253
    v_cvt_pk_bf16_f32 v62, v238, v239
    v_mfma_f32_16x16x32_bf16 v[210:213], v[104:107], v[196:199], v[210:213]
    v_cvt_pk_bf16_f32 v63, v240, v241
    v_cvt_pk_bf16_f32 v70, v242, v243
    v_mfma_f32_16x16x32_bf16 v[206:209], v[96:99], v[196:199], v[206:209]
    v_exp_f32 v184, v184
    v_mfma_f32_16x16x32_bf16 v[246:249], v[4:7], v[218:221], v[246:249]
    v_rcp_f32 v213, v212
    v_mfma_f32_16x16x32_bf16 v[246:249], v[8:11], v[222:225], v[246:249]
    v_max3_f32 v171, v171, v212, v213
    v_mul_f32 v213, 0x3febdf1c, v213
    v_mfma_f32_16x16x32_bf16 v[250:253], v[12:15], v[214:217], 0
    v_mul_f32 v206, v206, v213
    v_mul_f32 v207, v207, v213
    v_mfma_f32_16x16x32_bf16 v[250:253], v[16:19], v[218:221], v[250:253]
    v_mul_f32 v208, v208, v213
    v_mul_f32 v209, v209, v213
    v_mfma_f32_16x16x32_bf16 v[250:253], v[20:23], v[222:225], v[250:253]
    v_mul_f32 v210, v210, v213
    v_mul_f32 v211, v211, v213
    v_mfma_f32_16x16x32_bf16 v[238:241], v[24:27], v[214:217], 0
    s_setprio 2
    v_cvt_pk_bf16_f32 v206, v206, v207
    v_cvt_pk_bf16_f32 v207, v208, v209
    v_mfma_f32_16x16x32_bf16 v[238:241], v[28:31], v[218:221], v[238:241]
    ds_write_b64 v178, v[206:207] offset:21504
    v_mfma_f32_16x16x32_bf16 v[238:241], v[32:35], v[222:225], v[238:241]
    v_cvt_pk_bf16_f32 v210, v210, v211
    v_cvt_pk_bf16_f32 v71, v244, v245
    v_mfma_f32_16x16x32_bf16 v[242:245], v[214:217], v[36:39], 0
    ds_write_b32 v196, v210 offset:21504
    v_mfma_f32_16x16x32_bf16 v[242:245], v[218:221], v[40:43], v[242:245]
    s_setprio 0
    v_exp_f32 v185, v185
    v_mfma_f32_16x16x32_bf16 v[242:245], v[222:225], v[44:47], v[242:245]
    v_exp_f32 v186, v186
    v_exp_f32 v187, v187
    v_cvt_pk_bf16_f32 v184, v184, v185
    v_cvt_pk_bf16_f32 v185, v186, v187
    v_exp_f32 v188, v188
    v_exp_f32 v189, v189
    v_exp_f32 v190, v190
    v_exp_f32 v191, v191
    v_cvt_pk_bf16_f32 v186, v188, v189
    v_cvt_pk_bf16_f32 v187, v190, v191
    v_exp_f32 v180, v180
    s_nop 0
    v_mfma_f32_16x16x32_bf16 v[188:191], v[92:95], v[184:187], 0
    v_exp_f32 v181, v181
    v_exp_f32 v182, v182
    v_exp_f32 v183, v183
    v_cvt_pk_bf16_f32 v180, v180, v181
    v_cvt_pk_bf16_f32 v181, v182, v183
    v_exp_f32 v192, v192
    v_cvt_pk_bf16_f32 v132, v246, v247
    v_cvt_pk_bf16_f32 v179, v192, 0
    v_mfma_f32_16x16x32_bf16 v[192:195], v[100:103], v[184:187], 0
    v_cvt_pk_bf16_f32 v133, v248, v249
    v_cvt_pk_bf16_f32 v118, v252, v253
    v_mfma_f32_16x16x32_bf16 v[192:195], v[104:107], v[178:181], v[192:195]
    v_cvt_pk_bf16_f32 v134, v250, v251
    v_cvt_pk_bf16_f32 v116, v238, v239
    v_mfma_f32_16x16x32_bf16 v[188:191], v[96:99], v[178:181], v[188:191]
    v_cvt_pk_bf16_f32 v117, v240, v241
    v_cvt_pk_bf16_f32 v66, v242, v243
    v_mfma_f32_16x16x32_bf16 v[246:249], v[214:217], v[48:51], v[166:169]
    v_rcp_f32 v195, v194
    v_mfma_f32_16x16x32_bf16 v[246:249], v[218:221], v[52:55], v[246:249]
    v_max3_f32 v171, v171, v194, v195
    v_mul_f32 v195, 0x3febdf1c, v195
    v_mfma_f32_16x16x32_bf16 v[246:249], v[222:225], v[56:59], v[246:249]
    s_waitcnt lgkmcnt(0)
    v_mul_f32 v188, v188, v195
    v_mul_f32 v189, v189, v195
    v_mfma_f32_16x16x32_bf16 v[250:253], v[0:3], v[226:229], 0
    v_mul_f32 v190, v190, v195
    v_mul_f32 v191, v191, v195
    v_mfma_f32_16x16x32_bf16 v[250:253], v[4:7], v[230:233], v[250:253]
    v_mul_f32 v192, v192, v195
    v_mul_f32 v193, v193, v195
    v_mfma_f32_16x16x32_bf16 v[250:253], v[8:11], v[234:237], v[250:253]
    s_setprio 2
    v_cvt_pk_bf16_f32 v188, v188, v189
    v_cvt_pk_bf16_f32 v189, v190, v191
    v_mfma_f32_16x16x32_bf16 v[238:241], v[12:15], v[226:229], 0
    ds_write_b64 v178, v[188:189] offset:24576
    v_mfma_f32_16x16x32_bf16 v[238:241], v[16:19], v[230:233], v[238:241]
    v_cvt_pk_bf16_f32 v192, v192, v193
    v_cvt_pk_bf16_f32 v67, v244, v245
    v_mfma_f32_16x16x32_bf16 v[238:241], v[20:23], v[234:237], v[238:241]
    ds_write_b32 v196, v192 offset:24576
    v_mfma_f32_16x16x32_bf16 v[242:245], v[24:27], v[226:229], 0
    ds_add_u32 v127, v131 offset:20
    v_mfma_f32_16x16x32_bf16 v[242:245], v[28:31], v[230:233], v[242:245]
    s_setprio 0
    v_cvt_pk_bf16_f32 v74, v246, v247
    v_cvt_pk_bf16_f32 v75, v248, v249
    v_mfma_f32_16x16x32_bf16 v[242:245], v[32:35], v[234:237], v[242:245]
    v_cvt_pk_bf16_f32 v250, v250, v251
    v_cndmask_b32 v136, 0, v250, s[60:61]
    v_mfma_f32_16x16x32_bf16 v[246:249], v[226:229], v[36:39], 0
    v_cndmask_b32 v140, 0, v250, s[62:63]
    v_cndmask_b32 v144, 0, v250, s[64:65]
    v_mfma_f32_16x16x32_bf16 v[246:249], v[230:233], v[40:43], v[246:249]
    v_cvt_pk_bf16_f32 v252, v252, v253
    v_cndmask_b32 v137, 0, v252, s[60:61]
    v_mfma_f32_16x16x32_bf16 v[246:249], v[234:237], v[44:47], v[246:249]
    v_cndmask_b32 v141, 0, v252, s[62:63]
    v_cndmask_b32 v145, 0, v252, s[64:65]
    v_mfma_f32_16x16x32_bf16 v[250:253], v[226:229], v[48:51], v[166:169]
    v_cvt_pk_bf16_f32 v122, v240, v241
    v_cvt_pk_bf16_f32 v238, v238, v239
    v_mfma_f32_16x16x32_bf16 v[250:253], v[230:233], v[52:55], v[250:253]
    v_cndmask_b32 v138, 0, v238, s[60:61]
    v_cndmask_b32 v142, 0, v238, s[62:63]
    v_mfma_f32_16x16x32_bf16 v[250:253], v[234:237], v[56:59], v[250:253]
    v_cndmask_b32 v146, 0, v238, s[64:65]
    v_cvt_pk_bf16_f32 v120, v242, v243
    v_cvt_pk_bf16_f32 v121, v244, v245
    v_cvt_pk_bf16_f32 v65, v246, v247
    v_cvt_pk_bf16_f32 v81, v246, v247
    s_nop 1
    v_cvt_pk_bf16_f32 v73, v250, v251
    v_cvt_pk_bf16_f32 v89, v250, v251
    s_nop 0
    s_branch L_Afloop
L_Aflast:
    v_mfma_f32_16x16x32_bf16 v[184:187], v[108:111], v[124:127], 0
    v_mfma_f32_16x16x32_bf16 v[188:191], v[112:115], v[124:127], 0
    v_mfma_f32_16x16x32_bf16 v[180:183], v[116:119], v[124:127], 0
    v_exp_f32 v184, v184
    v_mfma_f32_16x16x32_bf16 v[192:195], v[120:123], v[124:127], v[174:177]
    v_exp_f32 v185, v185
    v_mfma_f32_16x16x32_bf16 v[154:157], v[108:111], v[144:147], v[154:157]
    v_exp_f32 v186, v186
    v_mfma_f32_16x16x32_bf16 v[158:161], v[112:115], v[144:147], v[158:161]
    v_exp_f32 v187, v187
    v_mfma_f32_16x16x32_bf16 v[150:153], v[116:119], v[144:147], v[150:153]
    v_cvt_pk_bf16_f32 v184, v184, v185
    v_cvt_pk_bf16_f32 v185, v186, v187
    v_mfma_f32_16x16x32_bf16 v[162:165], v[120:123], v[144:147], v[162:165]
    v_exp_f32 v188, v188
    v_mfma_f32_16x16x32_bf16 v[202:205], v[108:111], v[128:131], 0
    v_exp_f32 v189, v189
    v_mfma_f32_16x16x32_bf16 v[206:209], v[112:115], v[128:131], 0
    v_exp_f32 v190, v190
    v_mfma_f32_16x16x32_bf16 v[198:201], v[116:119], v[128:131], 0
    v_exp_f32 v191, v191
    v_mfma_f32_16x16x32_bf16 v[210:213], v[120:123], v[128:131], v[174:177]
    v_cvt_pk_bf16_f32 v186, v188, v189
    v_cvt_pk_bf16_f32 v187, v190, v191
    v_exp_f32 v180, v180
    s_nop 0
    v_mfma_f32_16x16x32_bf16 v[188:191], v[92:95], v[184:187], 0
    v_exp_f32 v181, v181
    v_exp_f32 v182, v182
    v_exp_f32 v183, v183
    v_cvt_pk_bf16_f32 v180, v180, v181
    v_cvt_pk_bf16_f32 v181, v182, v183
    v_exp_f32 v192, v192
    v_exp_f32 v154, v154
    v_cvt_pk_bf16_f32 v179, v192, 0
    v_mfma_f32_16x16x32_bf16 v[192:195], v[100:103], v[184:187], 0
    v_exp_f32 v155, v155
    v_mfma_f32_16x16x32_bf16 v[192:195], v[104:107], v[178:181], v[192:195]
    v_exp_f32 v156, v156
    v_mfma_f32_16x16x32_bf16 v[188:191], v[96:99], v[178:181], v[188:191]
    v_exp_f32 v157, v157
    v_mfma_f32_16x16x32_bf16 v[184:187], v[108:111], v[132:135], 0
    v_rcp_f32 v195, v194
    v_mfma_f32_16x16x32_bf16 v[180:183], v[116:119], v[132:135], 0
    s_setprio 2
    v_max3_f32 v171, v171, v194, v195
    v_mul_f32 v195, 0x3febdf1c, v195
    v_mul_f32 v188, v188, v195
    v_mul_f32 v189, v189, v195
    v_mul_f32 v190, v190, v195
    v_mul_f32 v191, v191, v195
    v_mul_f32 v192, v192, v195
    v_mul_f32 v193, v193, v195
    v_cvt_pk_bf16_f32 v188, v188, v189
    v_cvt_pk_bf16_f32 v189, v190, v191
    v_cvt_pk_bf16_f32 v192, v192, v193
    v_cvt_pk_bf16_f32 v154, v154, v155
    v_cvt_pk_bf16_f32 v155, v156, v157
    v_exp_f32 v158, v158
    v_exp_f32 v159, v159
    v_exp_f32 v160, v160
    v_exp_f32 v161, v161
    v_cvt_pk_bf16_f32 v156, v158, v159
    v_cvt_pk_bf16_f32 v157, v160, v161
    v_exp_f32 v150, v150
    s_nop 0
    v_mfma_f32_16x16x32_bf16 v[158:161], v[60:63], v[154:157], 0
    ds_write_b64 v178, v[188:189] offset:18432
    v_mfma_f32_16x16x32_bf16 v[188:191], v[112:115], v[132:135], 0
    ds_write_b32 v196, v192 offset:18432
    v_mfma_f32_16x16x32_bf16 v[192:195], v[120:123], v[132:135], v[174:177]
    s_setprio 0
    v_exp_f32 v151, v151
    v_mfma_f32_16x16x32_bf16 v[238:241], v[84:87], v[154:157], 0
    v_exp_f32 v152, v152
    v_mfma_f32_16x16x32_bf16 v[242:245], v[76:79], v[154:157], 0
    v_exp_f32 v153, v153
    v_mfma_f32_16x16x32_bf16 v[246:249], v[100:103], v[154:157], 0
    v_cvt_pk_bf16_f32 v150, v150, v151
    v_cvt_pk_bf16_f32 v151, v152, v153
    v_mfma_f32_16x16x32_bf16 v[250:253], v[92:95], v[154:157], 0
    v_exp_f32 v162, v162
    v_exp_f32 v202, v202
    v_cvt_pk_bf16_f32 v149, v162, 0
    v_mfma_f32_16x16x32_bf16 v[162:165], v[68:71], v[154:157], 0
    v_exp_f32 v203, v203
    v_mfma_f32_16x16x32_bf16 v[162:165], v[72:75], v[148:151], v[162:165]
    v_exp_f32 v204, v204
    v_mfma_f32_16x16x32_bf16 v[158:161], v[64:67], v[148:151], v[158:161]
    v_exp_f32 v205, v205
    v_mfma_f32_16x16x32_bf16 v[238:241], v[88:91], v[148:151], v[238:241]
    v_cvt_pk_bf16_f32 v202, v202, v203
    v_cvt_pk_bf16_f32 v203, v204, v205
    v_mfma_f32_16x16x32_bf16 v[242:245], v[80:83], v[148:151], v[242:245]
    v_exp_f32 v206, v206
    v_mfma_f32_16x16x32_bf16 v[246:249], v[104:107], v[148:151], v[246:249]
    v_cndmask_b32 v162, v162, v238, s[62:63]
    v_cndmask_b32 v163, v163, v239, s[62:63]
    v_mfma_f32_16x16x32_bf16 v[250:253], v[96:99], v[148:151], v[250:253]
    s_setprio 2
    v_cndmask_b32 v164, v164, v240, s[62:63]
    v_cndmask_b32 v158, v158, v242, s[62:63]
    v_cndmask_b32 v159, v159, v243, s[62:63]
    v_cndmask_b32 v160, v160, v244, s[62:63]
    v_cndmask_b32 v161, v161, v245, s[62:63]
    v_cndmask_b32 v162, v162, v246, s[64:65]
    v_cndmask_b32 v163, v163, v247, s[64:65]
    v_cndmask_b32 v164, v164, v248, s[64:65]
    v_cndmask_b32 v158, v158, v250, s[64:65]
    v_cndmask_b32 v159, v159, v251, s[64:65]
    v_cndmask_b32 v160, v160, v252, s[64:65]
    v_cndmask_b32 v161, v161, v253, s[64:65]
    v_rcp_f32 v165, v164
    v_exp_f32 v207, v207
    v_max3_f32 v171, v171, v164, v165
    v_mul_f32 v165, 0x3febdf1c, v165
    v_mul_f32 v158, v158, v165
    v_mul_f32 v159, v159, v165
    v_mul_f32 v160, v160, v165
    v_mul_f32 v161, v161, v165
    v_mul_f32 v162, v162, v165
    v_mul_f32 v163, v163, v165
    v_cvt_pk_bf16_f32 v158, v158, v159
    v_cvt_pk_bf16_f32 v159, v160, v161
    v_cvt_pk_bf16_f32 v162, v162, v163
    v_exp_f32 v208, v208
    v_exp_f32 v209, v209
    v_cvt_pk_bf16_f32 v204, v206, v207
    v_cvt_pk_bf16_f32 v205, v208, v209
    v_exp_f32 v198, v198
    s_nop 0
    v_mfma_f32_16x16x32_bf16 v[206:209], v[92:95], v[202:205], 0
    ds_write_b64 v178, v[158:159] offset:27648
    ds_write_b32 v196, v162 offset:27648
    v_exp_f32 v199, v199
    v_exp_f32 v200, v200
    v_exp_f32 v201, v201
    v_cvt_pk_bf16_f32 v198, v198, v199
    v_cvt_pk_bf16_f32 v199, v200, v201
    v_exp_f32 v210, v210
    v_exp_f32 v184, v184
    v_cvt_pk_bf16_f32 v197, v210, 0
    v_mfma_f32_16x16x32_bf16 v[210:213], v[100:103], v[202:205], 0
    s_setprio 0
    v_exp_f32 v185, v185
    v_mfma_f32_16x16x32_bf16 v[210:213], v[104:107], v[196:199], v[210:213]
    v_exp_f32 v186, v186
    v_mfma_f32_16x16x32_bf16 v[206:209], v[96:99], v[196:199], v[206:209]
    s_setprio 2
    v_exp_f32 v187, v187
    v_cvt_pk_bf16_f32 v184, v184, v185
    v_rcp_f32 v213, v212
    v_cvt_pk_bf16_f32 v185, v186, v187
    v_max3_f32 v171, v171, v212, v213
    v_mul_f32 v213, 0x3febdf1c, v213
    v_mul_f32 v206, v206, v213
    v_mul_f32 v207, v207, v213
    v_mul_f32 v208, v208, v213
    v_mul_f32 v209, v209, v213
    v_mul_f32 v210, v210, v213
    v_mul_f32 v211, v211, v213
    v_cvt_pk_bf16_f32 v206, v206, v207
    v_cvt_pk_bf16_f32 v207, v208, v209
    v_cvt_pk_bf16_f32 v210, v210, v211
    v_exp_f32 v188, v188
    v_exp_f32 v189, v189
    v_exp_f32 v190, v190
    v_exp_f32 v191, v191
    v_cvt_pk_bf16_f32 v186, v188, v189
    v_cvt_pk_bf16_f32 v187, v190, v191
    v_exp_f32 v180, v180
    s_nop 0
    v_mfma_f32_16x16x32_bf16 v[188:191], v[92:95], v[184:187], 0
    ds_write_b64 v178, v[206:207] offset:21504
    ds_write_b32 v196, v210 offset:21504
    v_exp_f32 v181, v181
    v_exp_f32 v182, v182
    v_exp_f32 v183, v183
    v_cvt_pk_bf16_f32 v180, v180, v181
    v_cvt_pk_bf16_f32 v181, v182, v183
    v_exp_f32 v192, v192
    s_nop 0
    v_cvt_pk_bf16_f32 v179, v192, 0
    v_mfma_f32_16x16x32_bf16 v[192:195], v[100:103], v[184:187], 0
    s_setprio 0
    v_mfma_f32_16x16x32_bf16 v[192:195], v[104:107], v[178:181], v[192:195]
    s_setprio 2
    v_mfma_f32_16x16x32_bf16 v[188:191], v[96:99], v[178:181], v[188:191]
    s_nop 3
    v_rcp_f32 v195, v194
    s_nop 0
    v_max3_f32 v171, v171, v194, v195
    v_mul_f32 v195, 0x3febdf1c, v195
    v_mul_f32 v188, v188, v195
    v_mul_f32 v189, v189, v195
    v_mul_f32 v190, v190, v195
    v_mul_f32 v191, v191, v195
    v_mul_f32 v192, v192, v195
    v_mul_f32 v193, v193, v195
    v_cvt_pk_bf16_f32 v188, v188, v189
    v_cvt_pk_bf16_f32 v189, v190, v191
    v_cvt_pk_bf16_f32 v192, v192, v193
    ds_write_b64 v178, v[188:189] offset:24576
    ds_write_b32 v196, v192 offset:24576
    ds_add_u32 v127, v131 offset:20
    s_setprio 0
    v_mov_b32 v209, 0
    v_and_b32 v210, 0x7fff7fff, v36
    v_pk_max_u16 v209, v209, v210
    v_and_b32 v210, 0x7fff7fff, v37
    v_pk_max_u16 v209, v209, v210
    v_and_b32 v210, 0x7fff7fff, v38
    v_pk_max_u16 v209, v209, v210
    v_and_b32 v210, 0x7fff7fff, v39
    v_pk_max_u16 v209, v209, v210
    v_and_b32 v210, 0x7fff7fff, v40
    v_pk_max_u16 v209, v209, v210
    v_and_b32 v210, 0x7fff7fff, v41
    v_pk_max_u16 v209, v209, v210
    v_and_b32 v210, 0x7fff7fff, v42
    v_pk_max_u16 v209, v209, v210
    v_and_b32 v210, 0x7fff7fff, v43
    v_pk_max_u16 v209, v209, v210
    v_and_b32 v210, 0x7fff7fff, v44
    v_pk_max_u16 v209, v209, v210
    v_and_b32 v210, 0x7fff7fff, v45
    v_pk_max_u16 v209, v209, v210
    v_and_b32 v210, 0x7fff7fff, v46
    v_pk_max_u16 v209, v209, v210
    v_and_b32 v210, 0x7fff7fff, v47
    v_pk_max_u16 v209, v209, v210
    v_lshrrev_b32 v210, 16, v209
    v_and_b32 v209, 0xffff, v209
    v_max_u32 v209, v209, v210
    v_cmp_lt_u32 vcc, 0x5880, v209
    s_nop 1
    s_cmp_lg_u64 vcc, 0
    s_cselect_b32 s51, 0xbf800000, s51
    v_subrev_u32 v209, 1, v209
    v_cmp_gt_u32 vcc, 0x3080, v209
    s_nop 1
    s_cmp_lg_u64 vcc, 0
    s_cselect_b32 s51, 0xbf800000, s51
    v_mov_b32 v209, 0
    v_and_b32 v210, 0x7fff7fff, v48
    v_pk_max_u16 v209, v209, v210
    v_and_b32 v210, 0x7fff7fff, v49
    v_pk_max_u16 v209, v209, v210
    v_and_b32 v210, 0x7fff7fff, v50
    v_pk_max_u16 v209, v209, v210
    v_and_b32 v210, 0x7fff7fff, v51
    v_pk_max_u16 v209, v209, v210
    v_and_b32 v210, 0x7fff7fff, v52
    v_pk_max_u16 v209, v209, v210
    v_and_b32 v210, 0x7fff7fff, v53
    v_pk_max_u16 v209, v209, v210
    v_and_b32 v210, 0x7fff7fff, v54
    v_pk_max_u16 v209, v209, v210
    v_and_b32 v210, 0x7fff7fff, v55
    v_pk_max_u16 v209, v209, v210
    v_and_b32 v210, 0x7fff7fff, v56
    v_pk_max_u16 v209, v209, v210
    v_and_b32 v210, 0x7fff7fff, v57
    v_pk_max_u16 v209, v209, v210
    v_and_b32 v210, 0x7fff7fff, v58
    v_pk_max_u16 v209, v209, v210
    v_and_b32 v210, 0x7fff7fff, v59
    v_pk_max_u16 v209, v209, v210
    v_lshrrev_b32 v210, 16, v209
    v_and_b32 v209, 0xffff, v209
    v_max_u32 v209, v209, v210
    v_cmp_lt_u32 vcc, 0x5880, v209
    s_nop 1
    s_cmp_lg_u64 vcc, 0
    s_cselect_b32 s51, 0xbf800000, s51
    v_subrev_u32 v209, 1, v209
    v_cmp_gt_u32 vcc, 0x3080, v209
    s_nop 1
    s_cmp_lg_u64 vcc, 0
    s_cselect_b32 s51, 0xbf800000, s51
    v_cmp_nge_f32 vcc, s51, v171
    v_mov_b32 v238, 0xe480
    v_mov_b32 v239, 1
    s_nop 2
    s_cbranch_vccz L_Anoflag
    ds_write_b32 v238, v239
    s_waitcnt lgkmcnt(0)
L_Anoflag:
    s_waitcnt lgkmcnt(0)
    s_barrier
    ds_read_b32 v239, v238
    s_waitcnt lgkmcnt(0)
    v_cmp_ne_u32 vcc, 0, v239
    s_nop 4
    s_cbranch_vccnz L_Asafe
    s_endpgm
L_sw1:
    s_sleep 2
    ds_read_b32 v255, v127 offset:16
    s_waitcnt lgkmcnt(0)
    v_readfirstlane_b32 s91, v255
    s_nop 1
    s_cmp_lt_u32 s91, s92
    s_nop 0
    s_cbranch_scc1 L_sw1
    s_branch L_sb1
L_sw2:
    s_sleep 2
    ds_read_b32 v255, v127 offset:16
    s_waitcnt lgkmcnt(0)
    v_readfirstlane_b32 s91, v255
    s_nop 1
    s_cmp_lt_u32 s91, s92
    s_nop 0
    s_cbranch_scc1 L_sw2
    s_branch L_sb2
L_sw3:
    s_sleep 2
    ds_read_b32 v255, v127 offset:16
    s_waitcnt lgkmcnt(0)
    v_readfirstlane_b32 s91, v255
    s_nop 1
    s_cmp_lt_u32 s91, s92
    s_nop 0
    s_cbranch_scc1 L_sw3
    s_branch L_sb3
L_T:
    s_cmp_eq_u32 s30, 7
    s_cbranch_scc1 L_T3
    s_setprio 1
    s_sub_u32 s54, s30, 4
    s_mul_i32 s40, s31, 0x382
    s_lshr_b32 s40, s40, 16
    s_mul_i32 s41, s40, 0x49
    s_sub_u32 s41, s31, s41
    s_mul_i32 s33, s40, 21
    s_mul_i32 s42, s41, 21
    s_cmp_eq_u32 s40, 3
    s_cselect_b32 s32, 0, s41
    s_cselect_b32 s34, s42, 0
    s_cselect_b32 s35, 0x199a, 0
    v_subrev_u32 v233, 8, v255
    v_and_b32 v230, 31, v233
    v_lshlrev_b32 v230, 8, v230
    v_add_u32 v230, s31, v230
    v_mul_u32_u24 v231, 0xe071, v230
    v_lshrrev_b32 v231, 22, v231
    v_mul_u32_u24 v232, 0x49, v231
    v_sub_u32 v230, v230, v232
    v_mul_u32_u24 v232, 0xa7ac0, v231
    v_mul_u32_u24 v236, 0x540, v230
    v_add3_u32 v224, v232, v236, 4
    v_cmp_eq_u32 s[60:61], 0, v231
    v_cmp_eq_u32 s[64:65], 0, v230
    s_movk_i32 s40, 0x48
    v_cmp_eq_u32 s[62:63], s40, v231
    v_cmp_eq_u32 s[66:67], s40, v230
    v_cmp_gt_u32 s[68:69], 21, v233
    v_cmp_ge_u32 s[70:71], s40, v231
    v_cndmask_b32 v232, 0, 1, s[60:61]
    v_cndmask_b32 v236, 0, 2, s[62:63]
    v_or3_b32 v224, v224, v232, v236
    v_cndmask_b32 v232, 0, 8, s[64:65]
    v_cndmask_b32 v236, 0, 16, s[66:67]
    v_or3_b32 v224, v224, v232, v236
    s_and_b64 s[68:69], s[68:69], s[70:71]
    v_mov_b32 v232, 0x40000004
    v_cndmask_b32 v224, v232, v224, s[68:69]
    v_add_u32 v233, 0, v255
    v_mul_u32_u24 v236, 0x13b2, v233
    v_lshrrev_b32 v236, 16, v236
    v_sub_u32 v230, v233, v236
    v_lshlrev_b32 v230, 4, v230
    s_mov_b32 s84, 0x2001000
    s_mov_b32 s85, 0x80040
    v_or_b32 v231, 0x80000000, v230
    v_cndmask_b32 v211, v230, v231, s[84:85]
    v_add_u32 v233, 64, v255
    v_mul_u32_u24 v236, 0x13b2, v233
    v_lshrrev_b32 v236, 16, v236
    v_sub_u32 v230, v233, v236
    v_lshlrev_b32 v230, 4, v230
    s_mov_b32 s84, 0x4002001
    s_mov_b32 s85, 0x100080
    v_or_b32 v231, 0x80000000, v230
    v_cndmask_b32 v212, v230, v231, s[84:85]
    s_mov_b32 s76, 0x1fff
    s_mov_b32 s77, 0
    s_mov_b32 s78, 0
    s_mov_b32 s79, 0xffffff00
    s_mov_b32 s80, 0xffffffff
    s_mov_b32 s81, 0x1fffff
    s_mov_b32 s82, 0xffffffff
    s_mov_b32 s83, 0x7f
    s_mul_i32 s59, s54, 0x2fe80
    s_mul_i32 s53, s54, 0xea0
    s_mul_i32 s55, s54, 0x840
    s_mov_b32 s48, 4
    v_mov_b32 v209, v211
    v_mov_b32 v210, v212
    s_cmp_eq_u32 s54, 0
    s_cselect_b32 s39, 1, 0
    v_lshlrev_b32 v234, 4, v255
    s_waitcnt lgkmcnt(0)
    s_sub_u32 s4, s16, 0x18000
    s_subb_u32 s5, s17, 0
    s_mov_b32 s6, 0x2fe80c0
    s_mov_b32 s7, 0x20000
    s_mov_b32 s12, s18
    s_mov_b32 s13, s19
    s_mov_b32 s14, 0x6c0
    s_lshl_b32 s45, s54, 11
    s_add_u32 s45, s45, 0x8800
    s_mov_b32 m0, s45
    s_nop 0
    buffer_load_dwordx4 v234, s[12:15], 0 offen lds
    buffer_load_dwordx4 v234, s[12:15], 0 offen offset:1024 lds
    s_mov_b32 s38, -4
    s_add_u32 s56, s38, 12
    v_readlane_b32 s46, v224, s56
    s_nop 1
    s_and_b32 s47, s46, 63
    s_cmp_lt_u32 s46, 0x40000000
    s_cselect_b32 s94, 0x2fe80c0, 0
    s_and_b32 s46, s46, 0x3fffffc0
    s_add_u32 s46, s46, s59
    s_cmp_eq_u32 s47, s48
    s_cbranch_scc1 L_cls1
    s_mov_b32 s48, s47
    s_and_b32 s40, s47, 8
    s_cselect_b64 s[84:85], s[76:77], 0
    v_or_b32 v227, 0x80000000, v211
    v_cndmask_b32 v209, v211, v227, s[84:85]
    s_and_b32 s40, s47, 16
    s_cselect_b64 s[84:85], s[78:79], 0
    v_or_b32 v227, 0x80000000, v212
    v_cndmask_b32 v210, v212, v227, s[84:85]
    s_nop 1
L_cls1:
    s_and_b32 s40, s47, s39
    s_cselect_b32 s6, 0, s94
    s_add_u32 m0, s53, 0
    s_add_u32 s41, s46, 0
    buffer_load_dwordx4 v209, s[4:7], s41 offen nt lds
    s_add_u32 m0, s53, 0x400
    s_mov_b64 exec, s[80:81]
    buffer_load_dwordx4 v210, s[4:7], s41 offen nt lds
    s_mov_b64 exec, -1
    s_mov_b32 s6, s94
    s_add_u32 m0, s53, 0x750
    s_add_u32 s41, s46, 0x17f40
    buffer_load_dwordx4 v209, s[4:7], s41 offen nt lds
    s_add_u32 m0, s53, 0xb50
    s_mov_b64 exec, s[80:81]
    buffer_load_dwordx4 v210, s[4:7], s41 offen nt lds
    s_mov_b64 exec, -1
    s_add_u32 s57, s38, s54
    s_add_u32 s57, s57, 12
    v_readlane_b32 s52, v224, s57
    s_nop 1
    s_cmp_lt_u32 s52, 0x40000000
    s_cselect_b32 s44, 0x2fe80c0, 0
    s_and_b32 s52, s52, 0x3fffffc0
    s_mov_b32 s6, s44
    s_mov_b64 exec, s[82:83]
    s_add_u32 m0, s55, 0xcc00
    s_add_u32 s41, s52, 0x30180
    buffer_load_dwordx4 v211, s[4:7], s41 offen nt lds
    s_add_u32 m0, s55, 0xce70
    s_add_u32 s41, s52, 0x480c0
    buffer_load_dwordx4 v211, s[4:7], s41 offen nt lds
    s_add_u32 m0, s55, 0xd0e0
    s_add_u32 s41, s52, 0x60000
    buffer_load_dwordx4 v211, s[4:7], s41 offen nt lds
    s_mov_b64 exec, -1
    s_waitcnt lgkmcnt(0)
    s_barrier
    s_mov_b32 s8, s24
    s_mov_b32 s9, s25
    s_mov_b32 s10, 0x2fd00c0
    s_mov_b32 s11, 0x20000
    v_lshrrev_b32 v228, 4, v255
    v_and_b32 v229, 15, v255
    v_lshlrev_b32 v235, 2, v229
    v_lshrrev_b32 v230, 3, v229
    v_lshlrev_b32 v230, 3, v230
    v_add_u32 v230, v230, v229
    v_lshlrev_b32 v230, 1, v230
    v_add_u32 v230, s45, v230
    v_lshlrev_b32 v232, 2, v228
    v_add_u32 v240, 0x3c0, v230
    s_mov_b32 s40, 0x4310
    v_bfe_u32 v231, s40, v232, 4
    v_mul_u32_u24 v231, 0xc0, v231
    v_add_u32 v241, v230, v231
    s_mov_b32 s40, 0x8276
    v_bfe_u32 v231, s40, v232, 4
    v_mul_u32_u24 v231, 0xc0, v231
    v_add_u32 v242, v230, v231
    v_and_b32 v230, 3, v229
    v_mul_u32_u24 v72, 0x5555, v230
    v_lshrrev_b32 v230, 2, v229
    v_lshlrev_b32 v226, 2, v230
    v_lshl_add_u32 v230, v230, 4, v229
    v_lshlrev_b32 v75, 2, v230
    v_mov_b32 v204, 0x380e6d33
    v_mov_b32 v156, 0x3f803f80
    v_mov_b32 v157, 0x3f803f80
    v_mov_b32 v158, 0x3f803f80
    v_mov_b32 v159, 0x3f803f80
    v_add_u32 v207, 0x1e0c0, v234
    s_mov_b64 s[88:89], 1
    v_mov_b32 v230, 0xf00000
    v_mov_b32 v214, 0xe480
    v_cndmask_b32 v214, v230, v214, s[88:89]
    v_and_b32 v230, 1, v228
    v_lshlrev_b32 v230, 5, v230
    v_lshrrev_b32 v231, 1, v228
    s_mov_b32 s84, 0x10000000
    s_cmp_eq_u32 s54, 1
    s_cselect_b32 s84, 0x33223322, s84
    s_cmp_eq_u32 s54, 2
    s_cselect_b32 s84, 0x55545554, s84
    s_mov_b32 s85, 0x21112111
    s_cmp_eq_u32 s54, 1
    s_cselect_b32 s85, 0x44434433, s85
    s_cmp_eq_u32 s54, 2
    s_cselect_b32 s85, 0x66666665, s85
    s_mov_b32 s86, 0x5316420
    s_cmp_eq_u32 s54, 1
    s_cselect_b32 s86, 0x20313120, s86
    s_cmp_eq_u32 s54, 2
    s_cselect_b32 s86, 0x42015310, s86
    s_mov_b32 s87, 0x65315642
    s_cmp_eq_u32 s54, 1
    s_cselect_b32 s87, 0x64255364, s87
    s_cmp_eq_u32 s54, 2
    s_cselect_b32 s87, 0x64205316, s87
    v_lshrrev_b64 v[250:251], v235, s[84:85]
    v_and_b32 v237, 7, v250
    v_lshrrev_b64 v[250:251], v235, s[86:87]
    v_and_b32 v238, 7, v250
    v_mul_u32_u24 v232, 9, v237
    v_add_u32 v232, v232, v238
    v_mul_u32_u24 v232, 0xd0, v232
    v_add_u32 v230, v230, v232
    v_mul_u32_u24 v232, 0xd0, v231
    v_add_u32 v73, v230, v232
    v_mul_u32_u24 v232, 0xea0, v231
    v_add_u32 v74, v230, v232
    s_mul_i32 s40, s54, 0xc00
    s_add_u32 s40, s40, 0xe4c0
    v_add_u32 v205, s40, v234
    s_mul_i32 s40, s54, 0x400
    s_add_u32 s40, s40, 0xe4c0
    v_add_u32 v206, s40, v234
    v_add_u32 v208, 0xc00, v206
    s_mov_b32 s50, 0xe400
    v_lshlrev_b32 v233, 4, v228
    s_lshl_b32 s40, s54, 6
    v_add_u32 v233, s40, v233
    s_mov_b32 s84, 0x10000000
    s_mov_b32 s85, 0x21112111
    s_mov_b32 s86, 0x5316420
    s_mov_b32 s87, 0x65315642
    v_lshrrev_b64 v[250:251], v235, s[84:85]
    v_and_b32 v237, 7, v250
    v_lshrrev_b64 v[250:251], v235, s[86:87]
    v_and_b32 v238, 7, v250
    v_mul_u32_u24 v230, 0x17f40, v237
    v_mul_u32_u24 v231, 0xc0, v238
    v_add3_u32 v217, v230, v231, v233
    s_mov_b32 s84, 0x33223322
    s_mov_b32 s85, 0x44434433
    s_mov_b32 s86, 0x20313120
    s_mov_b32 s87, 0x64255364
    v_lshrrev_b64 v[250:251], v235, s[84:85]
    v_and_b32 v237, 7, v250
    v_lshrrev_b64 v[250:251], v235, s[86:87]
    v_and_b32 v238, 7, v250
    v_mul_u32_u24 v230, 0x17f40, v237
    v_mul_u32_u24 v231, 0xc0, v238
    v_add3_u32 v218, v230, v231, v233
    v_add_u32 v230, 0x30180, v233
    v_or_b32 v231, 0x40000000, v230
    s_mov_b32 s84, 0x1110111
    s_mov_b32 s85, s84
    v_cndmask_b32 v219, v231, v230, s[84:85]
    v_and_b32 v230, 1, v229
    v_lshlrev_b32 v230, 4, v230
    v_mov_b32 v231, 0x3f80
    v_lshlrev_b32 v231, v230, v231
    s_mov_b32 s84, 3
    s_mov_b32 s85, 0x300
    v_cndmask_b32 v148, 0, v231, s[84:85]
    s_mov_b32 s84, 12
    s_mov_b32 s85, 0xc00
    v_cndmask_b32 v149, 0, v231, s[84:85]
    s_mov_b32 s84, 48
    s_mov_b32 s85, 0x3000
    v_cndmask_b32 v150, 0, v231, s[84:85]
    s_mov_b32 s84, 0xc0
    s_mov_b32 s85, 0xc000
    v_cndmask_b32 v151, 0, v231, s[84:85]
    s_mov_b32 s84, 0x30000
    s_mov_b32 s85, 0x3000000
    v_cndmask_b32 v152, 0, v231, s[84:85]
    s_mov_b32 s84, 0xc0000
    s_mov_b32 s85, 0xc000000
    v_cndmask_b32 v153, 0, v231, s[84:85]
    s_mov_b32 s84, 0x300000
    s_mov_b32 s85, 0x30000000
    v_cndmask_b32 v154, 0, v231, s[84:85]
    s_mov_b32 s84, 0xc00000
    s_mov_b32 s85, 0xc0000000
    v_cndmask_b32 v155, 0, v231, s[84:85]
    v_lshrrev_b32 v243, 2, v229
    v_and_b32 v244, 3, v229
    v_lshlrev_b32 v244, 4, v244
    s_lshl_b32 s40, s54, 6
    s_add_u32 s40, s40, 0x228c0
    v_add_u32 v244, s40, v244
    v_lshl_add_u32 v232, v228, 2, v243
    v_mul_u32_u24 v232, 0xc0, v232
    v_add_u32 v76, v232, v244
    v_lshrrev_b32 v232, 1, v243
    v_mul_u32_u24 v232, 24, v232
    v_and_b32 v233, 1, v243
    v_lshl_add_u32 v233, v228, 1, v233
    v_add3_u32 v232, v232, v233, 16
    v_mul_u32_u24 v232, 0xc0, v232
    v_add_u32 v77, v232, v244
    s_mov_b32 s60, 0x3000003
    s_mov_b32 s61, s60
    s_mov_b32 s62, 0xc00000c
    s_mov_b32 s63, s62
    s_mov_b32 s64, 0x30000030
    s_mov_b32 s65, s64
    s_mov_b32 s66, 0xc00000c0
    s_mov_b32 s67, s66
    s_mov_b32 s68, 0xf000f
    s_mov_b32 s69, s68
    s_mov_b32 s70, 0xf000f0
    s_mov_b32 s71, s70
    s_mov_b32 s72, 0xf000f00
    s_mov_b32 s73, s72
    s_mov_b32 s74, 0xf000f000
    s_mov_b32 s75, s74
    s_mov_b32 s86, 0xffffffff
    s_mov_b32 s87, 0
    s_waitcnt vmcnt(7)
    ds_read_u16 v3, v240
    ds_read_u16 v7, v241
    ds_read_u16 v11, v242
    ds_read_u16 v15, v240 offset:16
    ds_read_u16 v19, v241 offset:16
    ds_read_u16 v23, v242 offset:16
    ds_read_u16 v27, v240 offset:64
    ds_read_u16 v31, v241 offset:64
    ds_read_u16 v35, v242 offset:64
    ds_read_u16 v39, v240 offset:80
    ds_read_u16 v43, v241 offset:80
    ds_read_u16 v47, v242 offset:80
    ds_read_u16 v51, v240 offset:128
    ds_read_u16 v55, v241 offset:128
    ds_read_u16 v59, v242 offset:128
    s_waitcnt lgkmcnt(13)
    ds_read_u16 v63, v240 offset:144
    ds_read_u16 v67, v241 offset:144
    s_waitcnt lgkmcnt(13)
    ds_read_u16 v71, v242 offset:144
    v_lshlrev_b32 v232, v230, v3
    v_cndmask_b32 v232, v232, v231, s[86:87]
    v_cndmask_b32 v0, 0, v232, s[60:61]
    v_cndmask_b32 v1, 0, v232, s[62:63]
    v_cndmask_b32 v2, 0, v232, s[64:65]
    v_cndmask_b32 v3, 0, v232, s[66:67]
    v_cndmask_b32 v4, 0, v7, s[68:69]
    v_cndmask_b32 v5, 0, v7, s[70:71]
    v_cndmask_b32 v6, 0, v7, s[72:73]
    v_cndmask_b32 v7, 0, v7, s[74:75]
    v_cndmask_b32 v8, 0, v11, s[68:69]
    v_cndmask_b32 v9, 0, v11, s[70:71]
    v_cndmask_b32 v10, 0, v11, s[72:73]
    v_cndmask_b32 v11, 0, v11, s[74:75]
    v_lshlrev_b32 v232, v230, v15
    v_cndmask_b32 v232, v232, v231, s[86:87]
    v_cndmask_b32 v12, 0, v232, s[60:61]
    v_cndmask_b32 v13, 0, v232, s[62:63]
    v_cndmask_b32 v14, 0, v232, s[64:65]
    v_cndmask_b32 v15, 0, v232, s[66:67]
    s_waitcnt lgkmcnt(0)
    v_cndmask_b32 v16, 0, v19, s[68:69]
    v_cndmask_b32 v17, 0, v19, s[70:71]
    v_cndmask_b32 v18, 0, v19, s[72:73]
    v_cndmask_b32 v19, 0, v19, s[74:75]
    v_cndmask_b32 v20, 0, v23, s[68:69]
    v_cndmask_b32 v21, 0, v23, s[70:71]
    v_cndmask_b32 v22, 0, v23, s[72:73]
    v_cndmask_b32 v23, 0, v23, s[74:75]
    v_lshlrev_b32 v232, v230, v27
    v_cndmask_b32 v232, v232, v231, s[86:87]
    v_cndmask_b32 v24, 0, v232, s[60:61]
    v_cndmask_b32 v25, 0, v232, s[62:63]
    v_cndmask_b32 v26, 0, v232, s[64:65]
    v_cndmask_b32 v27, 0, v232, s[66:67]
    v_cndmask_b32 v28, 0, v31, s[68:69]
    v_cndmask_b32 v29, 0, v31, s[70:71]
    v_cndmask_b32 v30, 0, v31, s[72:73]
    v_cndmask_b32 v31, 0, v31, s[74:75]
    v_cndmask_b32 v32, 0, v35, s[68:69]
    v_cndmask_b32 v33, 0, v35, s[70:71]
    v_cndmask_b32 v34, 0, v35, s[72:73]
    v_cndmask_b32 v35, 0, v35, s[74:75]
    v_lshlrev_b32 v232, v230, v39
    v_cndmask_b32 v232, v232, v231, s[86:87]
    v_cndmask_b32 v36, 0, v232, s[60:61]
    v_cndmask_b32 v37, 0, v232, s[62:63]
    v_cndmask_b32 v38, 0, v232, s[64:65]
    v_cndmask_b32 v39, 0, v232, s[66:67]
    v_cndmask_b32 v40, 0, v43, s[68:69]
    v_cndmask_b32 v41, 0, v43, s[70:71]
    v_cndmask_b32 v42, 0, v43, s[72:73]
    v_cndmask_b32 v43, 0, v43, s[74:75]
    v_cndmask_b32 v44, 0, v47, s[68:69]
    v_cndmask_b32 v45, 0, v47, s[70:71]
    v_cndmask_b32 v46, 0, v47, s[72:73]
    v_cndmask_b32 v47, 0, v47, s[74:75]
    v_lshlrev_b32 v232, v230, v51
    v_cndmask_b32 v232, v232, v231, s[86:87]
    v_cndmask_b32 v48, 0, v232, s[60:61]
    v_cndmask_b32 v49, 0, v232, s[62:63]
    v_cndmask_b32 v50, 0, v232, s[64:65]
    v_cndmask_b32 v51, 0, v232, s[66:67]
    v_cndmask_b32 v52, 0, v55, s[68:69]
    v_cndmask_b32 v53, 0, v55, s[70:71]
    v_cndmask_b32 v54, 0, v55, s[72:73]
    v_cndmask_b32 v55, 0, v55, s[74:75]
    v_cndmask_b32 v56, 0, v59, s[68:69]
    v_cndmask_b32 v57, 0, v59, s[70:71]
    v_cndmask_b32 v58, 0, v59, s[72:73]
    v_cndmask_b32 v59, 0, v59, s[74:75]
    v_lshlrev_b32 v232, v230, v63
    v_cndmask_b32 v232, v232, v231, s[86:87]
    v_cndmask_b32 v60, 0, v232, s[60:61]
    v_cndmask_b32 v61, 0, v232, s[62:63]
    v_cndmask_b32 v62, 0, v232, s[64:65]
    v_cndmask_b32 v63, 0, v232, s[66:67]
    v_cndmask_b32 v64, 0, v67, s[68:69]
    v_cndmask_b32 v65, 0, v67, s[70:71]
    v_cndmask_b32 v66, 0, v67, s[72:73]
    v_cndmask_b32 v67, 0, v67, s[74:75]
    v_cndmask_b32 v68, 0, v71, s[68:69]
    v_cndmask_b32 v69, 0, v71, s[70:71]
    v_cndmask_b32 v70, 0, v71, s[72:73]
    v_cndmask_b32 v71, 0, v71, s[74:75]
    s_mov_b32 s60, 0x11111111
    s_mov_b32 s61, s60
    s_mov_b32 s62, 0x22222222
    s_mov_b32 s63, s62
    s_mov_b32 s64, 0x44444444
    s_mov_b32 s65, s64
    s_mov_b32 s66, 0x88888888
    s_mov_b32 s67, s66
    s_waitcnt vmcnt(0)
    v_mov_b32 v230, 0xe484
    v_mov_b32 v231, 1
    s_mov_b64 exec, 1
    ds_add_u32 v230, v231
    s_mov_b64 exec, -1
    s_waitcnt lgkmcnt(0)
L_spinTi:
    ds_read_b32 v231, v230
    s_waitcnt lgkmcnt(0)
    v_readfirstlane_b32 s40, v231
    s_nop 1
    s_cmp_lt_u32 s40, 4
    s_nop 0
    s_cbranch_scc1 L_spinTi
L_Tistart:
    s_mov_b32 s38, -3
    s_add_u32 s56, s38, 12
    v_readlane_b32 s46, v224, s56
    s_nop 1
    s_and_b32 s47, s46, 63
    s_cmp_lt_u32 s46, 0x40000000
    s_cselect_b32 s94, 0x2fe80c0, 0
    s_and_b32 s46, s46, 0x3fffffc0
    s_add_u32 s46, s46, s59
    s_cmp_eq_u32 s47, s48
    s_cbranch_scc1 L_cls2
    s_mov_b32 s48, s47
    s_and_b32 s40, s47, 8
    s_cselect_b64 s[84:85], s[76:77], 0
    v_or_b32 v227, 0x80000000, v211
    v_cndmask_b32 v209, v211, v227, s[84:85]
    s_and_b32 s40, s47, 16
    s_cselect_b64 s[84:85], s[78:79], 0
    v_or_b32 v227, 0x80000000, v212
    v_cndmask_b32 v210, v212, v227, s[84:85]
    s_nop 1
L_cls2:
    s_and_b32 s40, s47, s39
    s_cselect_b32 s6, 0, s94
    s_add_u32 m0, s53, 0x4400
    s_add_u32 s41, s46, 0
    buffer_load_dwordx4 v209, s[4:7], s41 offen nt lds
    s_add_u32 m0, s53, 0x4800
    s_mov_b64 exec, s[80:81]
    buffer_load_dwordx4 v210, s[4:7], s41 offen nt lds
    s_mov_b64 exec, -1
    s_mov_b32 s6, s94
    s_add_u32 m0, s53, 0x4b50
    s_add_u32 s41, s46, 0x17f40
    buffer_load_dwordx4 v209, s[4:7], s41 offen nt lds
    s_add_u32 m0, s53, 0x4f50
    s_mov_b64 exec, s[80:81]
    buffer_load_dwordx4 v210, s[4:7], s41 offen nt lds
    s_mov_b64 exec, -1
    s_mov_b32 s38, -2
    s_add_u32 s56, s38, 12
    v_readlane_b32 s46, v224, s56
    s_nop 1
    s_and_b32 s47, s46, 63
    s_cmp_lt_u32 s46, 0x40000000
    s_cselect_b32 s94, 0x2fe80c0, 0
    s_and_b32 s46, s46, 0x3fffffc0
    s_add_u32 s46, s46, s59
    s_cmp_eq_u32 s47, s48
    s_cbranch_scc1 L_cls3
    s_mov_b32 s48, s47
    s_and_b32 s40, s47, 8
    s_cselect_b64 s[84:85], s[76:77], 0
    v_or_b32 v227, 0x80000000, v211
    v_cndmask_b32 v209, v211, v227, s[84:85]
    s_and_b32 s40, s47, 16
    s_cselect_b64 s[84:85], s[78:79], 0
    v_or_b32 v227, 0x80000000, v212
    v_cndmask_b32 v210, v212, v227, s[84:85]
    s_nop 1
L_cls3:
    ds_read_b128 v[100:103], v73 offset:2080
    ds_read_b128 v[108:111], v73
    ds_read_b128 v[112:115], v73 offset:1872
    ds_read_b128 v[116:119], v73 offset:3744
    ds_read_b128 v[120:123], v74 offset:416
    ds_read_b128 v[104:107], v73 offset:2096
    ds_read_b128 v[124:127], v73 offset:16
    ds_read_b128 v[128:131], v73 offset:1888
    ds_read_b128 v[132:135], v73 offset:3760
    ds_read_b128 v[136:139], v74 offset:432
    s_waitcnt lgkmcnt(9)
    v_mfma_f32_16x16x32_bf16 v[160:163], v[0:3], v[100:103], 0
    ds_read_b128 v[100:103], v73 offset:2144
    s_waitcnt lgkmcnt(8)
    v_smfmac_f32_16x16x64_bf16 v[160:163], v[4:7], v[108:115], v72
    s_waitcnt lgkmcnt(6)
    v_smfmac_f32_16x16x64_bf16 v[160:163], v[8:11], v[116:123], v72
    ds_read_b128 v[108:111], v73 offset:64
    ds_read_b128 v[112:115], v73 offset:1936
    s_waitcnt lgkmcnt(7)
    v_mfma_f32_16x16x32_bf16 v[164:167], v[12:15], v[104:107], 0
    ds_read_b128 v[116:119], v73 offset:3808
    ds_read_b128 v[120:123], v74 offset:480
    s_waitcnt lgkmcnt(7)
    v_smfmac_f32_16x16x64_bf16 v[164:167], v[16:19], v[124:131], v72
    ds_read_b128 v[104:107], v73 offset:2160
    v_cvt_pk_bf16_f32 v184, v160, v161
    s_waitcnt lgkmcnt(6)
    v_smfmac_f32_16x16x64_bf16 v[164:167], v[20:23], v[132:139], v72
    ds_read_b128 v[124:127], v73 offset:80
    ds_read_b128 v[128:131], v73 offset:1952
    ds_read_b128 v[132:135], v73 offset:3824
    ds_read_b128 v[136:139], v74 offset:496
    s_waitcnt lgkmcnt(9)
    v_mfma_f32_16x16x32_bf16 v[168:171], v[24:27], v[100:103], 0
    ds_read_b128 v[100:103], v73 offset:2208
    v_cvt_pk_bf16_f32 v185, v162, v163
    v_cvt_pk_bf16_f32 v186, v164, v165
    v_cvt_pk_bf16_f32 v187, v166, v167
    s_waitcnt lgkmcnt(8)
    v_smfmac_f32_16x16x64_bf16 v[168:171], v[28:31], v[108:115], v72
    v_mfma_f32_16x16x32_bf16 v[200:203], v[184:187], v[184:187], 0
    ds_read_b128 v[108:111], v73 offset:128
    ds_read_b128 v[112:115], v73 offset:2000
    v_mfma_f32_16x16x32_bf16 v[196:199], v[156:159], v[184:187], 0
    s_waitcnt lgkmcnt(8)
    v_smfmac_f32_16x16x64_bf16 v[168:171], v[32:35], v[116:123], v72
    s_waitcnt lgkmcnt(7)
    v_mfma_f32_16x16x32_bf16 v[172:175], v[36:39], v[104:107], 0
    ds_read_b128 v[116:119], v73 offset:3872
    ds_read_b128 v[120:123], v74 offset:544
    s_waitcnt lgkmcnt(7)
    v_smfmac_f32_16x16x64_bf16 v[172:175], v[40:43], v[124:131], v72
    ds_read_b128 v[104:107], v73 offset:2224
    v_cvt_pk_bf16_f32 v188, v168, v169
    s_waitcnt lgkmcnt(6)
    v_smfmac_f32_16x16x64_bf16 v[172:175], v[44:47], v[132:139], v72
    ds_read_b128 v[124:127], v73 offset:144
    ds_read_b128 v[128:131], v73 offset:2016
    s_waitcnt lgkmcnt(7)
    v_mfma_f32_16x16x32_bf16 v[176:179], v[48:51], v[100:103], 0
    ds_read_b128 v[132:135], v73 offset:3888
    ds_read_b128 v[136:139], v74 offset:560
    s_waitcnt lgkmcnt(7)
    v_smfmac_f32_16x16x64_bf16 v[176:179], v[52:55], v[108:115], v72
    v_cvt_pk_bf16_f32 v189, v170, v171
    v_cvt_pk_bf16_f32 v190, v172, v173
    v_cvt_pk_bf16_f32 v191, v174, v175
    s_nop 1
    v_mfma_f32_16x16x32_bf16 v[200:203], v[188:191], v[188:191], v[200:203]
    v_mfma_f32_16x16x32_bf16 v[196:199], v[156:159], v[188:191], v[196:199]
    s_waitcnt lgkmcnt(5)
    v_smfmac_f32_16x16x64_bf16 v[176:179], v[56:59], v[116:123], v72
    s_waitcnt lgkmcnt(4)
    v_mfma_f32_16x16x32_bf16 v[180:183], v[60:63], v[104:107], 0
    s_waitcnt lgkmcnt(2)
    v_smfmac_f32_16x16x64_bf16 v[180:183], v[64:67], v[124:131], v72
    s_waitcnt lgkmcnt(0)
    v_cvt_pk_bf16_f32 v192, v176, v177
    v_smfmac_f32_16x16x64_bf16 v[180:183], v[68:71], v[132:139], v72
    v_cvt_pk_bf16_f32 v193, v178, v179
    s_nop 4
    v_cvt_pk_bf16_f32 v194, v180, v181
    v_cvt_pk_bf16_f32 v195, v182, v183
    s_nop 1
    v_mfma_f32_16x16x32_bf16 v[200:203], v[192:195], v[192:195], v[200:203]
    v_mfma_f32_16x16x32_bf16 v[196:199], v[156:159], v[192:195], v[196:199]
    s_nop 3
    v_cndmask_b32 v223, v200, v201, s[62:63]
    v_cndmask_b32 v223, v223, v202, s[64:65]
    v_cndmask_b32 v223, v223, v203, s[66:67]
    ds_bpermute_b32 v225, v75, v223
    s_and_b32 s40, s47, s39
    s_cselect_b32 s6, 0, s94
    s_add_u32 m0, s53, 0x8800
    s_add_u32 s41, s46, 0
    buffer_load_dwordx4 v209, s[4:7], s41 offen nt lds
    s_add_u32 m0, s53, 0x8c00
    s_mov_b64 exec, s[80:81]
    buffer_load_dwordx4 v210, s[4:7], s41 offen nt lds
    s_mov_b64 exec, -1
    s_mov_b32 s6, s94
    s_add_u32 m0, s53, 0x8f50
    s_add_u32 s41, s46, 0x17f40
    buffer_load_dwordx4 v209, s[4:7], s41 offen nt lds
    s_add_u32 m0, s53, 0x9350
    s_mov_b64 exec, s[80:81]
    buffer_load_dwordx4 v210, s[4:7], s41 offen nt lds
    s_mov_b64 exec, -1
    v_mul_f32 v221, v196, v196
    v_fmamk_f32 v221, v221, 0xb9c12dab, v204
    v_mul_f32 v222, 0xbc2aaaab, v196
    s_waitcnt lgkmcnt(0)
    v_fmamk_f32 v223, v225, 0x3d10e240, v221
    v_max_f32 v223, v223, v204
    v_rsq_f32 v221, v223
    s_nop 0
    v_mul_f32 v222, v222, v221
    v_fma_f32 v160, v160, v221, v222
    v_fma_f32 v161, v161, v221, v222
    v_fma_f32 v162, v162, v221, v222
    v_fma_f32 v163, v163, v221, v222
    v_cvt_pk_bf16_f32 v160, v160, v161
    v_cvt_pk_bf16_f32 v161, v162, v163
    v_fma_f32 v164, v164, v221, v222
    v_fma_f32 v165, v165, v221, v222
    v_fma_f32 v166, v166, v221, v222
    v_fma_f32 v167, v167, v221, v222
    v_cvt_pk_bf16_f32 v162, v164, v165
    v_cvt_pk_bf16_f32 v163, v166, v167
    v_fma_f32 v168, v168, v221, v222
    v_fma_f32 v169, v169, v221, v222
    v_fma_f32 v170, v170, v221, v222
    v_fma_f32 v171, v171, v221, v222
    v_cvt_pk_bf16_f32 v168, v168, v169
    v_cvt_pk_bf16_f32 v169, v170, v171
    v_fma_f32 v172, v172, v221, v222
    v_fma_f32 v173, v173, v221, v222
    v_fma_f32 v174, v174, v221, v222
    v_fma_f32 v175, v175, v221, v222
    v_cvt_pk_bf16_f32 v170, v172, v173
    v_cvt_pk_bf16_f32 v171, v174, v175
    v_fma_f32 v176, v176, v221, v222
    v_fma_f32 v177, v177, v221, v222
    v_fma_f32 v178, v178, v221, v222
    v_fma_f32 v179, v179, v221, v222
    v_cvt_pk_bf16_f32 v176, v176, v177
    v_cvt_pk_bf16_f32 v177, v178, v179
    v_fma_f32 v180, v180, v221, v222
    v_fma_f32 v181, v181, v221, v222
    v_fma_f32 v182, v182, v221, v222
    v_fma_f32 v183, v183, v221, v222
    v_cvt_pk_bf16_f32 v178, v180, v181
    v_cvt_pk_bf16_f32 v179, v182, v183
    ds_write_b128 v205, v[160:163] offset:6144
    ds_write_b128 v205, v[168:171] offset:7168
    ds_write_b128 v205, v[176:179] offset:8192
    s_waitcnt lgkmcnt(0)
L_Tijoin:
    s_mov_b32 s38, -1
    s_mov_b32 s37, 0
    s_waitcnt lgkmcnt(0) vmcnt(4)
    s_barrier
    s_mov_b32 s92, 0
    s_mov_b32 s93, 0x7f7f7f80
    s_add_u32 s56, s38, 12
    v_readlane_b32 s46, v224, s56
    s_nop 1
    s_and_b32 s47, s46, 63
    s_cmp_lt_u32 s46, 0x40000000
    s_cselect_b32 s94, 0x2fe80c0, 0
    s_and_b32 s46, s46, 0x3fffffc0
    s_add_u32 s46, s46, s59
    s_cmp_eq_u32 s47, s48
    s_cbranch_scc1 L_cls4
    s_mov_b32 s48, s47
    s_and_b32 s40, s47, 8
    s_cselect_b64 s[84:85], s[76:77], 0
    v_or_b32 v227, 0x80000000, v211
    v_cndmask_b32 v209, v211, v227, s[84:85]
    s_and_b32 s40, s47, 16
    s_cselect_b64 s[84:85], s[78:79], 0
    v_or_b32 v227, 0x80000000, v212
    v_cndmask_b32 v210, v212, v227, s[84:85]
    s_nop 1
L_cls4:
    ds_read_b128 v[100:103], v73 offset:19488
    ds_read_b128 v[108:111], v73 offset:17408
    ds_read_b128 v[112:115], v73 offset:19280
    ds_read_b128 v[116:119], v73 offset:21152
    ds_read_b128 v[120:123], v74 offset:17824
    ds_read_b128 v[104:107], v73 offset:19504
    ds_read_b128 v[124:127], v73 offset:17424
    ds_read_b128 v[128:131], v73 offset:19296
    ds_read_b128 v[132:135], v73 offset:21168
    ds_read_b128 v[136:139], v74 offset:17840
    s_and_b32 s40, s47, s39
    s_cselect_b32 s6, 0, s94
    s_add_u32 m0, s53, 0
    s_add_u32 s41, s46, 0
    buffer_load_dwordx4 v209, s[4:7], s41 offen nt lds
    s_add_u32 m0, s53, 0x400
    s_mov_b64 exec, s[80:81]
    buffer_load_dwordx4 v210, s[4:7], s41 offen nt lds
    s_mov_b64 exec, -1
    s_waitcnt lgkmcnt(9)
    v_mfma_f32_16x16x32_bf16 v[160:163], v[0:3], v[100:103], 0
    ds_read_b128 v[100:103], v73 offset:19552
    s_waitcnt lgkmcnt(8)
    v_smfmac_f32_16x16x64_bf16 v[160:163], v[4:7], v[108:115], v72
    s_waitcnt lgkmcnt(6)
    v_smfmac_f32_16x16x64_bf16 v[160:163], v[8:11], v[116:123], v72
    ds_read_b128 v[108:111], v73 offset:17472
    ds_read_b128 v[112:115], v73 offset:19344
    s_waitcnt lgkmcnt(5)
    v_mfma_f32_16x16x32_bf16 v[164:167], v[12:15], v[104:107], 0
    ds_read_b128 v[116:119], v73 offset:21216
    ds_read_b128 v[120:123], v74 offset:17888
    v_smfmac_f32_16x16x64_bf16 v[164:167], v[16:19], v[124:131], v72
    ds_read_b128 v[104:107], v73 offset:19568
    s_waitcnt lgkmcnt(6)
    v_smfmac_f32_16x16x64_bf16 v[164:167], v[20:23], v[132:139], v72
    ds_read_b128 v[124:127], v73 offset:17488
    ds_read_b128 v[128:131], v73 offset:19360
    ds_read_b128 v[132:135], v73 offset:21232
    ds_read_b128 v[136:139], v74 offset:17904
    s_waitcnt lgkmcnt(9)
    v_mfma_f32_16x16x32_bf16 v[168:171], v[24:27], v[100:103], 0
    ds_read_b128 v[100:103], v73 offset:19616
    s_mov_b32 s6, s94
    s_add_u32 m0, s53, 0x750
    s_add_u32 s41, s46, 0x17f40
    buffer_load_dwordx4 v209, s[4:7], s41 offen nt lds
    s_add_u32 m0, s53, 0xb50
    s_mov_b64 exec, s[80:81]
    buffer_load_dwordx4 v210, s[4:7], s41 offen nt lds
    s_mov_b64 exec, -1
    s_waitcnt lgkmcnt(7)
    v_smfmac_f32_16x16x64_bf16 v[168:171], v[28:31], v[108:115], v72
    s_add_u32 s57, s38, s54
    s_add_u32 s57, s57, 12
    v_readlane_b32 s52, v224, s57
    s_waitcnt lgkmcnt(5)
    v_smfmac_f32_16x16x64_bf16 v[168:171], v[32:35], v[116:123], v72
    ds_read_b128 v[108:111], v73 offset:17536
    ds_read_b128 v[112:115], v73 offset:19408
    v_mfma_f32_16x16x32_bf16 v[172:175], v[36:39], v[104:107], 0
    ds_read_b128 v[116:119], v73 offset:21280
    ds_read_b128 v[120:123], v74 offset:17952
    s_waitcnt lgkmcnt(4)
    v_smfmac_f32_16x16x64_bf16 v[172:175], v[40:43], v[124:131], v72
    ds_read_b128 v[104:107], v73 offset:19632
    s_cmp_lt_u32 s52, 0x40000000
    v_smfmac_f32_16x16x64_bf16 v[172:175], v[44:47], v[132:139], v72
    ds_read_b128 v[124:127], v73 offset:17552
    ds_read_b128 v[128:131], v73 offset:19424
    v_mfma_f32_16x16x32_bf16 v[176:179], v[48:51], v[100:103], 0
    ds_read_b128 v[132:135], v73 offset:21296
    ds_read_b128 v[136:139], v74 offset:17968
    ds_write_b128 v205, v[184:187] offset:15360
    ds_write_b128 v205, v[188:191] offset:16384
    s_waitcnt lgkmcnt(9)
    v_smfmac_f32_16x16x64_bf16 v[176:179], v[52:55], v[108:115], v72
    s_cselect_b32 s44, 0x2fe80c0, 0
    s_and_b32 s52, s52, 0x3fffffc0
    v_cvt_pk_bf16_f32 v184, v160, v161
    s_waitcnt lgkmcnt(7)
    v_smfmac_f32_16x16x64_bf16 v[176:179], v[56:59], v[116:123], v72
    s_waitcnt lgkmcnt(6)
    v_cvt_pk_bf16_f32 v185, v162, v163
    v_mfma_f32_16x16x32_bf16 v[180:183], v[60:63], v[104:107], 0
    s_waitcnt lgkmcnt(4)
    v_cvt_pk_bf16_f32 v186, v164, v165
    v_cvt_pk_bf16_f32 v187, v166, v167
    v_smfmac_f32_16x16x64_bf16 v[180:183], v[64:67], v[124:131], v72
    v_cvt_pk_bf16_f32 v188, v168, v169
    v_mfma_f32_16x16x32_bf16 v[200:203], v[184:187], v[184:187], 0
    v_cvt_pk_bf16_f32 v189, v170, v171
    v_cvt_pk_bf16_f32 v190, v172, v173
    v_mfma_f32_16x16x32_bf16 v[196:199], v[156:159], v[184:187], 0
    s_waitcnt lgkmcnt(0)
    v_cvt_pk_bf16_f32 v191, v174, v175
    v_smfmac_f32_16x16x64_bf16 v[180:183], v[68:71], v[132:139], v72
    s_nop 0
    v_mfma_f32_16x16x32_bf16 v[200:203], v[188:191], v[188:191], v[200:203]
    v_mfma_f32_16x16x32_bf16 v[196:199], v[156:159], v[188:191], v[196:199]
    ds_write_b128 v205, v[192:195] offset:17408
    v_cvt_pk_bf16_f32 v192, v176, v177
    v_cvt_pk_bf16_f32 v193, v178, v179
    v_cvt_pk_bf16_f32 v194, v180, v181
    v_cvt_pk_bf16_f32 v195, v182, v183
    s_nop 1
    v_mfma_f32_16x16x32_bf16 v[200:203], v[192:195], v[192:195], v[200:203]
    v_mfma_f32_16x16x32_bf16 v[196:199], v[156:159], v[192:195], v[196:199]
    s_nop 3
    v_cndmask_b32 v223, v200, v201, s[62:63]
    v_cndmask_b32 v223, v223, v202, s[64:65]
    v_cndmask_b32 v223, v223, v203, s[66:67]
    ds_bpermute_b32 v225, v75, v223
    v_mul_f32 v221, v196, v196
    v_fmamk_f32 v221, v221, 0xb9c12dab, v204
    v_mul_f32 v222, 0xbc2aaaab, v196
    s_mov_b32 s6, s44
    s_mov_b64 exec, s[82:83]
    s_add_u32 m0, s55, 0xcc00
    s_add_u32 s41, s52, 0x30180
    buffer_load_dwordx4 v211, s[4:7], s41 offen nt lds
    s_add_u32 m0, s55, 0xce70
    s_add_u32 s41, s52, 0x480c0
    buffer_load_dwordx4 v211, s[4:7], s41 offen nt lds
    s_add_u32 m0, s55, 0xd0e0
    s_add_u32 s41, s52, 0x60000
    buffer_load_dwordx4 v211, s[4:7], s41 offen nt lds
    s_mov_b64 exec, -1
    s_waitcnt lgkmcnt(0)
    v_fmamk_f32 v223, v225, 0x3d10e240, v221
    v_max_f32 v223, v223, v204
    v_rsq_f32 v221, v223
    s_add_i32 s38, s38, 1
    v_mul_f32 v222, v222, v221
    v_fma_f32 v160, v160, v221, v222
    v_fma_f32 v161, v161, v221, v222
    v_fma_f32 v162, v162, v221, v222
    v_fma_f32 v163, v163, v221, v222
    v_cvt_pk_bf16_f32 v160, v160, v161
    v_cvt_pk_bf16_f32 v161, v162, v163
    v_fma_f32 v164, v164, v221, v222
    v_fma_f32 v165, v165, v221, v222
    v_fma_f32 v166, v166, v221, v222
    v_fma_f32 v167, v167, v221, v222
    v_cvt_pk_bf16_f32 v162, v164, v165
    v_cvt_pk_bf16_f32 v163, v166, v167
    v_fma_f32 v168, v168, v221, v222
    v_fma_f32 v169, v169, v221, v222
    v_fma_f32 v170, v170, v221, v222
    v_fma_f32 v171, v171, v221, v222
    v_cvt_pk_bf16_f32 v168, v168, v169
    v_cvt_pk_bf16_f32 v169, v170, v171
    v_fma_f32 v172, v172, v221, v222
    v_fma_f32 v173, v173, v221, v222
    v_fma_f32 v174, v174, v221, v222
    v_fma_f32 v175, v175, v221, v222
    v_cvt_pk_bf16_f32 v170, v172, v173
    v_cvt_pk_bf16_f32 v171, v174, v175
    v_fma_f32 v176, v176, v221, v222
    v_fma_f32 v177, v177, v221, v222
    v_fma_f32 v178, v178, v221, v222
    v_fma_f32 v179, v179, v221, v222
    v_cvt_pk_bf16_f32 v176, v176, v177
    v_cvt_pk_bf16_f32 v177, v178, v179
    v_fma_f32 v180, v180, v221, v222
    v_fma_f32 v181, v181, v221, v222
    v_fma_f32 v182, v182, v221, v222
    v_fma_f32 v183, v183, v221, v222
    v_cvt_pk_bf16_f32 v178, v180, v181
    v_cvt_pk_bf16_f32 v179, v182, v183
    ds_write_b128 v205, v[160:163] offset:24576
    ds_write_b128 v205, v[168:171] offset:25600
    ds_write_b128 v205, v[176:179] offset:26624
    s_waitcnt vmcnt(7)
    ds_add_u32 v214, v214 offset:16
    s_add_u32 s92, s92, 0x39200
L_sp4:
    ds_read_b32 v215, v214 offset:16
    s_waitcnt lgkmcnt(0)
    v_readfirstlane_b32 s91, v215
    s_nop 1
    s_cmp_lt_u32 s91, s92
    s_nop 0
    s_cbranch_scc0 L_sq4
    s_sleep 1
    s_branch L_sp4
L_sq4:
    s_cmp_lg_u32 s36, 0
    s_cbranch_scc1 L_Tinowo
    v_mov_b32 v227, v76
    v_mov_b32 v223, v77
    ds_read_b64_tr_b16 v[76:77], v227
    ds_read_b64_tr_b16 v[78:79], v227 offset:4608
    ds_read_b64_tr_b16 v[80:81], v227 offset:9216
    ds_read_b64_tr_b16 v[82:83], v227 offset:13824
    ds_read_b64_tr_b16 v[84:85], v223
    ds_read_b64_tr_b16 v[86:87], v223 offset:9216
    ds_read_b64_tr_b16 v[88:89], v227 offset:8
    ds_read_b64_tr_b16 v[90:91], v227 offset:4616
    ds_read_b64_tr_b16 v[92:93], v227 offset:9224
    ds_read_b64_tr_b16 v[94:95], v227 offset:13832
    ds_read_b64_tr_b16 v[96:97], v223 offset:8
    ds_read_b64_tr_b16 v[98:99], v223 offset:9224
    s_waitcnt lgkmcnt(0)
L_Tinowo:
    s_add_u32 s56, s38, 12
    v_readlane_b32 s46, v224, s56
    s_nop 1
    s_and_b32 s47, s46, 63
    s_cmp_lt_u32 s46, 0x40000000
    s_cselect_b32 s94, 0x2fe80c0, 0
    s_and_b32 s46, s46, 0x3fffffc0
    s_add_u32 s46, s46, s59
    s_cmp_eq_u32 s47, s48
    s_cbranch_scc1 L_cls5
    s_mov_b32 s48, s47
    s_and_b32 s40, s47, 8
    s_cselect_b64 s[84:85], s[76:77], 0
    v_or_b32 v227, 0x80000000, v211
    v_cndmask_b32 v209, v211, v227, s[84:85]
    s_and_b32 s40, s47, 16
    s_cselect_b64 s[84:85], s[78:79], 0
    v_or_b32 v227, 0x80000000, v212
    v_cndmask_b32 v210, v212, v227, s[84:85]
    s_nop 1
L_cls5:
    ds_read_b128 v[100:103], v73 offset:36896
    ds_read_b128 v[108:111], v73 offset:34816
    ds_read_b128 v[112:115], v73 offset:36688
    ds_read_b128 v[116:119], v73 offset:38560
    ds_read_b128 v[120:123], v74 offset:35232
    ds_read_b128 v[104:107], v73 offset:36912
    ds_read_b128 v[124:127], v73 offset:34832
    ds_read_b128 v[128:131], v73 offset:36704
    ds_read_b128 v[132:135], v73 offset:38576
    ds_read_b128 v[136:139], v74 offset:35248
    s_and_b32 s40, s47, s39
    s_cselect_b32 s6, 0, s94
    s_add_u32 m0, s53, 0x4400
    s_add_u32 s41, s46, 0
    buffer_load_dwordx4 v209, s[4:7], s41 offen nt lds
    s_add_u32 m0, s53, 0x4800
    s_mov_b64 exec, s[80:81]
    buffer_load_dwordx4 v210, s[4:7], s41 offen nt lds
    s_mov_b64 exec, -1
    s_waitcnt lgkmcnt(9)
    v_mfma_f32_16x16x32_bf16 v[160:163], v[0:3], v[100:103], 0
    ds_read_b128 v[100:103], v73 offset:36960
    s_waitcnt lgkmcnt(8)
    v_smfmac_f32_16x16x64_bf16 v[160:163], v[4:7], v[108:115], v72
    s_waitcnt lgkmcnt(6)
    v_smfmac_f32_16x16x64_bf16 v[160:163], v[8:11], v[116:123], v72
    ds_read_b128 v[108:111], v73 offset:34880
    ds_read_b128 v[112:115], v73 offset:36752
    s_waitcnt lgkmcnt(5)
    v_mfma_f32_16x16x32_bf16 v[164:167], v[12:15], v[104:107], 0
    ds_read_b128 v[116:119], v73 offset:38624
    ds_read_b128 v[120:123], v74 offset:35296
    v_smfmac_f32_16x16x64_bf16 v[164:167], v[16:19], v[124:131], v72
    ds_read_b128 v[104:107], v73 offset:36976
    s_waitcnt lgkmcnt(6)
    v_smfmac_f32_16x16x64_bf16 v[164:167], v[20:23], v[132:139], v72
    ds_read_b128 v[124:127], v73 offset:34896
    ds_read_b128 v[128:131], v73 offset:36768
    ds_read_b128 v[132:135], v73 offset:38640
    ds_read_b128 v[136:139], v74 offset:35312
    s_waitcnt lgkmcnt(9)
    v_mfma_f32_16x16x32_bf16 v[168:171], v[24:27], v[100:103], 0
    ds_read_b128 v[100:103], v73 offset:37024
    s_mov_b32 s6, s94
    s_add_u32 m0, s53, 0x4b50
    s_add_u32 s41, s46, 0x17f40
    buffer_load_dwordx4 v209, s[4:7], s41 offen nt lds
    s_add_u32 m0, s53, 0x4f50
    s_mov_b64 exec, s[80:81]
    buffer_load_dwordx4 v210, s[4:7], s41 offen nt lds
    s_mov_b64 exec, -1
    s_waitcnt lgkmcnt(7)
    v_smfmac_f32_16x16x64_bf16 v[168:171], v[28:31], v[108:115], v72
    s_add_i32 s38, s38, 1
    s_waitcnt lgkmcnt(5)
    v_smfmac_f32_16x16x64_bf16 v[168:171], v[32:35], v[116:123], v72
    ds_read_b128 v[108:111], v73 offset:34944
    ds_read_b128 v[112:115], v73 offset:36816
    v_mfma_f32_16x16x32_bf16 v[172:175], v[36:39], v[104:107], 0
    ds_read_b128 v[116:119], v73 offset:38688
    ds_read_b128 v[120:123], v74 offset:35360
    s_waitcnt lgkmcnt(5)
    v_smfmac_f32_16x16x64_bf16 v[172:175], v[40:43], v[124:131], v72
    ds_read_b128 v[104:107], v73 offset:37040
    v_smfmac_f32_16x16x64_bf16 v[172:175], v[44:47], v[132:139], v72
    ds_read_b128 v[124:127], v73 offset:34960
    ds_read_b128 v[128:131], v73 offset:36832
    s_waitcnt lgkmcnt(7)
    v_mfma_f32_16x16x32_bf16 v[176:179], v[48:51], v[100:103], 0
    ds_read_b128 v[132:135], v73 offset:38704
    ds_read_b128 v[136:139], v74 offset:35376
    ds_write_b128 v205, v[184:187] offset:43008
    ds_write_b128 v205, v[188:191] offset:44032
    s_waitcnt lgkmcnt(9)
    v_smfmac_f32_16x16x64_bf16 v[176:179], v[52:55], v[108:115], v72
    s_waitcnt lgkmcnt(7)
    v_cvt_pk_bf16_f32 v184, v160, v161
    v_smfmac_f32_16x16x64_bf16 v[176:179], v[56:59], v[116:123], v72
    s_waitcnt lgkmcnt(6)
    v_cvt_pk_bf16_f32 v185, v162, v163
    v_mfma_f32_16x16x32_bf16 v[180:183], v[60:63], v[104:107], 0
    s_waitcnt lgkmcnt(4)
    v_cvt_pk_bf16_f32 v186, v164, v165
    v_cvt_pk_bf16_f32 v187, v166, v167
    v_smfmac_f32_16x16x64_bf16 v[180:183], v[64:67], v[124:131], v72
    v_cvt_pk_bf16_f32 v188, v168, v169
    v_mfma_f32_16x16x32_bf16 v[200:203], v[184:187], v[184:187], 0
    v_cvt_pk_bf16_f32 v189, v170, v171
    v_cvt_pk_bf16_f32 v190, v172, v173
    v_mfma_f32_16x16x32_bf16 v[196:199], v[156:159], v[184:187], 0
    s_waitcnt lgkmcnt(2)
    v_cvt_pk_bf16_f32 v191, v174, v175
    v_smfmac_f32_16x16x64_bf16 v[180:183], v[68:71], v[132:139], v72
    s_nop 0
    v_mfma_f32_16x16x32_bf16 v[200:203], v[188:191], v[188:191], v[200:203]
    v_mfma_f32_16x16x32_bf16 v[196:199], v[156:159], v[188:191], v[196:199]
    ds_write_b128 v205, v[192:195] offset:45056
    v_cvt_pk_bf16_f32 v192, v176, v177
    v_cvt_pk_bf16_f32 v193, v178, v179
    v_cvt_pk_bf16_f32 v194, v180, v181
    v_cvt_pk_bf16_f32 v195, v182, v183
    s_nop 1
    v_mfma_f32_16x16x32_bf16 v[200:203], v[192:195], v[192:195], v[200:203]
    v_mfma_f32_16x16x32_bf16 v[196:199], v[156:159], v[192:195], v[196:199]
    s_nop 3
    v_cndmask_b32 v223, v200, v201, s[62:63]
    v_cndmask_b32 v223, v223, v202, s[64:65]
    v_cndmask_b32 v223, v223, v203, s[66:67]
    ds_bpermute_b32 v225, v75, v223
    v_mul_f32 v221, v196, v196
    v_fmamk_f32 v221, v221, 0xb9c12dab, v204
    v_mul_f32 v222, 0xbc2aaaab, v196
    s_waitcnt lgkmcnt(0)
    v_fmamk_f32 v223, v225, 0x3d10e240, v221
    v_max_f32 v223, v223, v204
    v_rsq_f32 v221, v223
    s_nop 0
    v_mul_f32 v222, v222, v221
    v_fma_f32 v160, v160, v221, v222
    v_fma_f32 v161, v161, v221, v222
    v_fma_f32 v162, v162, v221, v222
    v_fma_f32 v163, v163, v221, v222
    v_cvt_pk_bf16_f32 v160, v160, v161
    v_cvt_pk_bf16_f32 v161, v162, v163
    v_fma_f32 v164, v164, v221, v222
    v_fma_f32 v165, v165, v221, v222
    v_fma_f32 v166, v166, v221, v222
    v_fma_f32 v167, v167, v221, v222
    v_cvt_pk_bf16_f32 v162, v164, v165
    v_cvt_pk_bf16_f32 v163, v166, v167
    v_fma_f32 v168, v168, v221, v222
    v_fma_f32 v169, v169, v221, v222
    v_fma_f32 v170, v170, v221, v222
    v_fma_f32 v171, v171, v221, v222
    v_cvt_pk_bf16_f32 v168, v168, v169
    v_cvt_pk_bf16_f32 v169, v170, v171
    v_fma_f32 v172, v172, v221, v222
    v_fma_f32 v173, v173, v221, v222
    v_fma_f32 v174, v174, v221, v222
    v_fma_f32 v175, v175, v221, v222
    v_cvt_pk_bf16_f32 v170, v172, v173
    v_cvt_pk_bf16_f32 v171, v174, v175
    v_fma_f32 v176, v176, v221, v222
    v_fma_f32 v177, v177, v221, v222
    v_fma_f32 v178, v178, v221, v222
    v_fma_f32 v179, v179, v221, v222
    v_cvt_pk_bf16_f32 v176, v176, v177
    v_cvt_pk_bf16_f32 v177, v178, v179
    v_fma_f32 v180, v180, v221, v222
    v_fma_f32 v181, v181, v221, v222
    v_fma_f32 v182, v182, v221, v222
    v_fma_f32 v183, v183, v221, v222
    v_cvt_pk_bf16_f32 v178, v180, v181
    v_cvt_pk_bf16_f32 v179, v182, v183
    ds_write_b128 v205, v[160:163] offset:33792
    ds_write_b128 v205, v[168:171] offset:34816
    ds_write_b128 v205, v[176:179] offset:35840
    s_waitcnt vmcnt(4)
    ds_add_u32 v214, v214 offset:16
L_Tiloop:
    s_add_u32 s92, s92, 0x39200
L_sp5:
    ds_read_b32 v215, v214 offset:16
    s_waitcnt lgkmcnt(0)
    v_readfirstlane_b32 s91, v215
    s_nop 1
    s_cmp_lt_u32 s91, s92
    s_nop 0
    s_cbranch_scc0 L_sq5
    s_sleep 1
    s_branch L_sp5
L_sq5:
    s_add_u32 s56, s38, 12
    v_readlane_b32 s46, v224, s56
    s_nop 1
    s_and_b32 s47, s46, 63
    s_cmp_lt_u32 s46, 0x40000000
    s_cselect_b32 s94, 0x2fe80c0, 0
    s_and_b32 s46, s46, 0x3fffffc0
    s_add_u32 s46, s46, s59
    s_cmp_eq_u32 s47, s48
    s_cbranch_scc1 L_cls6
    s_mov_b32 s48, s47
    s_and_b32 s40, s47, 8
    s_cselect_b64 s[84:85], s[76:77], 0
    v_or_b32 v227, 0x80000000, v211
    v_cndmask_b32 v209, v211, v227, s[84:85]
    s_and_b32 s40, s47, 16
    s_cselect_b64 s[84:85], s[78:79], 0
    v_or_b32 v227, 0x80000000, v212
    v_cndmask_b32 v210, v212, v227, s[84:85]
    s_nop 1
L_cls6:
    ds_read_b128 v[100:103], v73 offset:2080
    ds_read_b128 v[108:111], v73
    ds_read_b128 v[112:115], v73 offset:1872
    ds_read_b128 v[116:119], v73 offset:3744
    ds_read_b128 v[120:123], v74 offset:416
    ds_read_b128 v[104:107], v73 offset:2096
    ds_read_b128 v[124:127], v73 offset:16
    ds_read_b128 v[128:131], v73 offset:1888
    ds_read_b128 v[132:135], v73 offset:3760
    ds_read_b128 v[136:139], v74 offset:432
    ds_read_b128 v[252:255], v206 offset:15360
    ds_read_b128 v[140:143], v206 offset:18432
    s_and_b32 s40, s47, s39
    s_cselect_b32 s6, 0, s94
    s_add_u32 m0, s53, 0x8800
    s_add_u32 s41, s46, 0
    buffer_load_dwordx4 v209, s[4:7], s41 offen nt lds
    s_add_u32 m0, s53, 0x8c00
    s_mov_b64 exec, s[80:81]
    buffer_load_dwordx4 v210, s[4:7], s41 offen nt lds
    s_mov_b64 exec, -1
    s_waitcnt lgkmcnt(11)
    v_mfma_f32_16x16x32_bf16 v[160:163], v[0:3], v[100:103], 0
    ds_read_b128 v[100:103], v73 offset:2144
    s_waitcnt lgkmcnt(9)
    v_smfmac_f32_16x16x64_bf16 v[160:163], v[4:7], v[108:115], v72
    s_waitcnt lgkmcnt(7)
    v_smfmac_f32_16x16x64_bf16 v[160:163], v[8:11], v[116:123], v72
    ds_read_b128 v[108:111], v73 offset:64
    ds_read_b128 v[112:115], v73 offset:1936
    v_mfma_f32_16x16x32_bf16 v[164:167], v[12:15], v[104:107], 0
    ds_read_b128 v[116:119], v73 offset:3808
    ds_read_b128 v[120:123], v74 offset:480
    s_waitcnt lgkmcnt(5)
    v_smfmac_f32_16x16x64_bf16 v[164:167], v[16:19], v[124:131], v72
    ds_read_b128 v[104:107], v73 offset:2160
    v_smfmac_f32_16x16x64_bf16 v[164:167], v[20:23], v[132:139], v72
    ds_read_b128 v[124:127], v73 offset:80
    ds_read_b128 v[128:131], v73 offset:1952
    ds_read_b128 v[132:135], v73 offset:3824
    ds_read_b128 v[136:139], v74 offset:496
    s_waitcnt lgkmcnt(9)
    v_mfma_f32_16x16x32_bf16 v[168:171], v[24:27], v[100:103], 0
    ds_read_b128 v[100:103], v73 offset:2208
    s_mov_b32 s6, s94
    s_add_u32 m0, s53, 0x8f50
    s_add_u32 s41, s46, 0x17f40
    buffer_load_dwordx4 v209, s[4:7], s41 offen nt lds
    s_add_u32 m0, s53, 0x9350
    s_mov_b64 exec, s[80:81]
    buffer_load_dwordx4 v210, s[4:7], s41 offen nt lds
    s_mov_b64 exec, -1
    s_waitcnt lgkmcnt(7)
    v_smfmac_f32_16x16x64_bf16 v[168:171], v[28:31], v[108:115], v72
    s_add_u32 s93, s93, 0x1010101
    s_waitcnt lgkmcnt(6)
    v_smfmac_f32_16x16x64_bf16 v[168:171], v[32:35], v[116:123], v72
    ds_read_b128 v[108:111], v73 offset:128
    ds_read_b128 v[112:115], v73 offset:2000
    s_waitcnt lgkmcnt(5)
    v_mfma_f32_16x16x32_bf16 v[172:175], v[36:39], v[104:107], 0
    ds_read_b128 v[116:119], v73 offset:3872
    ds_read_b128 v[120:123], v74 offset:544
    v_smfmac_f32_16x16x64_bf16 v[172:175], v[40:43], v[124:131], v72
    ds_read_b128 v[104:107], v73 offset:2224
    s_waitcnt lgkmcnt(5)
    v_smfmac_f32_16x16x64_bf16 v[172:175], v[44:47], v[132:139], v72
    ds_read_b128 v[124:127], v73 offset:144
    ds_read_b128 v[128:131], v73 offset:2016
    v_mfma_f32_16x16x32_bf16 v[176:179], v[48:51], v[100:103], 0
    ds_read_b128 v[132:135], v73 offset:3888
    ds_read_b128 v[136:139], v74 offset:560
    s_nop 5
    ds_read_b32 v215, v214 offset:20
    ds_write_b128 v205, v[184:187] offset:52224
    s_waitcnt lgkmcnt(9)
    v_smfmac_f32_16x16x64_bf16 v[176:179], v[52:55], v[108:115], v72
    s_waitcnt lgkmcnt(7)
    v_cvt_pk_bf16_f32 v184, v160, v161
    v_smfmac_f32_16x16x64_bf16 v[176:179], v[56:59], v[116:123], v72
    s_waitcnt lgkmcnt(6)
    v_cvt_pk_bf16_f32 v185, v162, v163
    v_mfma_f32_16x16x32_bf16 v[180:183], v[60:63], v[104:107], 0
    s_waitcnt lgkmcnt(4)
    v_cvt_pk_bf16_f32 v186, v164, v165
    v_cvt_pk_bf16_f32 v187, v166, v167
    v_smfmac_f32_16x16x64_bf16 v[180:183], v[64:67], v[124:131], v72
    s_nop 0
    v_mfma_f32_16x16x32_bf16 v[200:203], v[184:187], v[184:187], 0
    s_waitcnt lgkmcnt(1)
    v_readfirstlane_b32 s91, v215
    v_mfma_f32_16x16x32_bf16 v[196:199], v[156:159], v[184:187], 0
    v_smfmac_f32_16x16x64_bf16 v[180:183], v[68:71], v[132:139], v72
    ds_write_b128 v205, v[188:191] offset:53248
    ds_write_b128 v205, v[192:195] offset:54272
    v_cvt_pk_bf16_f32 v188, v168, v169
    v_cvt_pk_bf16_f32 v189, v170, v171
    v_cvt_pk_bf16_f32 v190, v172, v173
    v_cvt_pk_bf16_f32 v191, v174, v175
    v_cvt_pk_bf16_f32 v192, v176, v177
    v_cvt_pk_bf16_f32 v193, v178, v179
    v_mfma_f32_16x16x32_bf16 v[200:203], v[188:191], v[188:191], v[200:203]
    s_sub_u32 s91, s91, s93
    s_andn2_b32 s91, 0x80808080, s91
    s_cbranch_scc1 L_sw6
L_sb6:
    v_mfma_f32_16x16x32_bf16 v[196:199], v[156:159], v[188:191], v[196:199]
    ds_read_b128 v[228:231], v207
    ds_read_b128 v[232:235], v207 offset:1024
    ds_read_b128 v[236:239], v207 offset:2048
    ds_read_b128 v[240:243], v207 offset:3072
    ds_read_b128 v[244:247], v207 offset:4096
    ds_read_b128 v[248:251], v207 offset:5120
    v_cvt_pk_bf16_f32 v194, v180, v181
    v_cvt_pk_bf16_f32 v195, v182, v183
    s_add_u32 s58, s38, 7
    v_readlane_b32 s49, v224, s58
    v_mfma_f32_16x16x32_bf16 v[200:203], v[192:195], v[192:195], v[200:203]
    v_mfma_f32_16x16x32_bf16 v[196:199], v[156:159], v[192:195], v[196:199]
    s_cmp_lt_u32 s49, 0x40000000
    s_cselect_b32 s10, 0x2fd00c0, 0
    s_and_b32 s49, s49, 0x3fffffc0
    s_add_i32 s38, s38, 1
    v_cndmask_b32 v223, v200, v201, s[62:63]
    v_cndmask_b32 v223, v223, v202, s[64:65]
    v_cndmask_b32 v223, v223, v203, s[66:67]
    ds_bpermute_b32 v225, v75, v223
    v_mul_f32 v221, v196, v196
    v_fmamk_f32 v221, v221, 0xb9c12dab, v204
    v_mul_f32 v222, 0xbc2aaaab, v196
    s_waitcnt lgkmcnt(0)
    v_fmamk_f32 v223, v225, 0x3d10e240, v221
    v_mfma_f32_16x16x32_bf16 v[144:147], v[148:151], v[252:255], 0
    v_max_f32 v223, v223, v204
    v_mfma_f32_16x16x32_bf16 v[144:147], v[76:79], v[228:231], v[144:147]
    v_rsq_f32 v221, v223
    v_mfma_f32_16x16x32_bf16 v[144:147], v[80:83], v[232:235], v[144:147]
    v_mul_f32 v222, v222, v221
    v_fma_f32 v160, v160, v221, v222
    v_mfma_f32_16x16x32_bf16 v[144:147], v[84:87], v[236:239], v[144:147]
    v_fma_f32 v161, v161, v221, v222
    v_fma_f32 v162, v162, v221, v222
    v_mfma_f32_16x16x32_bf16 v[100:103], v[152:155], v[252:255], 0
    v_fma_f32 v163, v163, v221, v222
    v_cvt_pk_bf16_f32 v160, v160, v161
    v_mfma_f32_16x16x32_bf16 v[100:103], v[88:91], v[228:231], v[100:103]
    v_cvt_pk_bf16_f32 v144, v144, v145
    v_cvt_pk_bf16_f32 v145, v146, v147
    v_mfma_f32_16x16x32_bf16 v[100:103], v[92:95], v[232:235], v[100:103]
    v_cvt_pk_bf16_f32 v161, v162, v163
    v_fma_f32 v164, v164, v221, v222
    v_mfma_f32_16x16x32_bf16 v[100:103], v[96:99], v[236:239], v[100:103]
    v_fma_f32 v165, v165, v221, v222
    v_fma_f32 v166, v166, v221, v222
    v_mfma_f32_16x16x32_bf16 v[104:107], v[148:151], v[140:143], 0
    v_fma_f32 v167, v167, v221, v222
    v_cvt_pk_bf16_f32 v162, v164, v165
    v_mfma_f32_16x16x32_bf16 v[104:107], v[76:79], v[240:243], v[104:107]
    v_cvt_pk_bf16_f32 v146, v100, v101
    v_cvt_pk_bf16_f32 v147, v102, v103
    v_mfma_f32_16x16x32_bf16 v[104:107], v[80:83], v[244:247], v[104:107]
    v_cvt_pk_bf16_f32 v163, v166, v167
    v_fma_f32 v168, v168, v221, v222
    v_mfma_f32_16x16x32_bf16 v[104:107], v[84:87], v[248:251], v[104:107]
    v_fma_f32 v169, v169, v221, v222
    v_fma_f32 v170, v170, v221, v222
    v_mfma_f32_16x16x32_bf16 v[108:111], v[152:155], v[140:143], 0
    v_fma_f32 v171, v171, v221, v222
    v_cvt_pk_bf16_f32 v168, v168, v169
    v_mfma_f32_16x16x32_bf16 v[108:111], v[88:91], v[240:243], v[108:111]
    v_cvt_pk_bf16_f32 v104, v104, v105
    v_cvt_pk_bf16_f32 v105, v106, v107
    v_mfma_f32_16x16x32_bf16 v[108:111], v[92:95], v[244:247], v[108:111]
    v_cvt_pk_bf16_f32 v169, v170, v171
    v_fma_f32 v172, v172, v221, v222
    v_mfma_f32_16x16x32_bf16 v[108:111], v[96:99], v[248:251], v[108:111]
    buffer_store_dwordx4 v[144:147], v217, s[8:11], s49 offen sc0 sc1
    ds_write_b128 v205, v[160:163] offset:6144
    s_nop 5
    v_cvt_pk_bf16_f32 v106, v108, v109
    v_cvt_pk_bf16_f32 v107, v110, v111
    v_fma_f32 v173, v173, v221, v222
    v_fma_f32 v174, v174, v221, v222
    v_fma_f32 v175, v175, v221, v222
    v_cvt_pk_bf16_f32 v170, v172, v173
    v_cvt_pk_bf16_f32 v171, v174, v175
    v_fma_f32 v176, v176, v221, v222
    v_fma_f32 v177, v177, v221, v222
    v_fma_f32 v178, v178, v221, v222
    v_fma_f32 v179, v179, v221, v222
    v_cvt_pk_bf16_f32 v176, v176, v177
    v_cvt_pk_bf16_f32 v177, v178, v179
    v_fma_f32 v180, v180, v221, v222
    v_fma_f32 v181, v181, v221, v222
    v_fma_f32 v182, v182, v221, v222
    v_fma_f32 v183, v183, v221, v222
    v_cvt_pk_bf16_f32 v178, v180, v181
    v_cvt_pk_bf16_f32 v179, v182, v183
    buffer_store_dwordx4 v[104:107], v218, s[8:11], s49 offen sc0 sc1
    ds_write_b128 v205, v[168:171] offset:7168
    ds_write_b128 v205, v[176:179] offset:8192
    s_waitcnt vmcnt(6)
    ds_add_u32 v214, v214 offset:16
    s_add_u32 s92, s92, 0x39200
L_sp7:
    ds_read_b32 v215, v214 offset:16
    s_waitcnt lgkmcnt(0)
    v_readfirstlane_b32 s91, v215
    s_nop 1
    s_cmp_lt_u32 s91, s92
    s_nop 0
    s_cbranch_scc0 L_sq7
    s_sleep 1
    s_branch L_sp7
L_sq7:
    s_add_u32 s56, s38, 12
    v_readlane_b32 s46, v224, s56
    s_nop 1
    s_and_b32 s47, s46, 63
    s_cmp_lt_u32 s46, 0x40000000
    s_cselect_b32 s94, 0x2fe80c0, 0
    s_and_b32 s46, s46, 0x3fffffc0
    s_add_u32 s46, s46, s59
    s_cmp_eq_u32 s47, s48
    s_cbranch_scc1 L_cls7
    s_mov_b32 s48, s47
    s_and_b32 s40, s47, 8
    s_cselect_b64 s[84:85], s[76:77], 0
    v_or_b32 v227, 0x80000000, v211
    v_cndmask_b32 v209, v211, v227, s[84:85]
    s_and_b32 s40, s47, 16
    s_cselect_b64 s[84:85], s[78:79], 0
    v_or_b32 v227, 0x80000000, v212
    v_cndmask_b32 v210, v212, v227, s[84:85]
    s_nop 1
L_cls7:
    ds_read_b128 v[100:103], v73 offset:19488
    ds_read_b128 v[108:111], v73 offset:17408
    ds_read_b128 v[112:115], v73 offset:19280
    ds_read_b128 v[116:119], v73 offset:21152
    ds_read_b128 v[120:123], v74 offset:17824
    ds_read_b128 v[104:107], v73 offset:19504
    ds_read_b128 v[124:127], v73 offset:17424
    ds_read_b128 v[128:131], v73 offset:19296
    ds_read_b128 v[132:135], v73 offset:21168
    ds_read_b128 v[136:139], v74 offset:17840
    ds_read_b128 v[252:255], v206 offset:43008
    ds_read_b128 v[140:143], v206 offset:46080
    s_and_b32 s40, s47, s39
    s_cselect_b32 s6, 0, s94
    s_add_u32 m0, s53, 0
    s_add_u32 s41, s46, 0
    buffer_load_dwordx4 v209, s[4:7], s41 offen nt lds
    s_add_u32 m0, s53, 0x400
    s_mov_b64 exec, s[80:81]
    buffer_load_dwordx4 v210, s[4:7], s41 offen nt lds
    s_mov_b64 exec, -1
    s_waitcnt lgkmcnt(11)
    v_mfma_f32_16x16x32_bf16 v[160:163], v[0:3], v[100:103], 0
    ds_read_b128 v[100:103], v73 offset:19552
    s_waitcnt lgkmcnt(9)
    v_smfmac_f32_16x16x64_bf16 v[160:163], v[4:7], v[108:115], v72
    s_waitcnt lgkmcnt(7)
    v_smfmac_f32_16x16x64_bf16 v[160:163], v[8:11], v[116:123], v72
    ds_read_b128 v[108:111], v73 offset:17472
    ds_read_b128 v[112:115], v73 offset:19344
    v_mfma_f32_16x16x32_bf16 v[164:167], v[12:15], v[104:107], 0
    ds_read_b128 v[116:119], v73 offset:21216
    ds_read_b128 v[120:123], v74 offset:17888
    s_waitcnt lgkmcnt(5)
    v_smfmac_f32_16x16x64_bf16 v[164:167], v[16:19], v[124:131], v72
    ds_read_b128 v[104:107], v73 offset:19568
    v_smfmac_f32_16x16x64_bf16 v[164:167], v[20:23], v[132:139], v72
    ds_read_b128 v[124:127], v73 offset:17488
    ds_read_b128 v[128:131], v73 offset:19360
    ds_read_b128 v[132:135], v73 offset:21232
    ds_read_b128 v[136:139], v74 offset:17904
    s_waitcnt lgkmcnt(9)
    v_mfma_f32_16x16x32_bf16 v[168:171], v[24:27], v[100:103], 0
    ds_read_b128 v[100:103], v73 offset:19616
    s_mov_b32 s6, s94
    s_add_u32 m0, s53, 0x750
    s_add_u32 s41, s46, 0x17f40
    buffer_load_dwordx4 v209, s[4:7], s41 offen nt lds
    s_add_u32 m0, s53, 0xb50
    s_mov_b64 exec, s[80:81]
    buffer_load_dwordx4 v210, s[4:7], s41 offen nt lds
    s_mov_b64 exec, -1
    s_waitcnt lgkmcnt(7)
    v_smfmac_f32_16x16x64_bf16 v[168:171], v[28:31], v[108:115], v72
    s_add_u32 s57, s38, s54
    s_add_u32 s57, s57, 12
    v_readlane_b32 s52, v224, s57
    s_waitcnt lgkmcnt(5)
    v_smfmac_f32_16x16x64_bf16 v[168:171], v[32:35], v[116:123], v72
    ds_read_b128 v[108:111], v73 offset:17536
    ds_read_b128 v[112:115], v73 offset:19408
    v_mfma_f32_16x16x32_bf16 v[172:175], v[36:39], v[104:107], 0
    ds_read_b128 v[116:119], v73 offset:21280
    ds_read_b128 v[120:123], v74 offset:17952
    s_waitcnt lgkmcnt(4)
    v_smfmac_f32_16x16x64_bf16 v[172:175], v[40:43], v[124:131], v72
    ds_read_b128 v[104:107], v73 offset:19632
    s_cmp_lt_u32 s52, 0x40000000
    v_smfmac_f32_16x16x64_bf16 v[172:175], v[44:47], v[132:139], v72
    ds_read_b128 v[124:127], v73 offset:17552
    ds_read_b128 v[128:131], v73 offset:19424
    v_mfma_f32_16x16x32_bf16 v[176:179], v[48:51], v[100:103], 0
    ds_read_b128 v[132:135], v73 offset:21296
    ds_read_b128 v[136:139], v74 offset:17968
    s_nop 5
    ds_read_b32 v215, v214 offset:20
    ds_write_b128 v205, v[184:187] offset:15360
    s_waitcnt lgkmcnt(9)
    v_smfmac_f32_16x16x64_bf16 v[176:179], v[52:55], v[108:115], v72
    s_cselect_b32 s44, 0x2fe80c0, 0
    s_and_b32 s52, s52, 0x3fffffc0
    v_cvt_pk_bf16_f32 v184, v160, v161
    s_waitcnt lgkmcnt(7)
    v_smfmac_f32_16x16x64_bf16 v[176:179], v[56:59], v[116:123], v72
    s_waitcnt lgkmcnt(6)
    v_cvt_pk_bf16_f32 v185, v162, v163
    v_mfma_f32_16x16x32_bf16 v[180:183], v[60:63], v[104:107], 0
    s_waitcnt lgkmcnt(4)
    v_cvt_pk_bf16_f32 v186, v164, v165
    v_cvt_pk_bf16_f32 v187, v166, v167
    v_smfmac_f32_16x16x64_bf16 v[180:183], v[64:67], v[124:131], v72
    s_nop 0
    v_mfma_f32_16x16x32_bf16 v[200:203], v[184:187], v[184:187], 0
    s_waitcnt lgkmcnt(1)
    v_readfirstlane_b32 s91, v215
    v_mfma_f32_16x16x32_bf16 v[196:199], v[156:159], v[184:187], 0
    v_smfmac_f32_16x16x64_bf16 v[180:183], v[68:71], v[132:139], v72
    ds_write_b128 v205, v[188:191] offset:16384
    ds_write_b128 v205, v[192:195] offset:17408
    v_cvt_pk_bf16_f32 v188, v168, v169
    v_cvt_pk_bf16_f32 v189, v170, v171
    v_cvt_pk_bf16_f32 v190, v172, v173
    v_cvt_pk_bf16_f32 v191, v174, v175
    v_cvt_pk_bf16_f32 v192, v176, v177
    v_cvt_pk_bf16_f32 v193, v178, v179
    v_mfma_f32_16x16x32_bf16 v[200:203], v[188:191], v[188:191], v[200:203]
    v_cvt_pk_bf16_f32 v194, v180, v181
    v_cvt_pk_bf16_f32 v195, v182, v183
    v_mfma_f32_16x16x32_bf16 v[196:199], v[156:159], v[188:191], v[196:199]
    s_nop 0
    v_mfma_f32_16x16x32_bf16 v[200:203], v[192:195], v[192:195], v[200:203]
    v_mfma_f32_16x16x32_bf16 v[196:199], v[156:159], v[192:195], v[196:199]
    s_nop 3
    v_cndmask_b32 v223, v200, v201, s[62:63]
    v_cndmask_b32 v223, v223, v202, s[64:65]
    v_cndmask_b32 v223, v223, v203, s[66:67]
    ds_bpermute_b32 v225, v75, v223
    v_mul_f32 v221, v196, v196
    v_fmamk_f32 v221, v221, 0xb9c12dab, v204
    v_mul_f32 v222, 0xbc2aaaab, v196
    s_mov_b32 s6, s44
    s_mov_b64 exec, s[82:83]
    s_add_u32 m0, s55, 0xcc00
    s_add_u32 s41, s52, 0x30180
    buffer_load_dwordx4 v211, s[4:7], s41 offen nt lds
    s_add_u32 m0, s55, 0xce70
    s_add_u32 s41, s52, 0x480c0
    buffer_load_dwordx4 v211, s[4:7], s41 offen nt lds
    s_add_u32 m0, s55, 0xd0e0
    s_add_u32 s41, s52, 0x60000
    buffer_load_dwordx4 v211, s[4:7], s41 offen nt lds
    s_mov_b64 exec, -1
    s_waitcnt lgkmcnt(0)
    v_fmamk_f32 v223, v225, 0x3d10e240, v221
    v_mfma_f32_16x16x32_bf16 v[144:147], v[148:151], v[252:255], 0
    s_add_u32 s93, s93, 0x1010101
    s_sub_u32 s91, s91, s93
    s_andn2_b32 s91, 0x80808080, s91
    v_mfma_f32_16x16x32_bf16 v[100:103], v[152:155], v[252:255], 0
    s_cbranch_scc1 L_sw8
L_sb8:
    ds_read_b128 v[228:231], v207 offset:9216
    v_mfma_f32_16x16x32_bf16 v[104:107], v[148:151], v[140:143], 0
    ds_read_b128 v[232:235], v207 offset:10240
    ds_read_b128 v[236:239], v207 offset:11264
    v_mfma_f32_16x16x32_bf16 v[108:111], v[152:155], v[140:143], 0
    ds_read_b128 v[240:243], v207 offset:12288
    ds_read_b128 v[244:247], v207 offset:13312
    ds_read_b128 v[248:251], v207 offset:14336
    v_max_f32 v223, v223, v204
    v_rsq_f32 v221, v223
    s_add_u32 s58, s38, 7
    v_mul_f32 v222, v222, v221
    v_readlane_b32 s49, v224, s58
    v_fma_f32 v160, v160, v221, v222
    v_fma_f32 v161, v161, v221, v222
    v_fma_f32 v162, v162, v221, v222
    v_fma_f32 v163, v163, v221, v222
    v_cvt_pk_bf16_f32 v160, v160, v161
    s_cmp_lt_u32 s49, 0x40000000
    s_cselect_b32 s10, 0x2fd00c0, 0
    s_waitcnt lgkmcnt(5)
    v_mfma_f32_16x16x32_bf16 v[144:147], v[76:79], v[228:231], v[144:147]
    s_and_b32 s49, s49, 0x3fffffc0
    s_add_i32 s38, s38, 1
    v_cvt_pk_bf16_f32 v161, v162, v163
    s_waitcnt lgkmcnt(3)
    v_mfma_f32_16x16x32_bf16 v[144:147], v[80:83], v[232:235], v[144:147]
    v_fma_f32 v164, v164, v221, v222
    v_fma_f32 v165, v165, v221, v222
    v_mfma_f32_16x16x32_bf16 v[144:147], v[84:87], v[236:239], v[144:147]
    v_fma_f32 v166, v166, v221, v222
    v_fma_f32 v167, v167, v221, v222
    v_mfma_f32_16x16x32_bf16 v[100:103], v[88:91], v[228:231], v[100:103]
    v_cvt_pk_bf16_f32 v162, v164, v165
    v_cvt_pk_bf16_f32 v163, v166, v167
    v_mfma_f32_16x16x32_bf16 v[100:103], v[92:95], v[232:235], v[100:103]
    v_cvt_pk_bf16_f32 v144, v144, v145
    v_cvt_pk_bf16_f32 v145, v146, v147
    v_mfma_f32_16x16x32_bf16 v[100:103], v[96:99], v[236:239], v[100:103]
    s_waitcnt lgkmcnt(0)
    v_fma_f32 v168, v168, v221, v222
    v_fma_f32 v169, v169, v221, v222
    v_mfma_f32_16x16x32_bf16 v[104:107], v[76:79], v[240:243], v[104:107]
    v_fma_f32 v170, v170, v221, v222
    v_fma_f32 v171, v171, v221, v222
    v_mfma_f32_16x16x32_bf16 v[104:107], v[80:83], v[244:247], v[104:107]
    v_cvt_pk_bf16_f32 v146, v100, v101
    v_cvt_pk_bf16_f32 v147, v102, v103
    v_mfma_f32_16x16x32_bf16 v[104:107], v[84:87], v[248:251], v[104:107]
    v_cvt_pk_bf16_f32 v168, v168, v169
    v_cvt_pk_bf16_f32 v169, v170, v171
    v_mfma_f32_16x16x32_bf16 v[108:111], v[88:91], v[240:243], v[108:111]
    v_fma_f32 v172, v172, v221, v222
    v_fma_f32 v173, v173, v221, v222
    v_mfma_f32_16x16x32_bf16 v[108:111], v[92:95], v[244:247], v[108:111]
    v_cvt_pk_bf16_f32 v104, v104, v105
    v_cvt_pk_bf16_f32 v105, v106, v107
    v_mfma_f32_16x16x32_bf16 v[108:111], v[96:99], v[248:251], v[108:111]
    buffer_store_dwordx4 v[144:147], v217, s[8:11], s49 offen sc0 sc1
    ds_write_b128 v205, v[160:163] offset:24576
    s_nop 5
    v_cvt_pk_bf16_f32 v106, v108, v109
    v_cvt_pk_bf16_f32 v107, v110, v111
    v_fma_f32 v174, v174, v221, v222
    v_fma_f32 v175, v175, v221, v222
    v_cvt_pk_bf16_f32 v170, v172, v173
    v_cvt_pk_bf16_f32 v171, v174, v175
    v_fma_f32 v176, v176, v221, v222
    v_fma_f32 v177, v177, v221, v222
    v_fma_f32 v178, v178, v221, v222
    v_fma_f32 v179, v179, v221, v222
    v_cvt_pk_bf16_f32 v176, v176, v177
    v_cvt_pk_bf16_f32 v177, v178, v179
    v_fma_f32 v180, v180, v221, v222
    v_fma_f32 v181, v181, v221, v222
    v_fma_f32 v182, v182, v221, v222
    v_fma_f32 v183, v183, v221, v222
    v_cvt_pk_bf16_f32 v178, v180, v181
    v_cvt_pk_bf16_f32 v179, v182, v183
    buffer_store_dwordx4 v[104:107], v218, s[8:11], s49 offen sc0 sc1
    ds_write_b128 v205, v[168:171] offset:25600
    ds_write_b128 v205, v[176:179] offset:26624
    s_waitcnt vmcnt(11)
    ds_add_u32 v214, v214 offset:16
    s_add_u32 s92, s92, 0x39200
L_sp9:
    ds_read_b32 v215, v214 offset:16
    s_waitcnt lgkmcnt(0)
    v_readfirstlane_b32 s91, v215
    s_nop 1
    s_cmp_lt_u32 s91, s92
    s_nop 0
    s_cbranch_scc0 L_sq9
    s_sleep 1
    s_branch L_sp9
L_sq9:
    s_add_u32 s56, s38, 12
    v_readlane_b32 s46, v224, s56
    s_nop 1
    s_and_b32 s47, s46, 63
    s_cmp_lt_u32 s46, 0x40000000
    s_cselect_b32 s94, 0x2fe80c0, 0
    s_and_b32 s46, s46, 0x3fffffc0
    s_add_u32 s46, s46, s59
    s_cmp_eq_u32 s47, s48
    s_cbranch_scc1 L_cls8
    s_mov_b32 s48, s47
    s_and_b32 s40, s47, 8
    s_cselect_b64 s[84:85], s[76:77], 0
    v_or_b32 v227, 0x80000000, v211
    v_cndmask_b32 v209, v211, v227, s[84:85]
    s_and_b32 s40, s47, 16
    s_cselect_b64 s[84:85], s[78:79], 0
    v_or_b32 v227, 0x80000000, v212
    v_cndmask_b32 v210, v212, v227, s[84:85]
    s_nop 1
L_cls8:
    ds_read_b128 v[100:103], v73 offset:36896
    ds_read_b128 v[108:111], v73 offset:34816
    ds_read_b128 v[112:115], v73 offset:36688
    ds_read_b128 v[116:119], v73 offset:38560
    ds_read_b128 v[120:123], v74 offset:35232
    ds_read_b128 v[104:107], v73 offset:36912
    ds_read_b128 v[124:127], v73 offset:34832
    ds_read_b128 v[128:131], v73 offset:36704
    ds_read_b128 v[132:135], v73 offset:38576
    ds_read_b128 v[136:139], v74 offset:35248
    ds_read_b128 v[252:255], v208
    ds_read_b128 v[140:143], v206 offset:52224
    s_and_b32 s40, s47, s39
    s_cselect_b32 s6, 0, s94
    s_add_u32 m0, s53, 0x4400
    s_add_u32 s41, s46, 0
    buffer_load_dwordx4 v209, s[4:7], s41 offen nt lds
    s_add_u32 m0, s53, 0x4800
    s_mov_b64 exec, s[80:81]
    buffer_load_dwordx4 v210, s[4:7], s41 offen nt lds
    s_mov_b64 exec, -1
    s_waitcnt lgkmcnt(11)
    v_mfma_f32_16x16x32_bf16 v[160:163], v[0:3], v[100:103], 0
    s_mov_b32 s10, 0x2fd00c0
    ds_read_b128 v[100:103], v73 offset:36960
    s_waitcnt lgkmcnt(8)
    v_smfmac_f32_16x16x64_bf16 v[160:163], v[4:7], v[108:115], v72
    v_add_u32 v208, s50, v208
    v_smfmac_f32_16x16x64_bf16 v[160:163], v[8:11], v[116:123], v72
    ds_read_b128 v[108:111], v73 offset:34880
    ds_read_b128 v[112:115], v73 offset:36752
    s_waitcnt lgkmcnt(4)
    v_mfma_f32_16x16x32_bf16 v[164:167], v[12:15], v[104:107], 0
    ds_read_b128 v[116:119], v73 offset:38624
    ds_read_b128 v[120:123], v74 offset:35296
    v_smfmac_f32_16x16x64_bf16 v[164:167], v[16:19], v[124:131], v72
    ds_read_b128 v[104:107], v73 offset:36976
    v_smfmac_f32_16x16x64_bf16 v[164:167], v[20:23], v[132:139], v72
    ds_read_b128 v[124:127], v73 offset:34896
    ds_read_b128 v[128:131], v73 offset:36768
    ds_read_b128 v[132:135], v73 offset:38640
    ds_read_b128 v[136:139], v74 offset:35312
    s_waitcnt lgkmcnt(9)
    v_mfma_f32_16x16x32_bf16 v[168:171], v[24:27], v[100:103], 0
    ds_read_b128 v[100:103], v73 offset:37024
    s_mov_b32 s6, s94
    s_add_u32 m0, s53, 0x4b50
    s_add_u32 s41, s46, 0x17f40
    buffer_load_dwordx4 v209, s[4:7], s41 offen nt lds
    s_add_u32 m0, s53, 0x4f50
    s_mov_b64 exec, s[80:81]
    buffer_load_dwordx4 v210, s[4:7], s41 offen nt lds
    s_mov_b64 exec, -1
    s_waitcnt lgkmcnt(8)
    v_smfmac_f32_16x16x64_bf16 v[168:171], v[28:31], v[108:115], v72
    s_add_u32 s93, s93, 0x1010101
    s_waitcnt lgkmcnt(6)
    v_smfmac_f32_16x16x64_bf16 v[168:171], v[32:35], v[116:123], v72
    ds_read_b128 v[108:111], v73 offset:34944
    ds_read_b128 v[112:115], v73 offset:36816
    s_waitcnt lgkmcnt(5)
    v_mfma_f32_16x16x32_bf16 v[172:175], v[36:39], v[104:107], 0
    ds_read_b128 v[116:119], v73 offset:38688
    ds_read_b128 v[120:123], v74 offset:35360
    v_smfmac_f32_16x16x64_bf16 v[172:175], v[40:43], v[124:131], v72
    ds_read_b128 v[104:107], v73 offset:37040
    s_waitcnt lgkmcnt(5)
    v_smfmac_f32_16x16x64_bf16 v[172:175], v[44:47], v[132:139], v72
    ds_read_b128 v[124:127], v73 offset:34960
    ds_read_b128 v[128:131], v73 offset:36832
    v_mfma_f32_16x16x32_bf16 v[176:179], v[48:51], v[100:103], 0
    ds_read_b128 v[132:135], v73 offset:38704
    ds_read_b128 v[136:139], v74 offset:35376
    s_nop 5
    ds_read_b32 v215, v214 offset:20
    ds_write_b128 v205, v[184:187] offset:43008
    s_waitcnt lgkmcnt(9)
    v_smfmac_f32_16x16x64_bf16 v[176:179], v[52:55], v[108:115], v72
    s_waitcnt lgkmcnt(7)
    v_cvt_pk_bf16_f32 v184, v160, v161
    v_smfmac_f32_16x16x64_bf16 v[176:179], v[56:59], v[116:123], v72
    s_waitcnt lgkmcnt(6)
    v_cvt_pk_bf16_f32 v185, v162, v163
    v_mfma_f32_16x16x32_bf16 v[180:183], v[60:63], v[104:107], 0
    s_waitcnt lgkmcnt(4)
    v_cvt_pk_bf16_f32 v186, v164, v165
    v_cvt_pk_bf16_f32 v187, v166, v167
    v_smfmac_f32_16x16x64_bf16 v[180:183], v[64:67], v[124:131], v72
    s_nop 0
    v_mfma_f32_16x16x32_bf16 v[200:203], v[184:187], v[184:187], 0
    s_waitcnt lgkmcnt(1)
    v_readfirstlane_b32 s91, v215
    v_mfma_f32_16x16x32_bf16 v[196:199], v[156:159], v[184:187], 0
    v_smfmac_f32_16x16x64_bf16 v[180:183], v[68:71], v[132:139], v72
    ds_write_b128 v205, v[188:191] offset:44032
    ds_write_b128 v205, v[192:195] offset:45056
    v_cvt_pk_bf16_f32 v188, v168, v169
    v_cvt_pk_bf16_f32 v189, v170, v171
    v_cvt_pk_bf16_f32 v190, v172, v173
    v_cvt_pk_bf16_f32 v191, v174, v175
    v_cvt_pk_bf16_f32 v192, v176, v177
    v_cvt_pk_bf16_f32 v193, v178, v179
    v_mfma_f32_16x16x32_bf16 v[200:203], v[188:191], v[188:191], v[200:203]
    s_sub_u32 s91, s91, s93
    s_andn2_b32 s91, 0x80808080, s91
    s_cbranch_scc1 L_sw10
L_sb10:
    v_mfma_f32_16x16x32_bf16 v[196:199], v[156:159], v[188:191], v[196:199]
    ds_read_b128 v[228:231], v207 offset:27648
    ds_read_b128 v[232:235], v207 offset:28672
    ds_read_b128 v[236:239], v207 offset:29696
    ds_read_b128 v[240:243], v207 offset:18432
    ds_read_b128 v[244:247], v207 offset:19456
    ds_read_b128 v[248:251], v207 offset:20480
    v_cvt_pk_bf16_f32 v194, v180, v181
    v_cvt_pk_bf16_f32 v195, v182, v183
    s_sub_i32 s50, 0, s50
    s_add_u32 s58, s38, 5
    v_mfma_f32_16x16x32_bf16 v[200:203], v[192:195], v[192:195], v[200:203]
    s_lshl_b32 s58, s58, 2
    v_add_u32 v220, s58, v226
    s_add_u32 s58, s38, 7
    v_mfma_f32_16x16x32_bf16 v[196:199], v[156:159], v[192:195], v[196:199]
    ds_bpermute_b32 v220, v220, v224
    v_readlane_b32 s49, v224, s58
    s_nop 1
    v_cndmask_b32 v223, v200, v201, s[62:63]
    v_cndmask_b32 v223, v223, v202, s[64:65]
    v_cndmask_b32 v223, v223, v203, s[66:67]
    ds_bpermute_b32 v225, v75, v223
    v_mul_f32 v221, v196, v196
    v_fmamk_f32 v221, v221, 0xb9c12dab, v204
    v_mul_f32 v222, 0xbc2aaaab, v196
    s_cmp_lt_u32 s49, 0x40000000
    s_waitcnt lgkmcnt(1)
    v_and_b32 v220, 0x7fffffc0, v220
    v_add_u32 v220, v220, v219
    s_waitcnt lgkmcnt(0)
    v_fmamk_f32 v223, v225, 0x3d10e240, v221
    v_mfma_f32_16x16x32_bf16 v[144:147], v[148:151], v[252:255], 0
    v_max_f32 v223, v223, v204
    v_mfma_f32_16x16x32_bf16 v[144:147], v[76:79], v[228:231], v[144:147]
    v_rsq_f32 v221, v223
    v_mfma_f32_16x16x32_bf16 v[144:147], v[80:83], v[232:235], v[144:147]
    v_mul_f32 v222, v222, v221
    v_fma_f32 v160, v160, v221, v222
    v_mfma_f32_16x16x32_bf16 v[144:147], v[84:87], v[236:239], v[144:147]
    v_fma_f32 v161, v161, v221, v222
    v_fma_f32 v162, v162, v221, v222
    v_mfma_f32_16x16x32_bf16 v[100:103], v[152:155], v[252:255], 0
    v_fma_f32 v163, v163, v221, v222
    v_cvt_pk_bf16_f32 v160, v160, v161
    v_mfma_f32_16x16x32_bf16 v[100:103], v[88:91], v[228:231], v[100:103]
    v_cvt_pk_bf16_f32 v144, v144, v145
    v_cvt_pk_bf16_f32 v145, v146, v147
    v_mfma_f32_16x16x32_bf16 v[100:103], v[92:95], v[232:235], v[100:103]
    v_cvt_pk_bf16_f32 v161, v162, v163
    v_fma_f32 v164, v164, v221, v222
    v_mfma_f32_16x16x32_bf16 v[100:103], v[96:99], v[236:239], v[100:103]
    v_fma_f32 v165, v165, v221, v222
    v_fma_f32 v166, v166, v221, v222
    v_mfma_f32_16x16x32_bf16 v[104:107], v[148:151], v[140:143], 0
    v_fma_f32 v167, v167, v221, v222
    v_cvt_pk_bf16_f32 v162, v164, v165
    v_mfma_f32_16x16x32_bf16 v[104:107], v[76:79], v[240:243], v[104:107]
    v_cvt_pk_bf16_f32 v146, v100, v101
    v_cvt_pk_bf16_f32 v147, v102, v103
    v_mfma_f32_16x16x32_bf16 v[104:107], v[80:83], v[244:247], v[104:107]
    v_cvt_pk_bf16_f32 v163, v166, v167
    v_fma_f32 v168, v168, v221, v222
    v_mfma_f32_16x16x32_bf16 v[104:107], v[84:87], v[248:251], v[104:107]
    v_fma_f32 v169, v169, v221, v222
    v_fma_f32 v170, v170, v221, v222
    v_mfma_f32_16x16x32_bf16 v[108:111], v[152:155], v[140:143], 0
    v_fma_f32 v171, v171, v221, v222
    v_cvt_pk_bf16_f32 v168, v168, v169
    v_mfma_f32_16x16x32_bf16 v[108:111], v[88:91], v[240:243], v[108:111]
    v_cvt_pk_bf16_f32 v104, v104, v105
    v_cvt_pk_bf16_f32 v105, v106, v107
    v_mfma_f32_16x16x32_bf16 v[108:111], v[92:95], v[244:247], v[108:111]
    v_cvt_pk_bf16_f32 v169, v170, v171
    v_fma_f32 v172, v172, v221, v222
    v_mfma_f32_16x16x32_bf16 v[108:111], v[96:99], v[248:251], v[108:111]
    buffer_store_dwordx4 v[144:147], v220, s[8:11], 0 offen sc0 sc1
    s_cselect_b32 s10, 0x2fd00c0, 0
    s_and_b32 s49, s49, 0x3fffffc0
    ds_write_b128 v205, v[160:163] offset:33792
    s_nop 3
    v_cvt_pk_bf16_f32 v106, v108, v109
    v_cvt_pk_bf16_f32 v107, v110, v111
    v_fma_f32 v173, v173, v221, v222
    v_fma_f32 v174, v174, v221, v222
    v_fma_f32 v175, v175, v221, v222
    v_cvt_pk_bf16_f32 v170, v172, v173
    v_cvt_pk_bf16_f32 v171, v174, v175
    v_fma_f32 v176, v176, v221, v222
    v_fma_f32 v177, v177, v221, v222
    v_fma_f32 v178, v178, v221, v222
    v_fma_f32 v179, v179, v221, v222
    v_cvt_pk_bf16_f32 v176, v176, v177
    v_cvt_pk_bf16_f32 v177, v178, v179
    v_fma_f32 v180, v180, v221, v222
    v_fma_f32 v181, v181, v221, v222
    v_fma_f32 v182, v182, v221, v222
    v_fma_f32 v183, v183, v221, v222
    v_cvt_pk_bf16_f32 v178, v180, v181
    v_cvt_pk_bf16_f32 v179, v182, v183
    s_add_i32 s38, s38, 1
    buffer_store_dwordx4 v[104:107], v217, s[8:11], s49 offen sc0 sc1
    ds_write_b128 v205, v[168:171] offset:34816
    ds_write_b128 v205, v[176:179] offset:35840
    s_waitcnt vmcnt(8)
    ds_add_u32 v214, v214 offset:16
    s_add_u32 s37, s37, 1
    s_cmp_lt_u32 s37, 6
    s_cbranch_scc1 L_Tiloop
    s_add_u32 s92, s92, 0x39200
L_sp11:
    ds_read_b32 v215, v214 offset:16
    s_waitcnt lgkmcnt(0)
    v_readfirstlane_b32 s91, v215
    s_nop 1
    s_cmp_lt_u32 s91, s92
    s_nop 0
    s_cbranch_scc0 L_sq11
    s_sleep 1
    s_branch L_sp11
L_sq11:
    ds_read_b32 v215, v214 offset:20
    ds_read_b128 v[252:255], v206 offset:15360
    ds_read_b128 v[140:143], v206 offset:18432
    ds_write_b128 v205, v[184:187] offset:52224
    ds_write_b128 v205, v[188:191] offset:53248
    ds_write_b128 v205, v[192:195] offset:54272
    s_add_u32 s93, s93, 0x1010101
    s_waitcnt lgkmcnt(5)
    v_readfirstlane_b32 s91, v215
    s_waitcnt lgkmcnt(4)
    v_mfma_f32_16x16x32_bf16 v[144:147], v[148:151], v[252:255], 0
    v_mfma_f32_16x16x32_bf16 v[100:103], v[152:155], v[252:255], 0
    s_sub_u32 s91, s91, s93
    s_andn2_b32 s91, 0x80808080, s91
    s_cbranch_scc1 L_sw12
L_sb12:
    s_waitcnt lgkmcnt(3)
    v_mfma_f32_16x16x32_bf16 v[104:107], v[148:151], v[140:143], 0
    ds_read_b128 v[228:231], v207
    ds_read_b128 v[232:235], v207 offset:1024
    v_mfma_f32_16x16x32_bf16 v[108:111], v[152:155], v[140:143], 0
    ds_read_b128 v[236:239], v207 offset:2048
    ds_read_b128 v[240:243], v207 offset:3072
    ds_read_b128 v[244:247], v207 offset:4096
    ds_read_b128 v[248:251], v207 offset:5120
    s_add_u32 s58, s38, 7
    v_readlane_b32 s49, v224, s58
    s_nop 1
    s_cmp_lt_u32 s49, 0x40000000
    s_cselect_b32 s10, 0x2fd00c0, 0
    s_and_b32 s49, s49, 0x3fffffc0
    s_add_i32 s38, s38, 1
    s_waitcnt lgkmcnt(5)
    v_mfma_f32_16x16x32_bf16 v[144:147], v[76:79], v[228:231], v[144:147]
    s_waitcnt lgkmcnt(4)
    v_mfma_f32_16x16x32_bf16 v[144:147], v[80:83], v[232:235], v[144:147]
    s_waitcnt lgkmcnt(3)
    v_mfma_f32_16x16x32_bf16 v[144:147], v[84:87], v[236:239], v[144:147]
    v_mfma_f32_16x16x32_bf16 v[100:103], v[88:91], v[228:231], v[100:103]
    v_mfma_f32_16x16x32_bf16 v[100:103], v[92:95], v[232:235], v[100:103]
    v_cvt_pk_bf16_f32 v144, v144, v145
    v_cvt_pk_bf16_f32 v145, v146, v147
    v_mfma_f32_16x16x32_bf16 v[100:103], v[96:99], v[236:239], v[100:103]
    s_waitcnt lgkmcnt(2)
    v_mfma_f32_16x16x32_bf16 v[104:107], v[76:79], v[240:243], v[104:107]
    s_waitcnt lgkmcnt(0)
    v_mfma_f32_16x16x32_bf16 v[104:107], v[80:83], v[244:247], v[104:107]
    v_cvt_pk_bf16_f32 v146, v100, v101
    v_cvt_pk_bf16_f32 v147, v102, v103
    v_mfma_f32_16x16x32_bf16 v[104:107], v[84:87], v[248:251], v[104:107]
    v_mfma_f32_16x16x32_bf16 v[108:111], v[88:91], v[240:243], v[108:111]
    v_mfma_f32_16x16x32_bf16 v[108:111], v[92:95], v[244:247], v[108:111]
    v_cvt_pk_bf16_f32 v104, v104, v105
    v_cvt_pk_bf16_f32 v105, v106, v107
    v_mfma_f32_16x16x32_bf16 v[108:111], v[96:99], v[248:251], v[108:111]
    buffer_store_dwordx4 v[144:147], v217, s[8:11], s49 offen sc0 sc1
    s_nop 6
    v_cvt_pk_bf16_f32 v106, v108, v109
    v_cvt_pk_bf16_f32 v107, v110, v111
    buffer_store_dwordx4 v[104:107], v218, s[8:11], s49 offen sc0 sc1
    ds_add_u32 v214, v214 offset:16
    s_add_u32 s92, s92, 0x39200
L_sp13:
    ds_read_b32 v215, v214 offset:16
    s_waitcnt lgkmcnt(0)
    v_readfirstlane_b32 s91, v215
    s_nop 1
    s_cmp_lt_u32 s91, s92
    s_nop 0
    s_cbranch_scc0 L_sq13
    s_sleep 1
    s_branch L_sp13
L_sq13:
    ds_read_b32 v215, v214 offset:20
    ds_read_b128 v[252:255], v206 offset:43008
    ds_read_b128 v[140:143], v206 offset:46080
    s_add_u32 s93, s93, 0x1010101
    s_waitcnt lgkmcnt(2)
    v_readfirstlane_b32 s91, v215
    s_waitcnt lgkmcnt(1)
    v_mfma_f32_16x16x32_bf16 v[144:147], v[148:151], v[252:255], 0
    v_mfma_f32_16x16x32_bf16 v[100:103], v[152:155], v[252:255], 0
    s_sub_u32 s91, s91, s93
    s_andn2_b32 s91, 0x80808080, s91
    s_cbranch_scc1 L_sw14
L_sb14:
    s_waitcnt lgkmcnt(0)
    v_mfma_f32_16x16x32_bf16 v[104:107], v[148:151], v[140:143], 0
    ds_read_b128 v[228:231], v207 offset:9216
    ds_read_b128 v[232:235], v207 offset:10240
    v_mfma_f32_16x16x32_bf16 v[108:111], v[152:155], v[140:143], 0
    ds_read_b128 v[236:239], v207 offset:11264
    ds_read_b128 v[240:243], v207 offset:12288
    ds_read_b128 v[244:247], v207 offset:13312
    ds_read_b128 v[248:251], v207 offset:14336
    s_add_u32 s58, s38, 7
    v_readlane_b32 s49, v224, s58
    s_nop 1
    s_cmp_lt_u32 s49, 0x40000000
    s_cselect_b32 s10, 0x2fd00c0, 0
    s_and_b32 s49, s49, 0x3fffffc0
    s_add_i32 s38, s38, 1
    s_waitcnt lgkmcnt(5)
    v_mfma_f32_16x16x32_bf16 v[144:147], v[76:79], v[228:231], v[144:147]
    s_waitcnt lgkmcnt(4)
    v_mfma_f32_16x16x32_bf16 v[144:147], v[80:83], v[232:235], v[144:147]
    s_waitcnt lgkmcnt(3)
    v_mfma_f32_16x16x32_bf16 v[144:147], v[84:87], v[236:239], v[144:147]
    v_mfma_f32_16x16x32_bf16 v[100:103], v[88:91], v[228:231], v[100:103]
    v_mfma_f32_16x16x32_bf16 v[100:103], v[92:95], v[232:235], v[100:103]
    v_cvt_pk_bf16_f32 v144, v144, v145
    v_cvt_pk_bf16_f32 v145, v146, v147
    v_mfma_f32_16x16x32_bf16 v[100:103], v[96:99], v[236:239], v[100:103]
    s_waitcnt lgkmcnt(2)
    v_mfma_f32_16x16x32_bf16 v[104:107], v[76:79], v[240:243], v[104:107]
    s_waitcnt lgkmcnt(0)
    v_mfma_f32_16x16x32_bf16 v[104:107], v[80:83], v[244:247], v[104:107]
    v_cvt_pk_bf16_f32 v146, v100, v101
    v_cvt_pk_bf16_f32 v147, v102, v103
    v_mfma_f32_16x16x32_bf16 v[104:107], v[84:87], v[248:251], v[104:107]
    v_mfma_f32_16x16x32_bf16 v[108:111], v[88:91], v[240:243], v[108:111]
    v_mfma_f32_16x16x32_bf16 v[108:111], v[92:95], v[244:247], v[108:111]
    v_cvt_pk_bf16_f32 v104, v104, v105
    v_cvt_pk_bf16_f32 v105, v106, v107
    v_mfma_f32_16x16x32_bf16 v[108:111], v[96:99], v[248:251], v[108:111]
    buffer_store_dwordx4 v[144:147], v217, s[8:11], s49 offen sc0 sc1
    s_nop 6
    v_cvt_pk_bf16_f32 v106, v108, v109
    v_cvt_pk_bf16_f32 v107, v110, v111
    buffer_store_dwordx4 v[104:107], v218, s[8:11], s49 offen sc0 sc1
    ds_add_u32 v214, v214 offset:16
    ds_read_b32 v215, v214 offset:20
    ds_read_b128 v[252:255], v208
    ds_read_b128 v[140:143], v206 offset:52224
    ds_read_b128 v[124:127], v206 offset:55296
    s_add_u32 s93, s93, 0x1010101
    v_add_u32 v208, s50, v208
    s_mov_b32 s10, 0x2fd00c0
    v_mov_b32 v227, 0xe480
    s_waitcnt lgkmcnt(3)
    v_readfirstlane_b32 s91, v215
    s_waitcnt lgkmcnt(2)
    v_mfma_f32_16x16x32_bf16 v[144:147], v[148:151], v[252:255], 0
    v_mfma_f32_16x16x32_bf16 v[100:103], v[152:155], v[252:255], 0
    s_sub_u32 s91, s91, s93
    s_andn2_b32 s91, 0x80808080, s91
    s_cbranch_scc1 L_sw15
L_sb15:
    s_waitcnt lgkmcnt(1)
    v_mfma_f32_16x16x32_bf16 v[104:107], v[148:151], v[140:143], 0
    ds_read_b128 v[228:231], v207 offset:27648
    ds_read_b128 v[232:235], v207 offset:28672
    v_mfma_f32_16x16x32_bf16 v[108:111], v[152:155], v[140:143], 0
    ds_read_b128 v[236:239], v207 offset:29696
    ds_read_b128 v[240:243], v207 offset:18432
    s_waitcnt lgkmcnt(4)
    v_mfma_f32_16x16x32_bf16 v[128:131], v[148:151], v[124:127], 0
    ds_read_b128 v[244:247], v207 offset:19456
    ds_read_b128 v[248:251], v207 offset:20480
    v_mfma_f32_16x16x32_bf16 v[132:135], v[152:155], v[124:127], 0
    ds_read_b128 v[112:115], v207 offset:21504
    ds_read_b128 v[116:119], v207 offset:22528
    ds_read_b128 v[120:123], v207 offset:23552
    s_sub_i32 s50, 0, s50
    s_add_u32 s58, s38, 5
    s_lshl_b32 s58, s58, 2
    v_add_u32 v220, s58, v226
    s_add_u32 s58, s38, 7
    ds_bpermute_b32 v220, v220, v224
    v_readlane_b32 s49, v224, s58
    s_waitcnt lgkmcnt(9)
    v_mfma_f32_16x16x32_bf16 v[144:147], v[76:79], v[228:231], v[144:147]
    s_waitcnt lgkmcnt(8)
    v_mfma_f32_16x16x32_bf16 v[144:147], v[80:83], v[232:235], v[144:147]
    s_cmp_lt_u32 s49, 0x40000000
    s_waitcnt lgkmcnt(6)
    v_mfma_f32_16x16x32_bf16 v[144:147], v[84:87], v[236:239], v[144:147]
    v_mfma_f32_16x16x32_bf16 v[100:103], v[88:91], v[228:231], v[100:103]
    v_mfma_f32_16x16x32_bf16 v[100:103], v[92:95], v[232:235], v[100:103]
    v_cvt_pk_bf16_f32 v144, v144, v145
    v_cvt_pk_bf16_f32 v145, v146, v147
    v_mfma_f32_16x16x32_bf16 v[100:103], v[96:99], v[236:239], v[100:103]
    s_waitcnt lgkmcnt(0)
    v_and_b32 v220, 0x7fffffc0, v220
    v_add_u32 v220, v220, v219
    v_mfma_f32_16x16x32_bf16 v[104:107], v[76:79], v[240:243], v[104:107]
    v_mfma_f32_16x16x32_bf16 v[104:107], v[80:83], v[244:247], v[104:107]
    v_cvt_pk_bf16_f32 v146, v100, v101
    v_cvt_pk_bf16_f32 v147, v102, v103
    v_mfma_f32_16x16x32_bf16 v[104:107], v[84:87], v[248:251], v[104:107]
    v_mfma_f32_16x16x32_bf16 v[108:111], v[88:91], v[240:243], v[108:111]
    v_mfma_f32_16x16x32_bf16 v[108:111], v[92:95], v[244:247], v[108:111]
    v_cvt_pk_bf16_f32 v104, v104, v105
    v_cvt_pk_bf16_f32 v105, v106, v107
    v_mfma_f32_16x16x32_bf16 v[108:111], v[96:99], v[248:251], v[108:111]
    v_mfma_f32_16x16x32_bf16 v[128:131], v[76:79], v[112:115], v[128:131]
    v_mfma_f32_16x16x32_bf16 v[128:131], v[80:83], v[116:119], v[128:131]
    v_cvt_pk_bf16_f32 v106, v108, v109
    v_cvt_pk_bf16_f32 v107, v110, v111
    v_mfma_f32_16x16x32_bf16 v[128:131], v[84:87], v[120:123], v[128:131]
    v_mfma_f32_16x16x32_bf16 v[132:135], v[88:91], v[112:115], v[132:135]
    v_mfma_f32_16x16x32_bf16 v[132:135], v[92:95], v[116:119], v[132:135]
    v_cvt_pk_bf16_f32 v128, v128, v129
    v_cvt_pk_bf16_f32 v129, v130, v131
    v_mfma_f32_16x16x32_bf16 v[132:135], v[96:99], v[120:123], v[132:135]
    buffer_store_dwordx4 v[144:147], v220, s[8:11], 0 offen sc0 sc1
    s_cselect_b32 s10, 0x2fd00c0, 0
    s_and_b32 s49, s49, 0x3fffffc0
    buffer_store_dwordx4 v[104:107], v217, s[8:11], s49 offen sc0 sc1
    s_nop 3
    v_cvt_pk_bf16_f32 v130, v132, v133
    v_cvt_pk_bf16_f32 v131, v134, v135
    buffer_store_dwordx4 v[128:131], v218, s[8:11], s49 offen sc0 sc1
    s_waitcnt lgkmcnt(0)
    s_barrier
    ds_read_b32 v223, v227
    s_waitcnt lgkmcnt(0)
    v_cmp_ne_u32 vcc, 0, v223
    s_cmp_lg_u32 s36, 0
    s_nop 2
    s_cbranch_scc1 L_Tiend
    s_cbranch_vccz L_Tiend
    s_mov_b32 s36, 1
    s_waitcnt vmcnt(0)
    s_mov_b32 s38, -4
    s_add_u32 s56, s38, 12
    v_readlane_b32 s46, v224, s56
    s_nop 1
    s_and_b32 s47, s46, 63
    s_cmp_lt_u32 s46, 0x40000000
    s_cselect_b32 s94, 0x2fe80c0, 0
    s_and_b32 s46, s46, 0x3fffffc0
    s_add_u32 s46, s46, s59
    s_cmp_eq_u32 s47, s48
    s_cbranch_scc1 L_cls9
    s_mov_b32 s48, s47
    s_and_b32 s40, s47, 8
    s_cselect_b64 s[84:85], s[76:77], 0
    v_or_b32 v227, 0x80000000, v211
    v_cndmask_b32 v209, v211, v227, s[84:85]
    s_and_b32 s40, s47, 16
    s_cselect_b64 s[84:85], s[78:79], 0
    v_or_b32 v227, 0x80000000, v212
    v_cndmask_b32 v210, v212, v227, s[84:85]
    s_nop 1
L_cls9:
    s_and_b32 s40, s47, s39
    s_cselect_b32 s6, 0, s94
    s_add_u32 m0, s53, 0
    s_add_u32 s41, s46, 0
    buffer_load_dwordx4 v209, s[4:7], s41 offen nt lds
    s_add_u32 m0, s53, 0x400
    s_mov_b64 exec, s[80:81]
    buffer_load_dwordx4 v210, s[4:7], s41 offen nt lds
    s_mov_b64 exec, -1
    s_mov_b32 s6, s94
    s_add_u32 m0, s53, 0x750
    s_add_u32 s41, s46, 0x17f40
    buffer_load_dwordx4 v209, s[4:7], s41 offen nt lds
    s_add_u32 m0, s53, 0xb50
    s_mov_b64 exec, s[80:81]
    buffer_load_dwordx4 v210, s[4:7], s41 offen nt lds
    s_mov_b64 exec, -1
    s_add_u32 s57, s38, s54
    s_add_u32 s57, s57, 12
    v_readlane_b32 s52, v224, s57
    s_nop 1
    s_cmp_lt_u32 s52, 0x40000000
    s_cselect_b32 s44, 0x2fe80c0, 0
    s_and_b32 s52, s52, 0x3fffffc0
    s_mov_b32 s6, s44
    s_mov_b64 exec, s[82:83]
    s_add_u32 m0, s55, 0xcc00
    s_add_u32 s41, s52, 0x30180
    buffer_load_dwordx4 v211, s[4:7], s41 offen nt lds
    s_add_u32 m0, s55, 0xce70
    s_add_u32 s41, s52, 0x480c0
    buffer_load_dwordx4 v211, s[4:7], s41 offen nt lds
    s_add_u32 m0, s55, 0xd0e0
    s_add_u32 s41, s52, 0x60000
    buffer_load_dwordx4 v211, s[4:7], s41 offen nt lds
    s_mov_b64 exec, -1
    v_add_u32 v208, 0xc00, v206
    s_mov_b32 s50, 0xe400
    s_waitcnt lgkmcnt(0) vmcnt(0)
    s_barrier
    s_branch L_Tistart
L_Tiend:
    s_endpgm
L_sw6:
    s_sleep 2
    ds_read_b32 v215, v214 offset:20
    s_waitcnt lgkmcnt(0)
    v_readfirstlane_b32 s91, v215
    s_nop 1
    s_sub_u32 s91, s91, s93
    s_andn2_b32 s91, 0x80808080, s91
    s_cbranch_scc1 L_sw6
    s_branch L_sb6
L_sw8:
    s_sleep 2
    ds_read_b32 v215, v214 offset:20
    s_waitcnt lgkmcnt(0)
    v_readfirstlane_b32 s91, v215
    s_nop 1
    s_sub_u32 s91, s91, s93
    s_andn2_b32 s91, 0x80808080, s91
    s_cbranch_scc1 L_sw8
    s_branch L_sb8
L_sw10:
    s_sleep 2
    ds_read_b32 v215, v214 offset:20
    s_waitcnt lgkmcnt(0)
    v_readfirstlane_b32 s91, v215
    s_nop 1
    s_sub_u32 s91, s91, s93
    s_andn2_b32 s91, 0x80808080, s91
    s_cbranch_scc1 L_sw10
    s_branch L_sb10
L_sw12:
    s_sleep 2
    ds_read_b32 v215, v214 offset:20
    s_waitcnt lgkmcnt(0)
    v_readfirstlane_b32 s91, v215
    s_nop 1
    s_sub_u32 s91, s91, s93
    s_andn2_b32 s91, 0x80808080, s91
    s_cbranch_scc1 L_sw12
    s_branch L_sb12
L_sw14:
    s_sleep 2
    ds_read_b32 v215, v214 offset:20
    s_waitcnt lgkmcnt(0)
    v_readfirstlane_b32 s91, v215
    s_nop 1
    s_sub_u32 s91, s91, s93
    s_andn2_b32 s91, 0x80808080, s91
    s_cbranch_scc1 L_sw14
    s_branch L_sb14
L_sw15:
    s_sleep 2
    ds_read_b32 v215, v214 offset:20
    s_waitcnt lgkmcnt(0)
    v_readfirstlane_b32 s91, v215
    s_nop 1
    s_sub_u32 s91, s91, s93
    s_andn2_b32 s91, 0x80808080, s91
    s_cbranch_scc1 L_sw15
    s_branch L_sb15
L_T3:
    s_setprio 1
    s_sub_u32 s54, s30, 4
    s_mul_i32 s40, s31, 0x382
    s_lshr_b32 s40, s40, 16
    s_mul_i32 s41, s40, 0x49
    s_sub_u32 s41, s31, s41
    s_mul_i32 s33, s40, 21
    s_mul_i32 s42, s41, 21
    s_cmp_eq_u32 s40, 3
    s_cselect_b32 s32, 0, s41
    s_cselect_b32 s34, s42, 0
    s_cselect_b32 s35, 0x199a, 0
    v_subrev_u32 v233, 8, v255
    v_and_b32 v230, 31, v233
    v_lshlrev_b32 v230, 8, v230
    v_add_u32 v230, s31, v230
    v_mul_u32_u24 v231, 0xe071, v230
    v_lshrrev_b32 v231, 22, v231
    v_mul_u32_u24 v232, 0x49, v231
    v_sub_u32 v230, v230, v232
    v_mul_u32_u24 v232, 0xa7ac0, v231
    v_mul_u32_u24 v236, 0x540, v230
    v_add3_u32 v224, v232, v236, 4
    v_cmp_eq_u32 s[60:61], 0, v231
    v_cmp_eq_u32 s[64:65], 0, v230
    s_movk_i32 s40, 0x48
    v_cmp_eq_u32 s[62:63], s40, v231
    v_cmp_eq_u32 s[66:67], s40, v230
    v_cmp_gt_u32 s[68:69], 21, v233
    v_cmp_ge_u32 s[70:71], s40, v231
    v_cndmask_b32 v232, 0, 1, s[60:61]
    v_cndmask_b32 v236, 0, 2, s[62:63]
    v_or3_b32 v224, v224, v232, v236
    v_cndmask_b32 v232, 0, 8, s[64:65]
    v_cndmask_b32 v236, 0, 16, s[66:67]
    v_or3_b32 v224, v224, v232, v236
    s_and_b64 s[68:69], s[68:69], s[70:71]
    v_mov_b32 v232, 0x40000004
    v_cndmask_b32 v224, v232, v224, s[68:69]
    v_add_u32 v233, 0, v255
    v_mul_u32_u24 v236, 0x13b2, v233
    v_lshrrev_b32 v236, 16, v236
    v_sub_u32 v230, v233, v236
    v_lshlrev_b32 v230, 4, v230
    s_mov_b32 s84, 0x2001000
    s_mov_b32 s85, 0x80040
    v_or_b32 v231, 0x80000000, v230
    v_cndmask_b32 v211, v230, v231, s[84:85]
    v_add_u32 v233, 64, v255
    v_mul_u32_u24 v236, 0x13b2, v233
    v_lshrrev_b32 v236, 16, v236
    v_sub_u32 v230, v233, v236
    v_lshlrev_b32 v230, 4, v230
    s_mov_b32 s84, 0x4002001
    s_mov_b32 s85, 0x100080
    v_or_b32 v231, 0x80000000, v230
    v_cndmask_b32 v212, v230, v231, s[84:85]
    s_mov_b32 s76, 0x1fff
    s_mov_b32 s77, 0
    s_mov_b32 s78, 0
    s_mov_b32 s79, 0xffffff00
    s_mov_b32 s80, 0xffffffff
    s_mov_b32 s81, 0x1fffff
    s_mov_b32 s82, 0xffffffff
    s_mov_b32 s83, 0x7f
    s_mul_i32 s59, s54, 0x2fe80
    s_mul_i32 s53, s54, 0xea0
    s_mul_i32 s55, s54, 0x840
    s_mov_b32 s48, 4
    v_mov_b32 v209, v211
    v_mov_b32 v210, v212
    s_mov_b32 s39, 2
    v_lshlrev_b32 v234, 4, v255
    s_waitcnt lgkmcnt(0)
    s_sub_u32 s4, s16, 0x18000
    s_subb_u32 s5, s17, 0
    s_mov_b32 s6, 0x2fe80c0
    s_mov_b32 s7, 0x20000
    s_mov_b32 s12, s18
    s_mov_b32 s13, s19
    s_mov_b32 s14, 0x6c0
    s_lshl_b32 s45, s54, 11
    s_add_u32 s45, s45, 0x8800
    s_mov_b32 m0, s45
    s_nop 0
    buffer_load_dwordx4 v234, s[12:15], 0 offen lds
    buffer_load_dwordx4 v234, s[12:15], 0 offen offset:1024 lds
    s_mov_b32 s38, -4
    s_add_u32 s56, s38, 12
    v_readlane_b32 s46, v224, s56
    s_nop 1
    s_and_b32 s47, s46, 63
    s_cmp_lt_u32 s46, 0x40000000
    s_cselect_b32 s94, 0x2fe80c0, 0
    s_and_b32 s46, s46, 0x3fffffc0
    s_add_u32 s46, s46, s59
    s_cmp_eq_u32 s47, s48
    s_cbranch_scc1 L_cls10
    s_mov_b32 s48, s47
    s_and_b32 s40, s47, 8
    s_cselect_b64 s[84:85], s[76:77], 0
    v_or_b32 v227, 0x80000000, v211
    v_cndmask_b32 v209, v211, v227, s[84:85]
    s_and_b32 s40, s47, 16
    s_cselect_b64 s[84:85], s[78:79], 0
    v_or_b32 v227, 0x80000000, v212
    v_cndmask_b32 v210, v212, v227, s[84:85]
    s_nop 1
L_cls10:
    s_mov_b32 s6, s94
    s_add_u32 m0, s53, 0
    s_add_u32 s41, s46, 0
    buffer_load_dwordx4 v209, s[4:7], s41 offen nt lds
    s_add_u32 m0, s53, 0x400
    s_mov_b64 exec, s[80:81]
    buffer_load_dwordx4 v210, s[4:7], s41 offen nt lds
    s_mov_b64 exec, -1
    s_mov_b32 s6, s94
    s_add_u32 m0, s53, 0x750
    s_add_u32 s41, s46, 0x17f40
    buffer_load_dwordx4 v209, s[4:7], s41 offen nt lds
    s_add_u32 m0, s53, 0xb50
    s_mov_b64 exec, s[80:81]
    buffer_load_dwordx4 v210, s[4:7], s41 offen nt lds
    s_mov_b64 exec, -1
    s_and_b32 s40, s47, s39
    s_cselect_b32 s6, 0, s94
    s_add_u32 m0, s53, 0xea0
    s_add_u32 s41, s46, 0x2fe80
    buffer_load_dwordx4 v209, s[4:7], s41 offen nt lds
    s_add_u32 m0, s53, 0x12a0
    s_mov_b64 exec, s[80:81]
    buffer_load_dwordx4 v210, s[4:7], s41 offen nt lds
    s_mov_b64 exec, -1
    s_waitcnt lgkmcnt(0)
    s_barrier
    s_mov_b32 s8, s24
    s_mov_b32 s9, s25
    s_mov_b32 s10, 0x2fd00c0
    s_mov_b32 s11, 0x20000
    v_lshrrev_b32 v228, 4, v255
    v_and_b32 v229, 15, v255
    v_lshlrev_b32 v235, 2, v229
    v_lshrrev_b32 v230, 3, v229
    v_lshlrev_b32 v230, 3, v230
    v_add_u32 v230, v230, v229
    v_lshlrev_b32 v230, 1, v230
    v_add_u32 v230, s45, v230
    v_lshlrev_b32 v232, 2, v228
    v_add_u32 v240, 0x3c0, v230
    s_mov_b32 s40, 0x4310
    v_bfe_u32 v231, s40, v232, 4
    v_mul_u32_u24 v231, 0xc0, v231
    v_add_u32 v241, v230, v231
    s_mov_b32 s40, 0x8276
    v_bfe_u32 v231, s40, v232, 4
    v_mul_u32_u24 v231, 0xc0, v231
    v_add_u32 v242, v230, v231
    v_and_b32 v230, 3, v229
    v_mul_u32_u24 v72, 0x5555, v230
    v_lshrrev_b32 v230, 2, v229
    v_lshlrev_b32 v226, 2, v230
    v_lshl_add_u32 v230, v230, 4, v229
    v_lshlrev_b32 v75, 2, v230
    v_mov_b32 v204, 0x380e6d33
    v_mov_b32 v156, 0x3f803f80
    v_mov_b32 v157, 0x3f803f80
    v_mov_b32 v158, 0x3f803f80
    v_mov_b32 v159, 0x3f803f80
    v_add_u32 v207, 0x1e0c0, v234
    s_mov_b64 s[88:89], 1
    v_mov_b32 v230, 0xf00000
    v_mov_b32 v214, 0xe480
    v_cndmask_b32 v214, v230, v214, s[88:89]
    v_and_b32 v230, 1, v228
    v_lshlrev_b32 v230, 5, v230
    v_lshrrev_b32 v231, 1, v228
    v_lshrrev_b32 v232, 2, v229
    v_min_u32 v232, 2, v232
    v_mul_u32_u24 v232, 0x840, v232
    v_add_u32 v230, v230, v232
    s_mov_b32 s84, 0x1110111
    s_mov_b32 s85, s84
    v_mov_b32 v232, 0xf00000
    v_cndmask_b32 v230, v232, v230, s[84:85]
    v_mul_u32_u24 v232, 0xd0, v231
    v_add_u32 v73, v230, v232
    v_mul_u32_u24 v232, 0x4e0, v231
    v_add_u32 v74, v230, v232
    v_add_u32 v205, 0xe4c0, v234
    v_add_u32 v208, 0xc00, v205
    s_mov_b32 s50, 0xe400
    v_lshlrev_b32 v233, 4, v228
    s_mov_b32 s84, 0x33223322
    s_mov_b32 s85, 0x44434433
    s_mov_b32 s86, 0x20313120
    s_mov_b32 s87, 0x64255364
    v_lshrrev_b64 v[250:251], v235, s[84:85]
    v_and_b32 v237, 7, v250
    v_lshrrev_b64 v[250:251], v235, s[86:87]
    v_and_b32 v238, 7, v250
    v_mul_u32_u24 v230, 0x17f40, v237
    v_mul_u32_u24 v231, 0xc0, v238
    v_add3_u32 v217, v230, v231, v233
    s_mov_b32 s84, 0x55545554
    s_mov_b32 s85, 0x66666665
    s_mov_b32 s86, 0x42015310
    s_mov_b32 s87, 0x64205316
    v_lshrrev_b64 v[250:251], v235, s[84:85]
    v_and_b32 v237, 7, v250
    v_lshrrev_b64 v[250:251], v235, s[86:87]
    v_and_b32 v238, 7, v250
    v_mul_u32_u24 v230, 0x17f40, v237
    v_mul_u32_u24 v231, 0xc0, v238
    v_add3_u32 v218, v230, v231, v233
    v_and_b32 v230, 1, v229
    v_lshlrev_b32 v230, 4, v230
    v_mov_b32 v231, 0x3f80
    v_lshlrev_b32 v231, v230, v231
    s_mov_b32 s84, 3
    s_mov_b32 s85, 0x300
    v_cndmask_b32 v148, 0, v231, s[84:85]
    s_mov_b32 s84, 12
    s_mov_b32 s85, 0xc00
    v_cndmask_b32 v149, 0, v231, s[84:85]
    s_mov_b32 s84, 48
    s_mov_b32 s85, 0x3000
    v_cndmask_b32 v150, 0, v231, s[84:85]
    s_mov_b32 s84, 0xc0
    s_mov_b32 s85, 0xc000
    v_cndmask_b32 v151, 0, v231, s[84:85]
    s_mov_b32 s84, 0x30000
    s_mov_b32 s85, 0x3000000
    v_cndmask_b32 v152, 0, v231, s[84:85]
    s_mov_b32 s84, 0xc0000
    s_mov_b32 s85, 0xc000000
    v_cndmask_b32 v153, 0, v231, s[84:85]
    s_mov_b32 s84, 0x300000
    s_mov_b32 s85, 0x30000000
    v_cndmask_b32 v154, 0, v231, s[84:85]
    s_mov_b32 s84, 0xc00000
    s_mov_b32 s85, 0xc0000000
    v_cndmask_b32 v155, 0, v231, s[84:85]
    v_lshrrev_b32 v243, 2, v229
    v_and_b32 v244, 3, v229
    v_lshlrev_b32 v244, 4, v244
    v_add_u32 v244, 0x228c0, v244
    v_lshl_add_u32 v232, v228, 2, v243
    v_mul_u32_u24 v232, 0xc0, v232
    v_add_u32 v76, v232, v244
    v_lshrrev_b32 v232, 1, v243
    v_mul_u32_u24 v232, 24, v232
    v_and_b32 v233, 1, v243
    v_lshl_add_u32 v233, v228, 1, v233
    v_add3_u32 v232, v232, v233, 16
    v_mul_u32_u24 v232, 0xc0, v232
    v_add_u32 v77, v232, v244
    s_mov_b32 s60, 0x3000003
    s_mov_b32 s61, s60
    s_mov_b32 s62, 0xc00000c
    s_mov_b32 s63, s62
    s_mov_b32 s64, 0x30000030
    s_mov_b32 s65, s64
    s_mov_b32 s66, 0xc00000c0
    s_mov_b32 s67, s66
    s_mov_b32 s68, 0xf000f
    s_mov_b32 s69, s68
    s_mov_b32 s70, 0xf000f0
    s_mov_b32 s71, s70
    s_mov_b32 s72, 0xf000f00
    s_mov_b32 s73, s72
    s_mov_b32 s74, 0xf000f000
    s_mov_b32 s75, s74
    s_mov_b32 s86, 0xffffffff
    s_mov_b32 s87, 0
    s_waitcnt vmcnt(6)
    ds_read_u16 v3, v240
    ds_read_u16 v7, v241
    ds_read_u16 v11, v242
    ds_read_u16 v15, v240 offset:16
    ds_read_u16 v19, v241 offset:16
    ds_read_u16 v23, v242 offset:16
    ds_read_u16 v27, v240 offset:64
    ds_read_u16 v31, v241 offset:64
    ds_read_u16 v35, v242 offset:64
    ds_read_u16 v39, v240 offset:80
    ds_read_u16 v43, v241 offset:80
    ds_read_u16 v47, v242 offset:80
    ds_read_u16 v51, v240 offset:128
    ds_read_u16 v55, v241 offset:128
    ds_read_u16 v59, v242 offset:128
    s_waitcnt lgkmcnt(13)
    ds_read_u16 v63, v240 offset:144
    ds_read_u16 v67, v241 offset:144
    s_waitcnt lgkmcnt(13)
    ds_read_u16 v71, v242 offset:144
    v_lshlrev_b32 v232, v230, v3
    v_cndmask_b32 v232, v232, v231, s[86:87]
    v_cndmask_b32 v0, 0, v232, s[60:61]
    v_cndmask_b32 v1, 0, v232, s[62:63]
    v_cndmask_b32 v2, 0, v232, s[64:65]
    v_cndmask_b32 v3, 0, v232, s[66:67]
    v_cndmask_b32 v4, 0, v7, s[68:69]
    v_cndmask_b32 v5, 0, v7, s[70:71]
    v_cndmask_b32 v6, 0, v7, s[72:73]
    v_cndmask_b32 v7, 0, v7, s[74:75]
    v_cndmask_b32 v8, 0, v11, s[68:69]
    v_cndmask_b32 v9, 0, v11, s[70:71]
    v_cndmask_b32 v10, 0, v11, s[72:73]
    v_cndmask_b32 v11, 0, v11, s[74:75]
    v_lshlrev_b32 v232, v230, v15
    v_cndmask_b32 v232, v232, v231, s[86:87]
    v_cndmask_b32 v12, 0, v232, s[60:61]
    v_cndmask_b32 v13, 0, v232, s[62:63]
    v_cndmask_b32 v14, 0, v232, s[64:65]
    v_cndmask_b32 v15, 0, v232, s[66:67]
    s_waitcnt lgkmcnt(0)
    v_cndmask_b32 v16, 0, v19, s[68:69]
    v_cndmask_b32 v17, 0, v19, s[70:71]
    v_cndmask_b32 v18, 0, v19, s[72:73]
    v_cndmask_b32 v19, 0, v19, s[74:75]
    v_cndmask_b32 v20, 0, v23, s[68:69]
    v_cndmask_b32 v21, 0, v23, s[70:71]
    v_cndmask_b32 v22, 0, v23, s[72:73]
    v_cndmask_b32 v23, 0, v23, s[74:75]
    v_lshlrev_b32 v232, v230, v27
    v_cndmask_b32 v232, v232, v231, s[86:87]
    v_cndmask_b32 v24, 0, v232, s[60:61]
    v_cndmask_b32 v25, 0, v232, s[62:63]
    v_cndmask_b32 v26, 0, v232, s[64:65]
    v_cndmask_b32 v27, 0, v232, s[66:67]
    v_cndmask_b32 v28, 0, v31, s[68:69]
    v_cndmask_b32 v29, 0, v31, s[70:71]
    v_cndmask_b32 v30, 0, v31, s[72:73]
    v_cndmask_b32 v31, 0, v31, s[74:75]
    v_cndmask_b32 v32, 0, v35, s[68:69]
    v_cndmask_b32 v33, 0, v35, s[70:71]
    v_cndmask_b32 v34, 0, v35, s[72:73]
    v_cndmask_b32 v35, 0, v35, s[74:75]
    v_lshlrev_b32 v232, v230, v39
    v_cndmask_b32 v232, v232, v231, s[86:87]
    v_cndmask_b32 v36, 0, v232, s[60:61]
    v_cndmask_b32 v37, 0, v232, s[62:63]
    v_cndmask_b32 v38, 0, v232, s[64:65]
    v_cndmask_b32 v39, 0, v232, s[66:67]
    v_cndmask_b32 v40, 0, v43, s[68:69]
    v_cndmask_b32 v41, 0, v43, s[70:71]
    v_cndmask_b32 v42, 0, v43, s[72:73]
    v_cndmask_b32 v43, 0, v43, s[74:75]
    v_cndmask_b32 v44, 0, v47, s[68:69]
    v_cndmask_b32 v45, 0, v47, s[70:71]
    v_cndmask_b32 v46, 0, v47, s[72:73]
    v_cndmask_b32 v47, 0, v47, s[74:75]
    v_lshlrev_b32 v232, v230, v51
    v_cndmask_b32 v232, v232, v231, s[86:87]
    v_cndmask_b32 v48, 0, v232, s[60:61]
    v_cndmask_b32 v49, 0, v232, s[62:63]
    v_cndmask_b32 v50, 0, v232, s[64:65]
    v_cndmask_b32 v51, 0, v232, s[66:67]
    v_cndmask_b32 v52, 0, v55, s[68:69]
    v_cndmask_b32 v53, 0, v55, s[70:71]
    v_cndmask_b32 v54, 0, v55, s[72:73]
    v_cndmask_b32 v55, 0, v55, s[74:75]
    v_cndmask_b32 v56, 0, v59, s[68:69]
    v_cndmask_b32 v57, 0, v59, s[70:71]
    v_cndmask_b32 v58, 0, v59, s[72:73]
    v_cndmask_b32 v59, 0, v59, s[74:75]
    v_lshlrev_b32 v232, v230, v63
    v_cndmask_b32 v232, v232, v231, s[86:87]
    v_cndmask_b32 v60, 0, v232, s[60:61]
    v_cndmask_b32 v61, 0, v232, s[62:63]
    v_cndmask_b32 v62, 0, v232, s[64:65]
    v_cndmask_b32 v63, 0, v232, s[66:67]
    v_cndmask_b32 v64, 0, v67, s[68:69]
    v_cndmask_b32 v65, 0, v67, s[70:71]
    v_cndmask_b32 v66, 0, v67, s[72:73]
    v_cndmask_b32 v67, 0, v67, s[74:75]
    v_cndmask_b32 v68, 0, v71, s[68:69]
    v_cndmask_b32 v69, 0, v71, s[70:71]
    v_cndmask_b32 v70, 0, v71, s[72:73]
    v_cndmask_b32 v71, 0, v71, s[74:75]
    s_mov_b32 s60, 0x11111111
    s_mov_b32 s61, s60
    s_mov_b32 s62, 0x22222222
    s_mov_b32 s63, s62
    s_mov_b32 s64, 0x44444444
    s_mov_b32 s65, s64
    s_mov_b32 s66, 0x88888888
    s_mov_b32 s67, s66
    s_waitcnt vmcnt(0)
    v_mov_b32 v230, 0xe484
    v_mov_b32 v231, 1
    s_mov_b64 exec, 1
    ds_add_u32 v230, v231
    s_mov_b64 exec, -1
    s_waitcnt lgkmcnt(0)
L_spinT3:
    ds_read_b32 v231, v230
    s_waitcnt lgkmcnt(0)
    v_readfirstlane_b32 s40, v231
    s_nop 1
    s_cmp_lt_u32 s40, 4
    s_nop 0
    s_cbranch_scc1 L_spinT3
L_T3start:
    s_mov_b32 s38, -3
    s_add_u32 s56, s38, 12
    v_readlane_b32 s46, v224, s56
    s_nop 1
    s_and_b32 s47, s46, 63
    s_cmp_lt_u32 s46, 0x40000000
    s_cselect_b32 s94, 0x2fe80c0, 0
    s_and_b32 s46, s46, 0x3fffffc0
    s_add_u32 s46, s46, s59
    s_cmp_eq_u32 s47, s48
    s_cbranch_scc1 L_cls11
    s_mov_b32 s48, s47
    s_and_b32 s40, s47, 8
    s_cselect_b64 s[84:85], s[76:77], 0
    v_or_b32 v227, 0x80000000, v211
    v_cndmask_b32 v209, v211, v227, s[84:85]
    s_and_b32 s40, s47, 16
    s_cselect_b64 s[84:85], s[78:79], 0
    v_or_b32 v227, 0x80000000, v212
    v_cndmask_b32 v210, v212, v227, s[84:85]
    s_nop 1
L_cls11:
    s_mov_b32 s6, s94
    s_add_u32 m0, s53, 0x4400
    s_add_u32 s41, s46, 0
    buffer_load_dwordx4 v209, s[4:7], s41 offen nt lds
    s_add_u32 m0, s53, 0x4800
    s_mov_b64 exec, s[80:81]
    buffer_load_dwordx4 v210, s[4:7], s41 offen nt lds
    s_mov_b64 exec, -1
    s_mov_b32 s6, s94
    s_add_u32 m0, s53, 0x4b50
    s_add_u32 s41, s46, 0x17f40
    buffer_load_dwordx4 v209, s[4:7], s41 offen nt lds
    s_add_u32 m0, s53, 0x4f50
    s_mov_b64 exec, s[80:81]
    buffer_load_dwordx4 v210, s[4:7], s41 offen nt lds
    s_mov_b64 exec, -1
    s_and_b32 s40, s47, s39
    s_cselect_b32 s6, 0, s94
    s_add_u32 m0, s53, 0x52a0
    s_add_u32 s41, s46, 0x2fe80
    buffer_load_dwordx4 v209, s[4:7], s41 offen nt lds
    s_add_u32 m0, s53, 0x56a0
    s_mov_b64 exec, s[80:81]
    buffer_load_dwordx4 v210, s[4:7], s41 offen nt lds
    s_mov_b64 exec, -1
    s_mov_b32 s38, -2
    s_add_u32 s56, s38, 12
    v_readlane_b32 s46, v224, s56
    s_nop 1
    s_and_b32 s47, s46, 63
    s_cmp_lt_u32 s46, 0x40000000
    s_cselect_b32 s94, 0x2fe80c0, 0
    s_and_b32 s46, s46, 0x3fffffc0
    s_add_u32 s46, s46, s59
    s_cmp_eq_u32 s47, s48
    s_cbranch_scc1 L_cls12
    s_mov_b32 s48, s47
    s_and_b32 s40, s47, 8
    s_cselect_b64 s[84:85], s[76:77], 0
    v_or_b32 v227, 0x80000000, v211
    v_cndmask_b32 v209, v211, v227, s[84:85]
    s_and_b32 s40, s47, 16
    s_cselect_b64 s[84:85], s[78:79], 0
    v_or_b32 v227, 0x80000000, v212
    v_cndmask_b32 v210, v212, v227, s[84:85]
    s_nop 1
L_cls12:
    ds_read_b128 v[252:255], v73 offset:53056
    ds_read_b128 v[228:231], v73 offset:52224
    ds_read_b128 v[232:235], v73 offset:52848
    ds_read_b128 v[236:239], v73 offset:53472
    ds_read_b128 v[240:243], v74 offset:52640
    ds_read_b128 v[244:247], v73 offset:52240
    ds_read_b128 v[248:251], v73 offset:52864
    s_waitcnt lgkmcnt(6)
    v_mfma_f32_16x16x32_bf16 v[160:163], v[0:3], v[252:255], 0
    ds_read_b128 v[252:255], v73 offset:53072
    s_waitcnt lgkmcnt(5)
    v_smfmac_f32_16x16x64_bf16 v[160:163], v[4:7], v[228:235], v72
    s_waitcnt lgkmcnt(3)
    v_smfmac_f32_16x16x64_bf16 v[160:163], v[8:11], v[236:243], v72
    ds_read_b128 v[228:231], v73 offset:53488
    ds_read_b128 v[232:235], v74 offset:52656
    ds_read_b128 v[236:239], v73 offset:52288
    ds_read_b128 v[240:243], v73 offset:52912
    s_nop 3
    v_cvt_pk_bf16_f32 v184, v160, v161
    v_cvt_pk_bf16_f32 v185, v162, v163
    s_waitcnt lgkmcnt(4)
    v_mfma_f32_16x16x32_bf16 v[164:167], v[12:15], v[252:255], 0
    ds_read_b128 v[252:255], v73 offset:53120
    v_smfmac_f32_16x16x64_bf16 v[164:167], v[16:19], v[244:251], v72
    s_waitcnt lgkmcnt(3)
    v_smfmac_f32_16x16x64_bf16 v[164:167], v[20:23], v[228:235], v72
    ds_read_b128 v[244:247], v73 offset:53536
    ds_read_b128 v[248:251], v74 offset:52704
    ds_read_b128 v[228:231], v73 offset:52304
    ds_read_b128 v[232:235], v73 offset:52928
    s_nop 3
    v_cvt_pk_bf16_f32 v186, v164, v165
    v_cvt_pk_bf16_f32 v187, v166, v167
    ds_write_b128 v208, v[184:187]
    s_nop 0
    v_mfma_f32_16x16x32_bf16 v[200:203], v[184:187], v[184:187], 0
    v_mfma_f32_16x16x32_bf16 v[196:199], v[156:159], v[184:187], 0
    s_waitcnt lgkmcnt(5)
    v_mfma_f32_16x16x32_bf16 v[168:171], v[24:27], v[252:255], 0
    ds_read_b128 v[252:255], v73 offset:53136
    v_smfmac_f32_16x16x64_bf16 v[168:171], v[28:31], v[236:243], v72
    s_waitcnt lgkmcnt(4)
    v_smfmac_f32_16x16x64_bf16 v[168:171], v[32:35], v[244:251], v72
    ds_read_b128 v[236:239], v73 offset:53552
    ds_read_b128 v[240:243], v74 offset:52720
    ds_read_b128 v[244:247], v73 offset:52352
    ds_read_b128 v[248:251], v73 offset:52976
    s_nop 3
    v_cvt_pk_bf16_f32 v188, v168, v169
    v_cvt_pk_bf16_f32 v189, v170, v171
    s_waitcnt lgkmcnt(4)
    v_mfma_f32_16x16x32_bf16 v[172:175], v[36:39], v[252:255], 0
    ds_read_b128 v[252:255], v73 offset:53184
    v_smfmac_f32_16x16x64_bf16 v[172:175], v[40:43], v[228:235], v72
    s_waitcnt lgkmcnt(3)
    v_smfmac_f32_16x16x64_bf16 v[172:175], v[44:47], v[236:243], v72
    ds_read_b128 v[228:231], v73 offset:53600
    ds_read_b128 v[232:235], v74 offset:52768
    ds_read_b128 v[236:239], v73 offset:52368
    ds_read_b128 v[240:243], v73 offset:52992
    s_nop 3
    v_cvt_pk_bf16_f32 v190, v172, v173
    v_cvt_pk_bf16_f32 v191, v174, v175
    ds_write_b128 v208, v[188:191] offset:1024
    s_nop 0
    v_mfma_f32_16x16x32_bf16 v[200:203], v[188:191], v[188:191], v[200:203]
    v_mfma_f32_16x16x32_bf16 v[196:199], v[156:159], v[188:191], v[196:199]
    s_waitcnt lgkmcnt(5)
    v_mfma_f32_16x16x32_bf16 v[176:179], v[48:51], v[252:255], 0
    ds_read_b128 v[252:255], v73 offset:53200
    v_smfmac_f32_16x16x64_bf16 v[176:179], v[52:55], v[244:251], v72
    s_waitcnt lgkmcnt(4)
    v_smfmac_f32_16x16x64_bf16 v[176:179], v[56:59], v[228:235], v72
    ds_read_b128 v[244:247], v73 offset:53616
    ds_read_b128 v[248:251], v74 offset:52784
    s_nop 5
    v_cvt_pk_bf16_f32 v192, v176, v177
    v_cvt_pk_bf16_f32 v193, v178, v179
    s_waitcnt lgkmcnt(2)
    v_mfma_f32_16x16x32_bf16 v[180:183], v[60:63], v[252:255], 0
    v_smfmac_f32_16x16x64_bf16 v[180:183], v[64:67], v[236:243], v72
    s_waitcnt lgkmcnt(0)
    v_smfmac_f32_16x16x64_bf16 v[180:183], v[68:71], v[244:251], v72
    s_nop 7
    v_cvt_pk_bf16_f32 v194, v180, v181
    v_cvt_pk_bf16_f32 v195, v182, v183
    ds_write_b128 v208, v[192:195] offset:2048
    s_nop 0
    v_mfma_f32_16x16x32_bf16 v[200:203], v[192:195], v[192:195], v[200:203]
    v_add_u32 v208, s50, v208
    v_mfma_f32_16x16x32_bf16 v[196:199], v[156:159], v[192:195], v[196:199]
    s_nop 3
    v_cndmask_b32 v223, v200, v201, s[62:63]
    v_cndmask_b32 v223, v223, v202, s[64:65]
    v_cndmask_b32 v223, v223, v203, s[66:67]
    ds_bpermute_b32 v225, v75, v223
    s_mov_b32 s6, s94
    s_add_u32 m0, s53, 0x8800
    s_add_u32 s41, s46, 0
    buffer_load_dwordx4 v209, s[4:7], s41 offen nt lds
    s_add_u32 m0, s53, 0x8c00
    s_mov_b64 exec, s[80:81]
    buffer_load_dwordx4 v210, s[4:7], s41 offen nt lds
    s_mov_b64 exec, -1
    s_mov_b32 s6, s94
    s_add_u32 m0, s53, 0x8f50
    s_add_u32 s41, s46, 0x17f40
    buffer_load_dwordx4 v209, s[4:7], s41 offen nt lds
    s_add_u32 m0, s53, 0x9350
    s_mov_b64 exec, s[80:81]
    buffer_load_dwordx4 v210, s[4:7], s41 offen nt lds
    s_mov_b64 exec, -1
    s_and_b32 s40, s47, s39
    s_cselect_b32 s6, 0, s94
    s_add_u32 m0, s53, 0x96a0
    s_add_u32 s41, s46, 0x2fe80
    buffer_load_dwordx4 v209, s[4:7], s41 offen nt lds
    s_add_u32 m0, s53, 0x9aa0
    s_mov_b64 exec, s[80:81]
    buffer_load_dwordx4 v210, s[4:7], s41 offen nt lds
    s_mov_b64 exec, -1
    v_mul_f32 v221, v196, v196
    v_fmamk_f32 v221, v221, 0xb9c12dab, v204
    v_mul_f32 v222, 0xbc2aaaab, v196
    s_waitcnt lgkmcnt(0)
    v_fmamk_f32 v223, v225, 0x3d10e240, v221
    v_max_f32 v223, v223, v204
    v_rsq_f32 v221, v223
    s_sub_i32 s50, 0, s50
    v_mul_f32 v222, v222, v221
    v_fma_f32 v160, v160, v221, v222
    v_fma_f32 v161, v161, v221, v222
    v_fma_f32 v162, v162, v221, v222
    v_fma_f32 v163, v163, v221, v222
    v_cvt_pk_bf16_f32 v160, v160, v161
    v_cvt_pk_bf16_f32 v161, v162, v163
    v_fma_f32 v164, v164, v221, v222
    v_fma_f32 v165, v165, v221, v222
    v_fma_f32 v166, v166, v221, v222
    v_fma_f32 v167, v167, v221, v222
    v_cvt_pk_bf16_f32 v162, v164, v165
    v_cvt_pk_bf16_f32 v163, v166, v167
    v_fma_f32 v168, v168, v221, v222
    v_fma_f32 v169, v169, v221, v222
    v_fma_f32 v170, v170, v221, v222
    v_fma_f32 v171, v171, v221, v222
    v_cvt_pk_bf16_f32 v168, v168, v169
    v_cvt_pk_bf16_f32 v169, v170, v171
    v_fma_f32 v172, v172, v221, v222
    v_fma_f32 v173, v173, v221, v222
    v_fma_f32 v174, v174, v221, v222
    v_fma_f32 v175, v175, v221, v222
    v_cvt_pk_bf16_f32 v170, v172, v173
    v_cvt_pk_bf16_f32 v171, v174, v175
    v_fma_f32 v176, v176, v221, v222
    v_fma_f32 v177, v177, v221, v222
    v_fma_f32 v178, v178, v221, v222
    v_fma_f32 v179, v179, v221, v222
    v_cvt_pk_bf16_f32 v176, v176, v177
    v_cvt_pk_bf16_f32 v177, v178, v179
    v_fma_f32 v180, v180, v221, v222
    v_fma_f32 v181, v181, v221, v222
    v_fma_f32 v182, v182, v221, v222
    v_fma_f32 v183, v183, v221, v222
    v_cvt_pk_bf16_f32 v178, v180, v181
    v_cvt_pk_bf16_f32 v179, v182, v183
    ds_write_b128 v205, v[160:163]
    ds_write_b128 v205, v[168:171] offset:1024
    ds_write_b128 v205, v[176:179] offset:2048
    s_waitcnt lgkmcnt(0)
L_T3join:
    s_mov_b32 s38, -1
    s_mov_b32 s37, 0
    s_waitcnt lgkmcnt(0) vmcnt(6)
    s_barrier
    s_mov_b32 s92, 0
    s_mov_b32 s93, 0x7f7f7f80
    v_subrev_u32 v227, 0x1e0c0, v207
    s_mov_b32 s12, s22
    s_mov_b32 s13, s23
    s_cmp_eq_u32 s36, 0
    s_cselect_b32 s14, 0x4800, 0
    s_mov_b32 m0, 0x228c0
    s_movk_i32 s42, 0
    buffer_load_dwordx4 v227, s[12:15], s42 offen lds
    s_mov_b32 m0, 0x22cc0
    s_movk_i32 s42, 0x400
    buffer_load_dwordx4 v227, s[12:15], s42 offen lds
    s_mov_b32 m0, 0x230c0
    s_movk_i32 s42, 0x800
    buffer_load_dwordx4 v227, s[12:15], s42 offen lds
    s_mov_b32 m0, 0x234c0
    s_movk_i32 s42, 0xc00
    buffer_load_dwordx4 v227, s[12:15], s42 offen lds
    s_mov_b32 m0, 0x238c0
    s_movk_i32 s42, 0x1000
    buffer_load_dwordx4 v227, s[12:15], s42 offen lds
    s_mov_b32 m0, 0x23cc0
    s_movk_i32 s42, 0x1400
    buffer_load_dwordx4 v227, s[12:15], s42 offen lds
    s_mov_b32 m0, 0x240c0
    s_movk_i32 s42, 0x1800
    buffer_load_dwordx4 v227, s[12:15], s42 offen lds
    s_mov_b32 m0, 0x244c0
    s_movk_i32 s42, 0x1c00
    buffer_load_dwordx4 v227, s[12:15], s42 offen lds
    s_mov_b32 m0, 0x248c0
    s_movk_i32 s42, 0x2000
    buffer_load_dwordx4 v227, s[12:15], s42 offen lds
    s_mov_b32 m0, 0x24cc0
    s_movk_i32 s42, 0x2400
    buffer_load_dwordx4 v227, s[12:15], s42 offen lds
    s_mov_b32 m0, 0x250c0
    s_movk_i32 s42, 0x2800
    buffer_load_dwordx4 v227, s[12:15], s42 offen lds
    s_mov_b32 m0, 0x254c0
    s_movk_i32 s42, 0x2c00
    buffer_load_dwordx4 v227, s[12:15], s42 offen lds
    s_mov_b32 m0, 0x258c0
    s_movk_i32 s42, 0x3000
    buffer_load_dwordx4 v227, s[12:15], s42 offen lds
    s_mov_b32 m0, 0x25cc0
    s_movk_i32 s42, 0x3400
    buffer_load_dwordx4 v227, s[12:15], s42 offen lds
    s_mov_b32 m0, 0x260c0
    s_movk_i32 s42, 0x3800
    buffer_load_dwordx4 v227, s[12:15], s42 offen lds
    s_mov_b32 m0, 0x264c0
    s_movk_i32 s42, 0x3c00
    buffer_load_dwordx4 v227, s[12:15], s42 offen lds
    s_mov_b32 m0, 0x268c0
    s_movk_i32 s42, 0x4000
    buffer_load_dwordx4 v227, s[12:15], s42 offen lds
    s_mov_b32 m0, 0x26cc0
    s_movk_i32 s42, 0x4400
    buffer_load_dwordx4 v227, s[12:15], s42 offen lds
    s_add_u32 s56, s38, 12
    v_readlane_b32 s46, v224, s56
    s_nop 1
    s_and_b32 s47, s46, 63
    s_cmp_lt_u32 s46, 0x40000000
    s_cselect_b32 s94, 0x2fe80c0, 0
    s_and_b32 s46, s46, 0x3fffffc0
    s_add_u32 s46, s46, s59
    s_cmp_eq_u32 s47, s48
    s_cbranch_scc1 L_cls13
    s_mov_b32 s48, s47
    s_and_b32 s40, s47, 8
    s_cselect_b64 s[84:85], s[76:77], 0
    v_or_b32 v227, 0x80000000, v211
    v_cndmask_b32 v209, v211, v227, s[84:85]
    s_and_b32 s40, s47, 16
    s_cselect_b64 s[84:85], s[78:79], 0
    v_or_b32 v227, 0x80000000, v212
    v_cndmask_b32 v210, v212, v227, s[84:85]
    s_nop 1
L_cls13:
    s_mov_b32 s6, s94
    s_add_u32 m0, s53, 0
    s_add_u32 s41, s46, 0
    buffer_load_dwordx4 v209, s[4:7], s41 offen nt lds
    s_add_u32 m0, s53, 0x400
    s_mov_b64 exec, s[80:81]
    buffer_load_dwordx4 v210, s[4:7], s41 offen nt lds
    s_mov_b64 exec, -1
    s_mov_b32 s6, s94
    s_add_u32 m0, s53, 0x750
    s_add_u32 s41, s46, 0x17f40
    buffer_load_dwordx4 v209, s[4:7], s41 offen nt lds
    s_add_u32 m0, s53, 0xb50
    s_mov_b64 exec, s[80:81]
    buffer_load_dwordx4 v210, s[4:7], s41 offen nt lds
    s_mov_b64 exec, -1
    s_and_b32 s40, s47, s39
    s_cselect_b32 s6, 0, s94
    s_add_u32 m0, s53, 0xea0
    s_add_u32 s41, s46, 0x2fe80
    buffer_load_dwordx4 v209, s[4:7], s41 offen nt lds
    s_add_u32 m0, s53, 0x12a0
    s_mov_b64 exec, s[80:81]
    buffer_load_dwordx4 v210, s[4:7], s41 offen nt lds
    s_mov_b64 exec, -1
    s_add_i32 s38, s38, 1
    s_waitcnt vmcnt(6)
    ds_add_u32 v214, v214 offset:16
    s_add_u32 s92, s92, 0x39200
L_sp16:
    ds_read_b32 v215, v214 offset:16
    s_waitcnt lgkmcnt(0)
    v_readfirstlane_b32 s91, v215
    s_nop 1
    s_cmp_lt_u32 s91, s92
    s_nop 0
    s_cbranch_scc0 L_sq16
    s_sleep 1
    s_branch L_sp16
L_sq16:
    s_cmp_lg_u32 s36, 0
    s_cbranch_scc1 L_T3nowo
    v_mov_b32 v227, v76
    v_mov_b32 v223, v77
    ds_read_b64_tr_b16 v[76:77], v227
    ds_read_b64_tr_b16 v[78:79], v227 offset:4608
    ds_read_b64_tr_b16 v[80:81], v227 offset:9216
    ds_read_b64_tr_b16 v[82:83], v227 offset:13824
    ds_read_b64_tr_b16 v[84:85], v223
    ds_read_b64_tr_b16 v[86:87], v223 offset:9216
    ds_read_b64_tr_b16 v[88:89], v227 offset:8
    ds_read_b64_tr_b16 v[90:91], v227 offset:4616
    ds_read_b64_tr_b16 v[92:93], v227 offset:9224
    ds_read_b64_tr_b16 v[94:95], v227 offset:13832
    ds_read_b64_tr_b16 v[96:97], v223 offset:8
    ds_read_b64_tr_b16 v[98:99], v223 offset:9224
    ds_read_b64_tr_b16 v[100:101], v227 offset:64
    ds_read_b64_tr_b16 v[102:103], v227 offset:4672
    ds_read_b64_tr_b16 v[104:105], v227 offset:9280
    s_waitcnt lgkmcnt(13)
    ds_read_b64_tr_b16 v[106:107], v227 offset:13888
    ds_read_b64_tr_b16 v[108:109], v223 offset:64
    s_waitcnt lgkmcnt(13)
    ds_read_b64_tr_b16 v[110:111], v223 offset:9280
    ds_read_b64_tr_b16 v[112:113], v227 offset:72
    s_waitcnt lgkmcnt(13)
    ds_read_b64_tr_b16 v[114:115], v227 offset:4680
    ds_read_b64_tr_b16 v[116:117], v227 offset:9288
    s_waitcnt lgkmcnt(13)
    ds_read_b64_tr_b16 v[118:119], v227 offset:13896
    ds_read_b64_tr_b16 v[120:121], v223 offset:72
    s_waitcnt lgkmcnt(13)
    ds_read_b64_tr_b16 v[122:123], v223 offset:9288
    ds_read_b64_tr_b16 v[124:125], v227 offset:128
    s_waitcnt lgkmcnt(13)
    ds_read_b64_tr_b16 v[126:127], v227 offset:4736
    ds_read_b64_tr_b16 v[128:129], v227 offset:9344
    s_waitcnt lgkmcnt(13)
    ds_read_b64_tr_b16 v[130:131], v227 offset:13952
    ds_read_b64_tr_b16 v[132:133], v223 offset:128
    s_waitcnt lgkmcnt(13)
    ds_read_b64_tr_b16 v[134:135], v223 offset:9344
    ds_read_b64_tr_b16 v[136:137], v227 offset:136
    s_waitcnt lgkmcnt(13)
    ds_read_b64_tr_b16 v[138:139], v227 offset:4744
    ds_read_b64_tr_b16 v[140:141], v227 offset:9352
    s_waitcnt lgkmcnt(13)
    ds_read_b64_tr_b16 v[142:143], v227 offset:13960
    ds_read_b64_tr_b16 v[144:145], v223 offset:136
    s_waitcnt lgkmcnt(13)
    ds_read_b64_tr_b16 v[146:147], v223 offset:9352
    s_waitcnt lgkmcnt(0)
L_T3nowo:
    s_add_u32 s56, s38, 12
    v_readlane_b32 s46, v224, s56
    s_nop 1
    s_and_b32 s47, s46, 63
    s_cmp_lt_u32 s46, 0x40000000
    s_cselect_b32 s94, 0x2fe80c0, 0
    s_and_b32 s46, s46, 0x3fffffc0
    s_add_u32 s46, s46, s59
    s_cmp_eq_u32 s47, s48
    s_cbranch_scc1 L_cls14
    s_mov_b32 s48, s47
    s_and_b32 s40, s47, 8
    s_cselect_b64 s[84:85], s[76:77], 0
    v_or_b32 v227, 0x80000000, v211
    v_cndmask_b32 v209, v211, v227, s[84:85]
    s_and_b32 s40, s47, 16
    s_cselect_b64 s[84:85], s[78:79], 0
    v_or_b32 v227, 0x80000000, v212
    v_cndmask_b32 v210, v212, v227, s[84:85]
    s_nop 1
L_cls14:
    s_mov_b32 s6, s94
    s_add_u32 m0, s53, 0x4400
    s_add_u32 s41, s46, 0
    buffer_load_dwordx4 v209, s[4:7], s41 offen nt lds
    s_add_u32 m0, s53, 0x4800
    s_mov_b64 exec, s[80:81]
    buffer_load_dwordx4 v210, s[4:7], s41 offen nt lds
    s_mov_b64 exec, -1
    s_mov_b32 s6, s94
    s_add_u32 m0, s53, 0x4b50
    s_add_u32 s41, s46, 0x17f40
    buffer_load_dwordx4 v209, s[4:7], s41 offen nt lds
    s_add_u32 m0, s53, 0x4f50
    s_mov_b64 exec, s[80:81]
    buffer_load_dwordx4 v210, s[4:7], s41 offen nt lds
    s_mov_b64 exec, -1
    s_and_b32 s40, s47, s39
    s_cselect_b32 s6, 0, s94
    s_add_u32 m0, s53, 0x52a0
    s_add_u32 s41, s46, 0x2fe80
    buffer_load_dwordx4 v209, s[4:7], s41 offen nt lds
    s_add_u32 m0, s53, 0x56a0
    s_mov_b64 exec, s[80:81]
    buffer_load_dwordx4 v210, s[4:7], s41 offen nt lds
    s_mov_b64 exec, -1
    s_add_i32 s38, s38, 1
    s_waitcnt vmcnt(6)
    ds_add_u32 v214, v214 offset:16
L_T3loop:
    s_add_u32 s92, s92, 0x39200
L_sp17:
    ds_read_b32 v215, v214 offset:16
    s_waitcnt lgkmcnt(0)
    v_readfirstlane_b32 s91, v215
    s_nop 1
    s_cmp_lt_u32 s91, s92
    s_nop 0
    s_cbranch_scc0 L_sq17
    s_sleep 1
    s_branch L_sp17
L_sq17:
    s_add_u32 s56, s38, 12
    v_readlane_b32 s46, v224, s56
    s_nop 1
    s_and_b32 s47, s46, 63
    s_cmp_lt_u32 s46, 0x40000000
    s_cselect_b32 s94, 0x2fe80c0, 0
    s_and_b32 s46, s46, 0x3fffffc0
    s_add_u32 s46, s46, s59
    s_cmp_eq_u32 s47, s48
    s_cbranch_scc1 L_cls15
    s_mov_b32 s48, s47
    s_and_b32 s40, s47, 8
    s_cselect_b64 s[84:85], s[76:77], 0
    v_or_b32 v227, 0x80000000, v211
    v_cndmask_b32 v209, v211, v227, s[84:85]
    s_and_b32 s40, s47, 16
    s_cselect_b64 s[84:85], s[78:79], 0
    v_or_b32 v227, 0x80000000, v212
    v_cndmask_b32 v210, v212, v227, s[84:85]
    s_nop 1
L_cls15:
    ds_read_b128 v[252:255], v73 offset:53056
    ds_read_b128 v[228:231], v73 offset:52224
    ds_read_b128 v[232:235], v73 offset:52848
    ds_read_b128 v[236:239], v73 offset:53472
    ds_read_b128 v[240:243], v74 offset:52640
    ds_read_b128 v[244:247], v73 offset:52240
    ds_read_b128 v[248:251], v73 offset:52864
    s_mov_b32 s6, s94
    s_add_u32 m0, s53, 0x8800
    s_add_u32 s41, s46, 0
    buffer_load_dwordx4 v209, s[4:7], s41 offen nt lds
    s_add_u32 m0, s53, 0x8c00
    s_mov_b64 exec, s[80:81]
    buffer_load_dwordx4 v210, s[4:7], s41 offen nt lds
    s_mov_b64 exec, -1
    s_waitcnt lgkmcnt(6)
    v_mfma_f32_16x16x32_bf16 v[160:163], v[0:3], v[252:255], 0
    ds_read_b128 v[252:255], v73 offset:53072
    s_waitcnt lgkmcnt(5)
    v_smfmac_f32_16x16x64_bf16 v[160:163], v[4:7], v[228:235], v72
    s_waitcnt lgkmcnt(3)
    v_smfmac_f32_16x16x64_bf16 v[160:163], v[8:11], v[236:243], v72
    ds_read_b128 v[228:231], v73 offset:53488
    ds_read_b128 v[232:235], v74 offset:52656
    ds_read_b128 v[236:239], v73 offset:52288
    ds_read_b128 v[240:243], v73 offset:52912
    s_mov_b32 s6, s94
    s_add_u32 m0, s53, 0x8f50
    s_add_u32 s41, s46, 0x17f40
    buffer_load_dwordx4 v209, s[4:7], s41 offen nt lds
    s_add_u32 m0, s53, 0x9350
    s_mov_b64 exec, s[80:81]
    buffer_load_dwordx4 v210, s[4:7], s41 offen nt lds
    s_mov_b64 exec, -1
    s_waitcnt lgkmcnt(4)
    v_mfma_f32_16x16x32_bf16 v[164:167], v[12:15], v[252:255], 0
    v_cvt_pk_bf16_f32 v184, v160, v161
    v_cvt_pk_bf16_f32 v185, v162, v163
    v_smfmac_f32_16x16x64_bf16 v[164:167], v[16:19], v[244:251], v72
    ds_read_b128 v[252:255], v73 offset:53120
    s_waitcnt lgkmcnt(3)
    v_smfmac_f32_16x16x64_bf16 v[164:167], v[20:23], v[228:235], v72
    ds_read_b128 v[244:247], v73 offset:53536
    ds_read_b128 v[248:251], v74 offset:52704
    ds_read_b128 v[228:231], v73 offset:52304
    ds_read_b128 v[232:235], v73 offset:52928
    s_and_b32 s40, s47, s39
    s_cselect_b32 s6, 0, s94
    s_add_u32 m0, s53, 0x96a0
    s_add_u32 s41, s46, 0x2fe80
    buffer_load_dwordx4 v209, s[4:7], s41 offen nt lds
    s_add_u32 m0, s53, 0x9aa0
    s_mov_b64 exec, s[80:81]
    buffer_load_dwordx4 v210, s[4:7], s41 offen nt lds
    s_mov_b64 exec, -1
    s_waitcnt lgkmcnt(4)
    v_mfma_f32_16x16x32_bf16 v[168:171], v[24:27], v[252:255], 0
    s_add_u32 s58, s38, 7
    ds_read_b128 v[252:255], v73 offset:53136
    v_smfmac_f32_16x16x64_bf16 v[168:171], v[28:31], v[236:243], v72
    s_waitcnt lgkmcnt(3)
    v_readlane_b32 s49, v224, s58
    v_smfmac_f32_16x16x64_bf16 v[168:171], v[32:35], v[244:251], v72
    ds_read_b128 v[236:239], v73 offset:53552
    ds_read_b128 v[240:243], v74 offset:52720
    ds_read_b128 v[244:247], v73 offset:52352
    ds_read_b128 v[248:251], v73 offset:52976
    s_cmp_lt_u32 s49, 0x40000000
    s_cselect_b32 s10, 0x2fd00c0, 0
    s_and_b32 s49, s49, 0x3fffffc0
    v_cvt_pk_bf16_f32 v186, v164, v165
    v_cvt_pk_bf16_f32 v187, v166, v167
    v_cvt_pk_bf16_f32 v188, v168, v169
    v_cvt_pk_bf16_f32 v189, v170, v171
    v_mfma_f32_16x16x32_bf16 v[200:203], v[184:187], v[184:187], 0
    v_mfma_f32_16x16x32_bf16 v[196:199], v[156:159], v[184:187], 0
    s_waitcnt lgkmcnt(4)
    v_mfma_f32_16x16x32_bf16 v[172:175], v[36:39], v[252:255], 0
    ds_read_b128 v[252:255], v73 offset:53184
    v_smfmac_f32_16x16x64_bf16 v[172:175], v[40:43], v[228:235], v72
    s_waitcnt lgkmcnt(3)
    v_smfmac_f32_16x16x64_bf16 v[172:175], v[44:47], v[236:243], v72
    ds_read_b128 v[228:231], v73 offset:53600
    ds_read_b128 v[232:235], v74 offset:52768
    ds_read_b128 v[236:239], v73 offset:52368
    ds_read_b128 v[240:243], v73 offset:52992
    ds_write_b128 v208, v[184:187]
    s_nop 2
    v_cvt_pk_bf16_f32 v190, v172, v173
    v_cvt_pk_bf16_f32 v191, v174, v175
    ds_write_b128 v208, v[188:191] offset:1024
    s_nop 0
    v_mfma_f32_16x16x32_bf16 v[200:203], v[188:191], v[188:191], v[200:203]
    v_mfma_f32_16x16x32_bf16 v[196:199], v[156:159], v[188:191], v[196:199]
    s_waitcnt lgkmcnt(6)
    v_mfma_f32_16x16x32_bf16 v[176:179], v[48:51], v[252:255], 0
    ds_read_b128 v[252:255], v73 offset:53200
    v_smfmac_f32_16x16x64_bf16 v[176:179], v[52:55], v[244:251], v72
    s_nop 3
    ds_read_b32 v215, v214 offset:20
    s_waitcnt lgkmcnt(6)
    v_smfmac_f32_16x16x64_bf16 v[176:179], v[56:59], v[228:235], v72
    ds_read_b128 v[244:247], v73 offset:53616
    ds_read_b128 v[248:251], v74 offset:52784
    s_nop 5
    v_cvt_pk_bf16_f32 v192, v176, v177
    v_cvt_pk_bf16_f32 v193, v178, v179
    s_waitcnt lgkmcnt(3)
    v_mfma_f32_16x16x32_bf16 v[180:183], v[60:63], v[252:255], 0
    s_waitcnt lgkmcnt(2)
    v_readfirstlane_b32 s91, v215
    v_smfmac_f32_16x16x64_bf16 v[180:183], v[64:67], v[236:243], v72
    s_waitcnt lgkmcnt(0)
    v_smfmac_f32_16x16x64_bf16 v[180:183], v[68:71], v[244:251], v72
    ds_read_b128 v[240:243], v205 offset:21504
    ds_read_b128 v[244:247], v205 offset:22528
    ds_read_b128 v[248:251], v205 offset:23552
    s_nop 4
    v_cvt_pk_bf16_f32 v194, v180, v181
    v_cvt_pk_bf16_f32 v195, v182, v183
    ds_write_b128 v208, v[192:195] offset:2048
    s_nop 0
    v_mfma_f32_16x16x32_bf16 v[200:203], v[192:195], v[192:195], v[200:203]
    v_add_u32 v208, s50, v208
    s_sub_i32 s50, 0, s50
    v_mfma_f32_16x16x32_bf16 v[196:199], v[156:159], v[192:195], v[196:199]
    s_add_u32 s93, s93, 0x1010101
    s_sub_u32 s91, s91, s93
    s_andn2_b32 s91, 0x80808080, s91
    s_cbranch_scc1 L_sw18
L_sb18:
    ds_read_b128 v[228:231], v207 offset:6144
    ds_read_b128 v[232:235], v207 offset:7168
    ds_read_b128 v[236:239], v207 offset:8192
    v_cndmask_b32 v223, v200, v201, s[62:63]
    v_cndmask_b32 v223, v223, v202, s[64:65]
    v_cndmask_b32 v223, v223, v203, s[66:67]
    v_mul_f32 v221, v196, v196
    v_fmamk_f32 v221, v221, 0xb9c12dab, v204
    v_mul_f32 v222, 0xbc2aaaab, v196
    s_add_i32 s38, s38, 1
    ds_bpermute_b32 v225, v75, v223
    s_waitcnt lgkmcnt(0)
    v_fmamk_f32 v223, v225, 0x3d10e240, v221
    v_mfma_f32_16x16x32_bf16 v[184:187], v[148:151], v[240:243], 0
    v_max_f32 v223, v223, v204
    v_mfma_f32_16x16x32_bf16 v[184:187], v[76:79], v[228:231], v[184:187]
    v_rsq_f32 v221, v223
    v_mfma_f32_16x16x32_bf16 v[184:187], v[80:83], v[232:235], v[184:187]
    v_mul_f32 v222, v222, v221
    v_fma_f32 v160, v160, v221, v222
    v_mfma_f32_16x16x32_bf16 v[184:187], v[84:87], v[236:239], v[184:187]
    v_fma_f32 v161, v161, v221, v222
    v_fma_f32 v162, v162, v221, v222
    v_mfma_f32_16x16x32_bf16 v[188:191], v[152:155], v[240:243], 0
    v_fma_f32 v163, v163, v221, v222
    v_cvt_pk_bf16_f32 v160, v160, v161
    v_mfma_f32_16x16x32_bf16 v[188:191], v[88:91], v[228:231], v[188:191]
    v_cvt_pk_bf16_f32 v184, v184, v185
    v_cvt_pk_bf16_f32 v185, v186, v187
    v_mfma_f32_16x16x32_bf16 v[188:191], v[92:95], v[232:235], v[188:191]
    v_cvt_pk_bf16_f32 v161, v162, v163
    v_fma_f32 v164, v164, v221, v222
    v_mfma_f32_16x16x32_bf16 v[188:191], v[96:99], v[236:239], v[188:191]
    v_fma_f32 v165, v165, v221, v222
    v_fma_f32 v166, v166, v221, v222
    v_mfma_f32_16x16x32_bf16 v[192:195], v[148:151], v[244:247], 0
    v_fma_f32 v167, v167, v221, v222
    v_cvt_pk_bf16_f32 v162, v164, v165
    v_mfma_f32_16x16x32_bf16 v[192:195], v[100:103], v[228:231], v[192:195]
    v_cvt_pk_bf16_f32 v186, v188, v189
    v_cvt_pk_bf16_f32 v187, v190, v191
    v_mfma_f32_16x16x32_bf16 v[192:195], v[104:107], v[232:235], v[192:195]
    v_cvt_pk_bf16_f32 v163, v166, v167
    v_fma_f32 v168, v168, v221, v222
    v_mfma_f32_16x16x32_bf16 v[192:195], v[108:111], v[236:239], v[192:195]
    v_fma_f32 v169, v169, v221, v222
    v_fma_f32 v170, v170, v221, v222
    v_mfma_f32_16x16x32_bf16 v[196:199], v[152:155], v[244:247], 0
    v_fma_f32 v171, v171, v221, v222
    v_cvt_pk_bf16_f32 v168, v168, v169
    v_mfma_f32_16x16x32_bf16 v[196:199], v[112:115], v[228:231], v[196:199]
    v_cvt_pk_bf16_f32 v192, v192, v193
    v_cvt_pk_bf16_f32 v193, v194, v195
    v_mfma_f32_16x16x32_bf16 v[196:199], v[116:119], v[232:235], v[196:199]
    v_cvt_pk_bf16_f32 v169, v170, v171
    v_fma_f32 v172, v172, v221, v222
    v_mfma_f32_16x16x32_bf16 v[196:199], v[120:123], v[236:239], v[196:199]
    v_fma_f32 v173, v173, v221, v222
    v_fma_f32 v174, v174, v221, v222
    v_mfma_f32_16x16x32_bf16 v[200:203], v[148:151], v[248:251], 0
    v_fma_f32 v175, v175, v221, v222
    v_cvt_pk_bf16_f32 v170, v172, v173
    v_mfma_f32_16x16x32_bf16 v[200:203], v[124:127], v[228:231], v[200:203]
    v_cvt_pk_bf16_f32 v194, v196, v197
    v_cvt_pk_bf16_f32 v195, v198, v199
    v_mfma_f32_16x16x32_bf16 v[200:203], v[128:131], v[232:235], v[200:203]
    v_cvt_pk_bf16_f32 v171, v174, v175
    v_fma_f32 v176, v176, v221, v222
    v_mfma_f32_16x16x32_bf16 v[200:203], v[132:135], v[236:239], v[200:203]
    v_fma_f32 v177, v177, v221, v222
    v_fma_f32 v178, v178, v221, v222
    v_mfma_f32_16x16x32_bf16 v[252:255], v[152:155], v[248:251], 0
    v_fma_f32 v179, v179, v221, v222
    v_cvt_pk_bf16_f32 v176, v176, v177
    v_mfma_f32_16x16x32_bf16 v[252:255], v[136:139], v[228:231], v[252:255]
    v_cvt_pk_bf16_f32 v200, v200, v201
    v_cvt_pk_bf16_f32 v201, v202, v203
    v_mfma_f32_16x16x32_bf16 v[252:255], v[140:143], v[232:235], v[252:255]
    v_cvt_pk_bf16_f32 v177, v178, v179
    v_fma_f32 v180, v180, v221, v222
    v_mfma_f32_16x16x32_bf16 v[252:255], v[144:147], v[236:239], v[252:255]
    buffer_store_dwordx4 v[184:187], v218, s[8:11], s49 offen sc0 sc1
    buffer_store_dwordx4 v[192:195], v218, s[8:11], s49 offen offset:64 sc0 sc1
    s_nop 5
    v_cvt_pk_bf16_f32 v202, v252, v253
    v_cvt_pk_bf16_f32 v203, v254, v255
    v_fma_f32 v181, v181, v221, v222
    v_fma_f32 v182, v182, v221, v222
    v_fma_f32 v183, v183, v221, v222
    v_cvt_pk_bf16_f32 v178, v180, v181
    v_cvt_pk_bf16_f32 v179, v182, v183
    buffer_store_dwordx4 v[200:203], v218, s[8:11], s49 offen offset:128 sc0 sc1
    ds_write_b128 v205, v[160:163]
    ds_write_b128 v205, v[168:171] offset:1024
    ds_write_b128 v205, v[176:179] offset:2048
    s_waitcnt vmcnt(9)
    ds_add_u32 v214, v214 offset:16
    s_add_u32 s92, s92, 0x39200
L_sp19:
    ds_read_b32 v215, v214 offset:16
    s_waitcnt lgkmcnt(0)
    v_readfirstlane_b32 s91, v215
    s_nop 1
    s_cmp_lt_u32 s91, s92
    s_nop 0
    s_cbranch_scc0 L_sq19
    s_sleep 1
    s_branch L_sp19
L_sq19:
    s_add_u32 s56, s38, 12
    v_readlane_b32 s46, v224, s56
    s_nop 1
    s_and_b32 s47, s46, 63
    s_cmp_lt_u32 s46, 0x40000000
    s_cselect_b32 s94, 0x2fe80c0, 0
    s_and_b32 s46, s46, 0x3fffffc0
    s_add_u32 s46, s46, s59
    s_cmp_eq_u32 s47, s48
    s_cbranch_scc1 L_cls16
    s_mov_b32 s48, s47
    s_and_b32 s40, s47, 8
    s_cselect_b64 s[84:85], s[76:77], 0
    v_or_b32 v227, 0x80000000, v211
    v_cndmask_b32 v209, v211, v227, s[84:85]
    s_and_b32 s40, s47, 16
    s_cselect_b64 s[84:85], s[78:79], 0
    v_or_b32 v227, 0x80000000, v212
    v_cndmask_b32 v210, v212, v227, s[84:85]
    s_nop 1
L_cls16:
    ds_read_b128 v[172:175], v205 offset:49152
    ds_read_b128 v[176:179], v205 offset:50176
    ds_read_b128 v[180:183], v205 offset:51200
    s_mov_b32 s6, s94
    s_add_u32 m0, s53, 0
    s_add_u32 s41, s46, 0
    buffer_load_dwordx4 v209, s[4:7], s41 offen nt lds
    s_add_u32 m0, s53, 0x400
    s_mov_b64 exec, s[80:81]
    buffer_load_dwordx4 v210, s[4:7], s41 offen nt lds
    s_mov_b64 exec, -1
    s_waitcnt lgkmcnt(2)
    v_mfma_f32_16x16x32_bf16 v[184:187], v[148:151], v[172:175], 0
    v_mfma_f32_16x16x32_bf16 v[188:191], v[152:155], v[172:175], 0
    s_waitcnt lgkmcnt(1)
    v_mfma_f32_16x16x32_bf16 v[192:195], v[148:151], v[176:179], 0
    v_mfma_f32_16x16x32_bf16 v[196:199], v[152:155], v[176:179], 0
    s_waitcnt lgkmcnt(0)
    v_mfma_f32_16x16x32_bf16 v[200:203], v[148:151], v[180:183], 0
    v_mfma_f32_16x16x32_bf16 v[252:255], v[152:155], v[180:183], 0
    s_mov_b32 s6, s94
    s_add_u32 m0, s53, 0x750
    s_add_u32 s41, s46, 0x17f40
    buffer_load_dwordx4 v209, s[4:7], s41 offen nt lds
    s_add_u32 m0, s53, 0xb50
    s_mov_b64 exec, s[80:81]
    buffer_load_dwordx4 v210, s[4:7], s41 offen nt lds
    s_mov_b64 exec, -1
    s_and_b32 s40, s47, s39
    s_cselect_b32 s6, 0, s94
    s_add_u32 m0, s53, 0xea0
    s_add_u32 s41, s46, 0x2fe80
    buffer_load_dwordx4 v209, s[4:7], s41 offen nt lds
    s_add_u32 m0, s53, 0x12a0
    s_mov_b64 exec, s[80:81]
    buffer_load_dwordx4 v210, s[4:7], s41 offen nt lds
    s_mov_b64 exec, -1
    s_add_u32 s58, s38, 7
    ds_read_b32 v215, v214 offset:20
    v_readlane_b32 s49, v224, s58
    s_nop 1
    s_cmp_lt_u32 s49, 0x40000000
    s_cselect_b32 s10, 0x2fd00c0, 0
    s_and_b32 s49, s49, 0x3fffffc0
    s_add_u32 s93, s93, 0x1010101
    s_waitcnt lgkmcnt(0)
    v_readfirstlane_b32 s91, v215
    s_nop 1
    s_sub_u32 s91, s91, s93
    s_andn2_b32 s91, 0x80808080, s91
    s_cbranch_scc1 L_sw20
L_sb20:
    ds_read_b128 v[160:163], v207 offset:15360
    ds_read_b128 v[164:167], v207 offset:16384
    ds_read_b128 v[168:171], v207 offset:17408
    s_add_i32 s38, s38, 1
    s_waitcnt lgkmcnt(2)
    v_mfma_f32_16x16x32_bf16 v[184:187], v[76:79], v[160:163], v[184:187]
    s_waitcnt lgkmcnt(1)
    v_mfma_f32_16x16x32_bf16 v[184:187], v[80:83], v[164:167], v[184:187]
    s_waitcnt lgkmcnt(0)
    v_mfma_f32_16x16x32_bf16 v[184:187], v[84:87], v[168:171], v[184:187]
    v_mfma_f32_16x16x32_bf16 v[188:191], v[88:91], v[160:163], v[188:191]
    v_mfma_f32_16x16x32_bf16 v[188:191], v[92:95], v[164:167], v[188:191]
    v_cvt_pk_bf16_f32 v184, v184, v185
    v_cvt_pk_bf16_f32 v185, v186, v187
    v_mfma_f32_16x16x32_bf16 v[188:191], v[96:99], v[168:171], v[188:191]
    v_mfma_f32_16x16x32_bf16 v[192:195], v[100:103], v[160:163], v[192:195]
    v_mfma_f32_16x16x32_bf16 v[192:195], v[104:107], v[164:167], v[192:195]
    v_cvt_pk_bf16_f32 v186, v188, v189
    v_cvt_pk_bf16_f32 v187, v190, v191
    v_mfma_f32_16x16x32_bf16 v[192:195], v[108:111], v[168:171], v[192:195]
    v_mfma_f32_16x16x32_bf16 v[196:199], v[112:115], v[160:163], v[196:199]
    v_mfma_f32_16x16x32_bf16 v[196:199], v[116:119], v[164:167], v[196:199]
    v_cvt_pk_bf16_f32 v192, v192, v193
    v_cvt_pk_bf16_f32 v193, v194, v195
    v_mfma_f32_16x16x32_bf16 v[196:199], v[120:123], v[168:171], v[196:199]
    v_mfma_f32_16x16x32_bf16 v[200:203], v[124:127], v[160:163], v[200:203]
    v_mfma_f32_16x16x32_bf16 v[200:203], v[128:131], v[164:167], v[200:203]
    v_cvt_pk_bf16_f32 v194, v196, v197
    v_cvt_pk_bf16_f32 v195, v198, v199
    v_mfma_f32_16x16x32_bf16 v[200:203], v[132:135], v[168:171], v[200:203]
    v_mfma_f32_16x16x32_bf16 v[252:255], v[136:139], v[160:163], v[252:255]
    v_mfma_f32_16x16x32_bf16 v[252:255], v[140:143], v[164:167], v[252:255]
    v_cvt_pk_bf16_f32 v200, v200, v201
    v_cvt_pk_bf16_f32 v201, v202, v203
    v_mfma_f32_16x16x32_bf16 v[252:255], v[144:147], v[168:171], v[252:255]
    buffer_store_dwordx4 v[184:187], v218, s[8:11], s49 offen sc0 sc1
    buffer_store_dwordx4 v[192:195], v218, s[8:11], s49 offen offset:64 sc0 sc1
    s_nop 5
    v_cvt_pk_bf16_f32 v202, v252, v253
    v_cvt_pk_bf16_f32 v203, v254, v255
    buffer_store_dwordx4 v[200:203], v218, s[8:11], s49 offen offset:128 sc0 sc1
    s_waitcnt vmcnt(12)
    ds_add_u32 v214, v214 offset:16
    s_add_u32 s92, s92, 0x39200
L_sp21:
    ds_read_b32 v215, v214 offset:16
    s_waitcnt lgkmcnt(0)
    v_readfirstlane_b32 s91, v215
    s_nop 1
    s_cmp_lt_u32 s91, s92
    s_nop 0
    s_cbranch_scc0 L_sq21
    s_sleep 1
    s_branch L_sp21
L_sq21:
    s_add_u32 s56, s38, 12
    v_readlane_b32 s46, v224, s56
    s_nop 1
    s_and_b32 s47, s46, 63
    s_cmp_lt_u32 s46, 0x40000000
    s_cselect_b32 s94, 0x2fe80c0, 0
    s_and_b32 s46, s46, 0x3fffffc0
    s_add_u32 s46, s46, s59
    s_cmp_eq_u32 s47, s48
    s_cbranch_scc1 L_cls17
    s_mov_b32 s48, s47
    s_and_b32 s40, s47, 8
    s_cselect_b64 s[84:85], s[76:77], 0
    v_or_b32 v227, 0x80000000, v211
    v_cndmask_b32 v209, v211, v227, s[84:85]
    s_and_b32 s40, s47, 16
    s_cselect_b64 s[84:85], s[78:79], 0
    v_or_b32 v227, 0x80000000, v212
    v_cndmask_b32 v210, v212, v227, s[84:85]
    s_nop 1
L_cls17:
    ds_read_b128 v[172:175], v205 offset:55296
    ds_read_b128 v[176:179], v205 offset:56320
    ds_read_b128 v[180:183], v205 offset:57344
    ds_read_b128 v[240:243], v205 offset:58368
    ds_read_b128 v[244:247], v205 offset:59392
    ds_read_b128 v[248:251], v205 offset:60416
    s_mov_b32 s6, s94
    s_add_u32 m0, s53, 0x4400
    s_add_u32 s41, s46, 0
    buffer_load_dwordx4 v209, s[4:7], s41 offen nt lds
    s_add_u32 m0, s53, 0x4800
    s_mov_b64 exec, s[80:81]
    buffer_load_dwordx4 v210, s[4:7], s41 offen nt lds
    s_mov_b64 exec, -1
    s_waitcnt lgkmcnt(5)
    v_mfma_f32_16x16x32_bf16 v[184:187], v[148:151], v[172:175], 0
    v_mfma_f32_16x16x32_bf16 v[188:191], v[152:155], v[172:175], 0
    s_waitcnt lgkmcnt(4)
    v_mfma_f32_16x16x32_bf16 v[192:195], v[148:151], v[176:179], 0
    v_mfma_f32_16x16x32_bf16 v[196:199], v[152:155], v[176:179], 0
    s_waitcnt lgkmcnt(3)
    v_mfma_f32_16x16x32_bf16 v[200:203], v[148:151], v[180:183], 0
    v_mfma_f32_16x16x32_bf16 v[252:255], v[152:155], v[180:183], 0
    s_mov_b32 s6, s94
    s_add_u32 m0, s53, 0x4b50
    s_add_u32 s41, s46, 0x17f40
    buffer_load_dwordx4 v209, s[4:7], s41 offen nt lds
    s_add_u32 m0, s53, 0x4f50
    s_mov_b64 exec, s[80:81]
    buffer_load_dwordx4 v210, s[4:7], s41 offen nt lds
    s_mov_b64 exec, -1
    s_and_b32 s40, s47, s39
    s_cselect_b32 s6, 0, s94
    s_add_u32 m0, s53, 0x52a0
    s_add_u32 s41, s46, 0x2fe80
    buffer_load_dwordx4 v209, s[4:7], s41 offen nt lds
    s_add_u32 m0, s53, 0x56a0
    s_mov_b64 exec, s[80:81]
    buffer_load_dwordx4 v210, s[4:7], s41 offen nt lds
    s_mov_b64 exec, -1
    s_add_u32 s58, s38, 7
    ds_read_b32 v215, v214 offset:20
    v_readlane_b32 s49, v224, s58
    s_nop 1
    s_cmp_lt_u32 s49, 0x40000000
    s_cselect_b32 s10, 0x2fd00c0, 0
    s_and_b32 s49, s49, 0x3fffffc0
    s_add_u32 s93, s93, 0x1010101
    s_waitcnt lgkmcnt(0)
    v_readfirstlane_b32 s91, v215
    s_nop 1
    s_sub_u32 s91, s91, s93
    s_andn2_b32 s91, 0x80808080, s91
    s_cbranch_scc1 L_sw22
L_sb22:
    ds_read_b128 v[160:163], v207 offset:21504
    ds_read_b128 v[164:167], v207 offset:22528
    ds_read_b128 v[168:171], v207 offset:23552
    ds_read_b128 v[228:231], v207 offset:24576
    ds_read_b128 v[232:235], v207 offset:25600
    ds_read_b128 v[236:239], v207 offset:26624
    s_add_i32 s38, s38, 1
    s_waitcnt lgkmcnt(5)
    v_mfma_f32_16x16x32_bf16 v[184:187], v[76:79], v[160:163], v[184:187]
    s_waitcnt lgkmcnt(4)
    v_mfma_f32_16x16x32_bf16 v[184:187], v[80:83], v[164:167], v[184:187]
    s_waitcnt lgkmcnt(3)
    v_mfma_f32_16x16x32_bf16 v[184:187], v[84:87], v[168:171], v[184:187]
    v_mfma_f32_16x16x32_bf16 v[188:191], v[88:91], v[160:163], v[188:191]
    v_mfma_f32_16x16x32_bf16 v[188:191], v[92:95], v[164:167], v[188:191]
    v_cvt_pk_bf16_f32 v184, v184, v185
    v_cvt_pk_bf16_f32 v185, v186, v187
    v_mfma_f32_16x16x32_bf16 v[188:191], v[96:99], v[168:171], v[188:191]
    v_mfma_f32_16x16x32_bf16 v[192:195], v[100:103], v[160:163], v[192:195]
    v_mfma_f32_16x16x32_bf16 v[192:195], v[104:107], v[164:167], v[192:195]
    v_cvt_pk_bf16_f32 v186, v188, v189
    v_cvt_pk_bf16_f32 v187, v190, v191
    v_mfma_f32_16x16x32_bf16 v[192:195], v[108:111], v[168:171], v[192:195]
    v_mfma_f32_16x16x32_bf16 v[196:199], v[112:115], v[160:163], v[196:199]
    v_mfma_f32_16x16x32_bf16 v[196:199], v[116:119], v[164:167], v[196:199]
    v_cvt_pk_bf16_f32 v192, v192, v193
    v_cvt_pk_bf16_f32 v193, v194, v195
    v_mfma_f32_16x16x32_bf16 v[196:199], v[120:123], v[168:171], v[196:199]
    v_mfma_f32_16x16x32_bf16 v[200:203], v[124:127], v[160:163], v[200:203]
    v_mfma_f32_16x16x32_bf16 v[200:203], v[128:131], v[164:167], v[200:203]
    v_cvt_pk_bf16_f32 v194, v196, v197
    v_cvt_pk_bf16_f32 v195, v198, v199
    v_mfma_f32_16x16x32_bf16 v[200:203], v[132:135], v[168:171], v[200:203]
    v_mfma_f32_16x16x32_bf16 v[252:255], v[136:139], v[160:163], v[252:255]
    v_mfma_f32_16x16x32_bf16 v[252:255], v[140:143], v[164:167], v[252:255]
    v_cvt_pk_bf16_f32 v200, v200, v201
    v_cvt_pk_bf16_f32 v201, v202, v203
    v_mfma_f32_16x16x32_bf16 v[252:255], v[144:147], v[168:171], v[252:255]
    v_mfma_f32_16x16x32_bf16 v[188:191], v[152:155], v[240:243], 0
    s_waitcnt lgkmcnt(0)
    v_mfma_f32_16x16x32_bf16 v[188:191], v[88:91], v[228:231], v[188:191]
    v_cvt_pk_bf16_f32 v202, v252, v253
    v_cvt_pk_bf16_f32 v203, v254, v255
    v_mfma_f32_16x16x32_bf16 v[188:191], v[92:95], v[232:235], v[188:191]
    v_mfma_f32_16x16x32_bf16 v[188:191], v[96:99], v[236:239], v[188:191]
    v_mfma_f32_16x16x32_bf16 v[196:199], v[152:155], v[244:247], 0
    v_mfma_f32_16x16x32_bf16 v[196:199], v[112:115], v[228:231], v[196:199]
    v_mfma_f32_16x16x32_bf16 v[196:199], v[116:119], v[232:235], v[196:199]
    v_mfma_f32_16x16x32_bf16 v[196:199], v[120:123], v[236:239], v[196:199]
    v_mfma_f32_16x16x32_bf16 v[252:255], v[152:155], v[248:251], 0
    v_mfma_f32_16x16x32_bf16 v[252:255], v[136:139], v[228:231], v[252:255]
    v_mfma_f32_16x16x32_bf16 v[252:255], v[140:143], v[232:235], v[252:255]
    v_mfma_f32_16x16x32_bf16 v[252:255], v[144:147], v[236:239], v[252:255]
    buffer_store_dwordx4 v[184:187], v217, s[8:11], s49 offen sc0 sc1
    s_nop 1
    v_mfma_f32_16x16x32_bf16 v[184:187], v[148:151], v[240:243], 0
    v_mfma_f32_16x16x32_bf16 v[184:187], v[76:79], v[228:231], v[184:187]
    v_mfma_f32_16x16x32_bf16 v[184:187], v[80:83], v[232:235], v[184:187]
    v_mfma_f32_16x16x32_bf16 v[184:187], v[84:87], v[236:239], v[184:187]
    buffer_store_dwordx4 v[192:195], v217, s[8:11], s49 offen offset:64 sc0 sc1
    s_nop 1
    v_mfma_f32_16x16x32_bf16 v[192:195], v[148:151], v[244:247], 0
    v_mfma_f32_16x16x32_bf16 v[192:195], v[100:103], v[228:231], v[192:195]
    v_cvt_pk_bf16_f32 v184, v184, v185
    v_cvt_pk_bf16_f32 v185, v186, v187
    v_mfma_f32_16x16x32_bf16 v[192:195], v[104:107], v[232:235], v[192:195]
    v_cvt_pk_bf16_f32 v186, v188, v189
    v_cvt_pk_bf16_f32 v187, v190, v191
    v_mfma_f32_16x16x32_bf16 v[192:195], v[108:111], v[236:239], v[192:195]
    buffer_store_dwordx4 v[200:203], v217, s[8:11], s49 offen offset:128 sc0 sc1
    s_nop 1
    v_mfma_f32_16x16x32_bf16 v[200:203], v[148:151], v[248:251], 0
    v_mfma_f32_16x16x32_bf16 v[200:203], v[124:127], v[228:231], v[200:203]
    v_cvt_pk_bf16_f32 v192, v192, v193
    v_cvt_pk_bf16_f32 v193, v194, v195
    v_mfma_f32_16x16x32_bf16 v[200:203], v[128:131], v[232:235], v[200:203]
    v_cvt_pk_bf16_f32 v194, v196, v197
    v_cvt_pk_bf16_f32 v195, v198, v199
    v_mfma_f32_16x16x32_bf16 v[200:203], v[132:135], v[236:239], v[200:203]
    buffer_store_dwordx4 v[184:187], v218, s[8:11], s49 offen sc0 sc1
    buffer_store_dwordx4 v[192:195], v218, s[8:11], s49 offen offset:64 sc0 sc1
    s_nop 5
    v_cvt_pk_bf16_f32 v200, v200, v201
    v_cvt_pk_bf16_f32 v201, v202, v203
    v_cvt_pk_bf16_f32 v202, v252, v253
    v_cvt_pk_bf16_f32 v203, v254, v255
    buffer_store_dwordx4 v[200:203], v218, s[8:11], s49 offen offset:128 sc0 sc1
    s_waitcnt vmcnt(15)
    ds_add_u32 v214, v214 offset:16
    s_add_u32 s37, s37, 1
    s_cmp_lt_u32 s37, 6
    s_cbranch_scc1 L_T3loop
    s_add_u32 s92, s92, 0x39200
L_sp23:
    ds_read_b32 v215, v214 offset:16
    s_waitcnt lgkmcnt(0)
    v_readfirstlane_b32 s91, v215
    s_nop 1
    s_cmp_lt_u32 s91, s92
    s_nop 0
    s_cbranch_scc0 L_sq23
    s_sleep 1
    s_branch L_sp23
L_sq23:
    ds_read_b32 v215, v214 offset:20
    ds_read_b128 v[172:175], v205 offset:21504
    ds_read_b128 v[176:179], v205 offset:22528
    ds_read_b128 v[180:183], v205 offset:23552
    s_add_u32 s58, s38, 7
    v_readlane_b32 s49, v224, s58
    s_nop 1
    s_cmp_lt_u32 s49, 0x40000000
    s_cselect_b32 s10, 0x2fd00c0, 0
    s_and_b32 s49, s49, 0x3fffffc0
    s_add_u32 s93, s93, 0x1010101
    s_waitcnt lgkmcnt(3)
    v_readfirstlane_b32 s91, v215
    s_waitcnt lgkmcnt(2)
    v_mfma_f32_16x16x32_bf16 v[184:187], v[148:151], v[172:175], 0
    v_mfma_f32_16x16x32_bf16 v[188:191], v[152:155], v[172:175], 0
    s_sub_u32 s91, s91, s93
    s_andn2_b32 s91, 0x80808080, s91
    s_cbranch_scc1 L_sw24
L_sb24:
    s_waitcnt lgkmcnt(1)
    v_mfma_f32_16x16x32_bf16 v[192:195], v[148:151], v[176:179], 0
    ds_read_b128 v[160:163], v207 offset:6144
    ds_read_b128 v[164:167], v207 offset:7168
    v_mfma_f32_16x16x32_bf16 v[196:199], v[152:155], v[176:179], 0
    ds_read_b128 v[168:171], v207 offset:8192
    s_add_i32 s38, s38, 1
    s_waitcnt lgkmcnt(3)
    v_mfma_f32_16x16x32_bf16 v[200:203], v[148:151], v[180:183], 0
    v_mfma_f32_16x16x32_bf16 v[252:255], v[152:155], v[180:183], 0
    s_waitcnt lgkmcnt(2)
    v_mfma_f32_16x16x32_bf16 v[184:187], v[76:79], v[160:163], v[184:187]
    s_waitcnt lgkmcnt(1)
    v_mfma_f32_16x16x32_bf16 v[184:187], v[80:83], v[164:167], v[184:187]
    s_waitcnt lgkmcnt(0)
    v_mfma_f32_16x16x32_bf16 v[184:187], v[84:87], v[168:171], v[184:187]
    v_mfma_f32_16x16x32_bf16 v[188:191], v[88:91], v[160:163], v[188:191]
    v_mfma_f32_16x16x32_bf16 v[188:191], v[92:95], v[164:167], v[188:191]
    v_cvt_pk_bf16_f32 v184, v184, v185
    v_cvt_pk_bf16_f32 v185, v186, v187
    v_mfma_f32_16x16x32_bf16 v[188:191], v[96:99], v[168:171], v[188:191]
    v_mfma_f32_16x16x32_bf16 v[192:195], v[100:103], v[160:163], v[192:195]
    v_mfma_f32_16x16x32_bf16 v[192:195], v[104:107], v[164:167], v[192:195]
    v_cvt_pk_bf16_f32 v186, v188, v189
    v_cvt_pk_bf16_f32 v187, v190, v191
    v_mfma_f32_16x16x32_bf16 v[192:195], v[108:111], v[168:171], v[192:195]
    v_mfma_f32_16x16x32_bf16 v[196:199], v[112:115], v[160:163], v[196:199]
    v_mfma_f32_16x16x32_bf16 v[196:199], v[116:119], v[164:167], v[196:199]
    v_cvt_pk_bf16_f32 v192, v192, v193
    v_cvt_pk_bf16_f32 v193, v194, v195
    v_mfma_f32_16x16x32_bf16 v[196:199], v[120:123], v[168:171], v[196:199]
    v_mfma_f32_16x16x32_bf16 v[200:203], v[124:127], v[160:163], v[200:203]
    v_mfma_f32_16x16x32_bf16 v[200:203], v[128:131], v[164:167], v[200:203]
    v_cvt_pk_bf16_f32 v194, v196, v197
    v_cvt_pk_bf16_f32 v195, v198, v199
    v_mfma_f32_16x16x32_bf16 v[200:203], v[132:135], v[168:171], v[200:203]
    v_mfma_f32_16x16x32_bf16 v[252:255], v[136:139], v[160:163], v[252:255]
    v_mfma_f32_16x16x32_bf16 v[252:255], v[140:143], v[164:167], v[252:255]
    v_cvt_pk_bf16_f32 v200, v200, v201
    v_cvt_pk_bf16_f32 v201, v202, v203
    v_mfma_f32_16x16x32_bf16 v[252:255], v[144:147], v[168:171], v[252:255]
    buffer_store_dwordx4 v[184:187], v218, s[8:11], s49 offen sc0 sc1
    buffer_store_dwordx4 v[192:195], v218, s[8:11], s49 offen offset:64 sc0 sc1
    s_nop 5
    v_cvt_pk_bf16_f32 v202, v252, v253
    v_cvt_pk_bf16_f32 v203, v254, v255
    buffer_store_dwordx4 v[200:203], v218, s[8:11], s49 offen offset:128 sc0 sc1
    ds_add_u32 v214, v214 offset:16
    s_add_u32 s92, s92, 0x39200
L_sp25:
    ds_read_b32 v215, v214 offset:16
    s_waitcnt lgkmcnt(0)
    v_readfirstlane_b32 s91, v215
    s_nop 1
    s_cmp_lt_u32 s91, s92
    s_nop 0
    s_cbranch_scc0 L_sq25
    s_sleep 1
    s_branch L_sp25
L_sq25:
    ds_read_b32 v215, v214 offset:20
    ds_read_b128 v[172:175], v205 offset:49152
    ds_read_b128 v[176:179], v205 offset:50176
    ds_read_b128 v[180:183], v205 offset:51200
    s_add_u32 s58, s38, 7
    v_readlane_b32 s49, v224, s58
    s_nop 1
    s_cmp_lt_u32 s49, 0x40000000
    s_cselect_b32 s10, 0x2fd00c0, 0
    s_and_b32 s49, s49, 0x3fffffc0
    s_add_u32 s93, s93, 0x1010101
    s_waitcnt lgkmcnt(3)
    v_readfirstlane_b32 s91, v215
    s_waitcnt lgkmcnt(2)
    v_mfma_f32_16x16x32_bf16 v[184:187], v[148:151], v[172:175], 0
    v_mfma_f32_16x16x32_bf16 v[188:191], v[152:155], v[172:175], 0
    s_sub_u32 s91, s91, s93
    s_andn2_b32 s91, 0x80808080, s91
    s_cbranch_scc1 L_sw26
L_sb26:
    s_waitcnt lgkmcnt(1)
    v_mfma_f32_16x16x32_bf16 v[192:195], v[148:151], v[176:179], 0
    ds_read_b128 v[160:163], v207 offset:15360
    ds_read_b128 v[164:167], v207 offset:16384
    v_mfma_f32_16x16x32_bf16 v[196:199], v[152:155], v[176:179], 0
    ds_read_b128 v[168:171], v207 offset:17408
    s_add_i32 s38, s38, 1
    s_waitcnt lgkmcnt(3)
    v_mfma_f32_16x16x32_bf16 v[200:203], v[148:151], v[180:183], 0
    v_mfma_f32_16x16x32_bf16 v[252:255], v[152:155], v[180:183], 0
    s_waitcnt lgkmcnt(2)
    v_mfma_f32_16x16x32_bf16 v[184:187], v[76:79], v[160:163], v[184:187]
    s_waitcnt lgkmcnt(1)
    v_mfma_f32_16x16x32_bf16 v[184:187], v[80:83], v[164:167], v[184:187]
    s_waitcnt lgkmcnt(0)
    v_mfma_f32_16x16x32_bf16 v[184:187], v[84:87], v[168:171], v[184:187]
    v_mfma_f32_16x16x32_bf16 v[188:191], v[88:91], v[160:163], v[188:191]
    v_mfma_f32_16x16x32_bf16 v[188:191], v[92:95], v[164:167], v[188:191]
    v_cvt_pk_bf16_f32 v184, v184, v185
    v_cvt_pk_bf16_f32 v185, v186, v187
    v_mfma_f32_16x16x32_bf16 v[188:191], v[96:99], v[168:171], v[188:191]
    v_mfma_f32_16x16x32_bf16 v[192:195], v[100:103], v[160:163], v[192:195]
    v_mfma_f32_16x16x32_bf16 v[192:195], v[104:107], v[164:167], v[192:195]
    v_cvt_pk_bf16_f32 v186, v188, v189
    v_cvt_pk_bf16_f32 v187, v190, v191
    v_mfma_f32_16x16x32_bf16 v[192:195], v[108:111], v[168:171], v[192:195]
    v_mfma_f32_16x16x32_bf16 v[196:199], v[112:115], v[160:163], v[196:199]
    v_mfma_f32_16x16x32_bf16 v[196:199], v[116:119], v[164:167], v[196:199]
    v_cvt_pk_bf16_f32 v192, v192, v193
    v_cvt_pk_bf16_f32 v193, v194, v195
    v_mfma_f32_16x16x32_bf16 v[196:199], v[120:123], v[168:171], v[196:199]
    v_mfma_f32_16x16x32_bf16 v[200:203], v[124:127], v[160:163], v[200:203]
    v_mfma_f32_16x16x32_bf16 v[200:203], v[128:131], v[164:167], v[200:203]
    v_cvt_pk_bf16_f32 v194, v196, v197
    v_cvt_pk_bf16_f32 v195, v198, v199
    v_mfma_f32_16x16x32_bf16 v[200:203], v[132:135], v[168:171], v[200:203]
    v_mfma_f32_16x16x32_bf16 v[252:255], v[136:139], v[160:163], v[252:255]
    v_mfma_f32_16x16x32_bf16 v[252:255], v[140:143], v[164:167], v[252:255]
    v_cvt_pk_bf16_f32 v200, v200, v201
    v_cvt_pk_bf16_f32 v201, v202, v203
    v_mfma_f32_16x16x32_bf16 v[252:255], v[144:147], v[168:171], v[252:255]
    buffer_store_dwordx4 v[184:187], v218, s[8:11], s49 offen sc0 sc1
    buffer_store_dwordx4 v[192:195], v218, s[8:11], s49 offen offset:64 sc0 sc1
    s_nop 5
    v_cvt_pk_bf16_f32 v202, v252, v253
    v_cvt_pk_bf16_f32 v203, v254, v255
    buffer_store_dwordx4 v[200:203], v218, s[8:11], s49 offen offset:128 sc0 sc1
    ds_add_u32 v214, v214 offset:16
    ds_read_b32 v215, v214 offset:20
    ds_read_b128 v[172:175], v205 offset:58368
    ds_read_b128 v[176:179], v205 offset:59392
    ds_read_b128 v[180:183], v205 offset:60416
    s_add_u32 s93, s93, 0x1010101
    v_mov_b32 v227, 0xe480
    s_waitcnt lgkmcnt(3)
    v_readfirstlane_b32 s91, v215
    s_waitcnt lgkmcnt(2)
    v_mfma_f32_16x16x32_bf16 v[184:187], v[148:151], v[172:175], 0
    v_mfma_f32_16x16x32_bf16 v[188:191], v[152:155], v[172:175], 0
    s_sub_u32 s91, s91, s93
    s_andn2_b32 s91, 0x80808080, s91
    s_cbranch_scc1 L_sw27
L_sb27:
    s_waitcnt lgkmcnt(1)
    v_mfma_f32_16x16x32_bf16 v[192:195], v[148:151], v[176:179], 0
    ds_read_b128 v[160:163], v207 offset:24576
    ds_read_b128 v[164:167], v207 offset:25600
    v_mfma_f32_16x16x32_bf16 v[196:199], v[152:155], v[176:179], 0
    ds_read_b128 v[168:171], v207 offset:26624
    s_add_u32 s58, s38, 7
    s_waitcnt lgkmcnt(3)
    v_mfma_f32_16x16x32_bf16 v[200:203], v[148:151], v[180:183], 0
    v_readlane_b32 s49, v224, s58
    v_mfma_f32_16x16x32_bf16 v[252:255], v[152:155], v[180:183], 0
    s_nop 0
    s_cmp_lt_u32 s49, 0x40000000
    s_cselect_b32 s10, 0x2fd00c0, 0
    s_and_b32 s49, s49, 0x3fffffc0
    s_waitcnt lgkmcnt(2)
    v_mfma_f32_16x16x32_bf16 v[184:187], v[76:79], v[160:163], v[184:187]
    s_waitcnt lgkmcnt(1)
    v_mfma_f32_16x16x32_bf16 v[184:187], v[80:83], v[164:167], v[184:187]
    s_waitcnt lgkmcnt(0)
    v_mfma_f32_16x16x32_bf16 v[184:187], v[84:87], v[168:171], v[184:187]
    v_mfma_f32_16x16x32_bf16 v[188:191], v[88:91], v[160:163], v[188:191]
    v_mfma_f32_16x16x32_bf16 v[188:191], v[92:95], v[164:167], v[188:191]
    v_cvt_pk_bf16_f32 v184, v184, v185
    v_cvt_pk_bf16_f32 v185, v186, v187
    v_mfma_f32_16x16x32_bf16 v[188:191], v[96:99], v[168:171], v[188:191]
    v_mfma_f32_16x16x32_bf16 v[192:195], v[100:103], v[160:163], v[192:195]
    v_mfma_f32_16x16x32_bf16 v[192:195], v[104:107], v[164:167], v[192:195]
    v_cvt_pk_bf16_f32 v186, v188, v189
    v_cvt_pk_bf16_f32 v187, v190, v191
    v_mfma_f32_16x16x32_bf16 v[192:195], v[108:111], v[168:171], v[192:195]
    v_mfma_f32_16x16x32_bf16 v[196:199], v[112:115], v[160:163], v[196:199]
    v_mfma_f32_16x16x32_bf16 v[196:199], v[116:119], v[164:167], v[196:199]
    v_cvt_pk_bf16_f32 v192, v192, v193
    v_cvt_pk_bf16_f32 v193, v194, v195
    v_mfma_f32_16x16x32_bf16 v[196:199], v[120:123], v[168:171], v[196:199]
    v_mfma_f32_16x16x32_bf16 v[200:203], v[124:127], v[160:163], v[200:203]
    v_mfma_f32_16x16x32_bf16 v[200:203], v[128:131], v[164:167], v[200:203]
    v_cvt_pk_bf16_f32 v194, v196, v197
    v_cvt_pk_bf16_f32 v195, v198, v199
    v_mfma_f32_16x16x32_bf16 v[200:203], v[132:135], v[168:171], v[200:203]
    v_mfma_f32_16x16x32_bf16 v[252:255], v[136:139], v[160:163], v[252:255]
    v_mfma_f32_16x16x32_bf16 v[252:255], v[140:143], v[164:167], v[252:255]
    v_cvt_pk_bf16_f32 v200, v200, v201
    v_cvt_pk_bf16_f32 v201, v202, v203
    v_mfma_f32_16x16x32_bf16 v[252:255], v[144:147], v[168:171], v[252:255]
    buffer_store_dwordx4 v[184:187], v218, s[8:11], s49 offen sc0 sc1
    buffer_store_dwordx4 v[192:195], v218, s[8:11], s49 offen offset:64 sc0 sc1
    s_nop 5
    v_cvt_pk_bf16_f32 v202, v252, v253
    v_cvt_pk_bf16_f32 v203, v254, v255
    buffer_store_dwordx4 v[200:203], v218, s[8:11], s49 offen offset:128 sc0 sc1
    s_waitcnt lgkmcnt(0)
    s_barrier
    ds_read_b32 v223, v227
    s_waitcnt lgkmcnt(0)
    v_cmp_ne_u32 vcc, 0, v223
    s_cmp_lg_u32 s36, 0
    s_nop 2
    s_cbranch_scc1 L_T3end
    s_cbranch_vccz L_T3end
    s_mov_b32 s36, 1
    s_waitcnt vmcnt(0)
    s_mov_b32 s38, -4
    s_add_u32 s56, s38, 12
    v_readlane_b32 s46, v224, s56
    s_nop 1
    s_and_b32 s47, s46, 63
    s_cmp_lt_u32 s46, 0x40000000
    s_cselect_b32 s94, 0x2fe80c0, 0
    s_and_b32 s46, s46, 0x3fffffc0
    s_add_u32 s46, s46, s59
    s_cmp_eq_u32 s47, s48
    s_cbranch_scc1 L_cls18
    s_mov_b32 s48, s47
    s_and_b32 s40, s47, 8
    s_cselect_b64 s[84:85], s[76:77], 0
    v_or_b32 v227, 0x80000000, v211
    v_cndmask_b32 v209, v211, v227, s[84:85]
    s_and_b32 s40, s47, 16
    s_cselect_b64 s[84:85], s[78:79], 0
    v_or_b32 v227, 0x80000000, v212
    v_cndmask_b32 v210, v212, v227, s[84:85]
    s_nop 1
L_cls18:
    s_mov_b32 s6, s94
    s_add_u32 m0, s53, 0
    s_add_u32 s41, s46, 0
    buffer_load_dwordx4 v209, s[4:7], s41 offen nt lds
    s_add_u32 m0, s53, 0x400
    s_mov_b64 exec, s[80:81]
    buffer_load_dwordx4 v210, s[4:7], s41 offen nt lds
    s_mov_b64 exec, -1
    s_mov_b32 s6, s94
    s_add_u32 m0, s53, 0x750
    s_add_u32 s41, s46, 0x17f40
    buffer_load_dwordx4 v209, s[4:7], s41 offen nt lds
    s_add_u32 m0, s53, 0xb50
    s_mov_b64 exec, s[80:81]
    buffer_load_dwordx4 v210, s[4:7], s41 offen nt lds
    s_mov_b64 exec, -1
    s_and_b32 s40, s47, s39
    s_cselect_b32 s6, 0, s94
    s_add_u32 m0, s53, 0xea0
    s_add_u32 s41, s46, 0x2fe80
    buffer_load_dwordx4 v209, s[4:7], s41 offen nt lds
    s_add_u32 m0, s53, 0x12a0
    s_mov_b64 exec, s[80:81]
    buffer_load_dwordx4 v210, s[4:7], s41 offen nt lds
    s_mov_b64 exec, -1
    v_add_u32 v208, 0xc00, v205
    s_mov_b32 s50, 0xe400
    s_waitcnt lgkmcnt(0) vmcnt(0)
    s_barrier
    s_branch L_T3start
L_T3end:
    s_endpgm
L_sw18:
    s_sleep 2
    ds_read_b32 v215, v214 offset:20
    s_waitcnt lgkmcnt(0)
    v_readfirstlane_b32 s91, v215
    s_nop 1
    s_sub_u32 s91, s91, s93
    s_andn2_b32 s91, 0x80808080, s91
    s_cbranch_scc1 L_sw18
    s_branch L_sb18
L_sw20:
    s_sleep 2
    ds_read_b32 v215, v214 offset:20
    s_waitcnt lgkmcnt(0)
    v_readfirstlane_b32 s91, v215
    s_nop 1
    s_sub_u32 s91, s91, s93
    s_andn2_b32 s91, 0x80808080, s91
    s_cbranch_scc1 L_sw20
    s_branch L_sb20
L_sw22:
    s_sleep 2
    ds_read_b32 v215, v214 offset:20
    s_waitcnt lgkmcnt(0)
    v_readfirstlane_b32 s91, v215
    s_nop 1
    s_sub_u32 s91, s91, s93
    s_andn2_b32 s91, 0x80808080, s91
    s_cbranch_scc1 L_sw22
    s_branch L_sb22
L_sw24:
    s_sleep 2
    ds_read_b32 v215, v214 offset:20
    s_waitcnt lgkmcnt(0)
    v_readfirstlane_b32 s91, v215
    s_nop 1
    s_sub_u32 s91, s91, s93
    s_andn2_b32 s91, 0x80808080, s91
    s_cbranch_scc1 L_sw24
    s_branch L_sb24
L_sw26:
    s_sleep 2
    ds_read_b32 v215, v214 offset:20
    s_waitcnt lgkmcnt(0)
    v_readfirstlane_b32 s91, v215
    s_nop 1
    s_sub_u32 s91, s91, s93
    s_andn2_b32 s91, 0x80808080, s91
    s_cbranch_scc1 L_sw26
    s_branch L_sb26
L_sw27:
    s_sleep 2
    ds_read_b32 v215, v214 offset:20
    s_waitcnt lgkmcnt(0)
    v_readfirstlane_b32 s91, v215
    s_nop 1
    s_sub_u32 s91, s91, s93
    s_andn2_b32 s91, 0x80808080, s91
    s_cbranch_scc1 L_sw27
    s_branch L_sb27
L_end:
    s_endpgm
L_hotend:
L_Asafe:
    v_mov_b32 v239, 0
    ds_write_b32 v238, v239 offset:16
    ds_write_b32 v238, v239 offset:20
    s_waitcnt lgkmcnt(0)
    s_barrier
    s_waitcnt lgkmcnt(0)
    s_barrier
    s_setprio 2
    ds_read_b128 v[214:217], v148
    ds_read_b128 v[218:221], v148 offset:1024
    ds_read_b128 v[222:225], v148 offset:2048
    ds_read_b128 v[226:229], v148 offset:6144
    ds_read_b128 v[230:233], v148 offset:7168
    ds_read_b128 v[234:237], v148 offset:8192
    s_mov_b32 s92, 0
    s_mov_b32 s37, 0
    s_waitcnt lgkmcnt(5)
    v_mfma_f32_16x16x32_bf16 v[238:241], v[0:3], v[214:217], 0
    s_setprio 0
    s_waitcnt lgkmcnt(4)
    v_mfma_f32_16x16x32_bf16 v[238:241], v[4:7], v[218:221], v[238:241]
    s_waitcnt lgkmcnt(3)
    v_mfma_f32_16x16x32_bf16 v[238:241], v[8:11], v[222:225], v[238:241]
    v_mfma_f32_16x16x32_bf16 v[242:245], v[12:15], v[214:217], 0
    v_mfma_f32_16x16x32_bf16 v[242:245], v[16:19], v[218:221], v[242:245]
    v_cvt_pk_bf16_f32 v238, v238, v239
    v_cndmask_b32 v136, 0, v238, s[60:61]
    v_mfma_f32_16x16x32_bf16 v[242:245], v[20:23], v[222:225], v[242:245]
    v_cndmask_b32 v140, 0, v238, s[62:63]
    v_cndmask_b32 v144, 0, v238, s[64:65]
    v_mfma_f32_16x16x32_bf16 v[246:249], v[24:27], v[214:217], 0
    v_cvt_pk_bf16_f32 v240, v240, v241
    v_cndmask_b32 v137, 0, v240, s[60:61]
    v_mfma_f32_16x16x32_bf16 v[246:249], v[28:31], v[218:221], v[246:249]
    v_cndmask_b32 v141, 0, v240, s[62:63]
    v_cndmask_b32 v145, 0, v240, s[64:65]
    v_mfma_f32_16x16x32_bf16 v[246:249], v[32:35], v[222:225], v[246:249]
    v_cvt_pk_bf16_f32 v122, v244, v245
    v_cvt_pk_bf16_f32 v242, v242, v243
    v_mfma_f32_16x16x32_bf16 v[250:253], v[214:217], v[36:39], 0
    v_cndmask_b32 v138, 0, v242, s[60:61]
    v_cndmask_b32 v142, 0, v242, s[62:63]
    v_mfma_f32_16x16x32_bf16 v[250:253], v[218:221], v[40:43], v[250:253]
    v_cndmask_b32 v146, 0, v242, s[64:65]
    v_cvt_pk_bf16_f32 v120, v246, v247
    v_mfma_f32_16x16x32_bf16 v[250:253], v[222:225], v[44:47], v[250:253]
    s_setprio 2
    v_cvt_pk_bf16_f32 v121, v248, v249
    v_mfma_f32_16x16x32_bf16 v[238:241], v[214:217], v[48:51], v[166:169]
    ds_read_b128 v[214:217], v148 offset:9216
    v_mfma_f32_16x16x32_bf16 v[238:241], v[218:221], v[52:55], v[238:241]
    v_cvt_pk_bf16_f32 v65, v250, v251
    v_cvt_pk_bf16_f32 v81, v250, v251
    v_mfma_f32_16x16x32_bf16 v[238:241], v[222:225], v[56:59], v[238:241]
    ds_read_b128 v[218:221], v148 offset:10240
    ds_read_b128 v[222:225], v148 offset:11264
    s_waitcnt lgkmcnt(3)
    v_mfma_f32_16x16x32_bf16 v[242:245], v[0:3], v[226:229], 0
    s_setprio 0
    v_mfma_f32_16x16x32_bf16 v[242:245], v[4:7], v[230:233], v[242:245]
    v_cvt_pk_bf16_f32 v73, v238, v239
    v_cvt_pk_bf16_f32 v89, v238, v239
    v_mfma_f32_16x16x32_bf16 v[242:245], v[8:11], v[234:237], v[242:245]
    v_mfma_f32_16x16x32_bf16 v[246:249], v[12:15], v[226:229], 0
    v_mfma_f32_16x16x32_bf16 v[246:249], v[16:19], v[230:233], v[246:249]
    v_cvt_pk_bf16_f32 v124, v242, v243
    v_cvt_pk_bf16_f32 v125, v244, v245
    v_mfma_f32_16x16x32_bf16 v[246:249], v[20:23], v[234:237], v[246:249]
    v_mfma_f32_16x16x32_bf16 v[250:253], v[24:27], v[226:229], 0
    v_mfma_f32_16x16x32_bf16 v[250:253], v[28:31], v[230:233], v[250:253]
    v_cvt_pk_bf16_f32 v110, v248, v249
    v_cvt_pk_bf16_f32 v126, v246, v247
    v_mfma_f32_16x16x32_bf16 v[250:253], v[32:35], v[234:237], v[250:253]
    v_mfma_f32_16x16x32_bf16 v[238:241], v[226:229], v[36:39], 0
    v_mfma_f32_16x16x32_bf16 v[238:241], v[230:233], v[40:43], v[238:241]
    v_cvt_pk_bf16_f32 v108, v250, v251
    v_cvt_pk_bf16_f32 v109, v252, v253
    v_mfma_f32_16x16x32_bf16 v[238:241], v[234:237], v[44:47], v[238:241]
    s_setprio 2
    v_mfma_f32_16x16x32_bf16 v[242:245], v[226:229], v[48:51], v[166:169]
    ds_read_b128 v[226:229], v148 offset:12288
    v_mfma_f32_16x16x32_bf16 v[242:245], v[230:233], v[52:55], v[242:245]
    v_cvt_pk_bf16_f32 v60, v238, v239
    v_cvt_pk_bf16_f32 v61, v240, v241
    v_mfma_f32_16x16x32_bf16 v[242:245], v[234:237], v[56:59], v[242:245]
    ds_read_b128 v[230:233], v148 offset:13312
    ds_read_b128 v[234:237], v148 offset:14336
    s_waitcnt lgkmcnt(3)
    v_mfma_f32_16x16x32_bf16 v[246:249], v[0:3], v[214:217], 0
    s_setprio 0
    v_mfma_f32_16x16x32_bf16 v[246:249], v[4:7], v[218:221], v[246:249]
    v_cvt_pk_bf16_f32 v68, v242, v243
    v_cvt_pk_bf16_f32 v69, v244, v245
    v_mfma_f32_16x16x32_bf16 v[246:249], v[8:11], v[222:225], v[246:249]
    v_mfma_f32_16x16x32_bf16 v[250:253], v[12:15], v[214:217], 0
    v_mfma_f32_16x16x32_bf16 v[250:253], v[16:19], v[218:221], v[250:253]
    v_cvt_pk_bf16_f32 v128, v246, v247
    v_cvt_pk_bf16_f32 v129, v248, v249
    v_mfma_f32_16x16x32_bf16 v[250:253], v[20:23], v[222:225], v[250:253]
    v_mfma_f32_16x16x32_bf16 v[238:241], v[24:27], v[214:217], 0
    v_mfma_f32_16x16x32_bf16 v[238:241], v[28:31], v[218:221], v[238:241]
    v_cvt_pk_bf16_f32 v114, v252, v253
    v_cvt_pk_bf16_f32 v130, v250, v251
    v_mfma_f32_16x16x32_bf16 v[238:241], v[32:35], v[222:225], v[238:241]
    v_mfma_f32_16x16x32_bf16 v[242:245], v[214:217], v[36:39], 0
    v_mfma_f32_16x16x32_bf16 v[242:245], v[218:221], v[40:43], v[242:245]
    v_cvt_pk_bf16_f32 v112, v238, v239
    v_cvt_pk_bf16_f32 v113, v240, v241
    v_mfma_f32_16x16x32_bf16 v[242:245], v[222:225], v[44:47], v[242:245]
    v_mfma_f32_16x16x32_bf16 v[246:249], v[214:217], v[48:51], v[166:169]
    v_mfma_f32_16x16x32_bf16 v[246:249], v[218:221], v[52:55], v[246:249]
    v_cvt_pk_bf16_f32 v62, v242, v243
    v_cvt_pk_bf16_f32 v63, v244, v245
    v_mfma_f32_16x16x32_bf16 v[246:249], v[222:225], v[56:59], v[246:249]
    s_waitcnt lgkmcnt(0)
    v_mfma_f32_16x16x32_bf16 v[250:253], v[0:3], v[226:229], 0
    v_mfma_f32_16x16x32_bf16 v[250:253], v[4:7], v[230:233], v[250:253]
    v_cvt_pk_bf16_f32 v70, v246, v247
    v_cvt_pk_bf16_f32 v71, v248, v249
    v_mfma_f32_16x16x32_bf16 v[250:253], v[8:11], v[234:237], v[250:253]
    v_mfma_f32_16x16x32_bf16 v[238:241], v[12:15], v[226:229], 0
    v_mfma_f32_16x16x32_bf16 v[238:241], v[16:19], v[230:233], v[238:241]
    v_cvt_pk_bf16_f32 v132, v250, v251
    v_cvt_pk_bf16_f32 v133, v252, v253
    v_mfma_f32_16x16x32_bf16 v[238:241], v[20:23], v[234:237], v[238:241]
    v_mfma_f32_16x16x32_bf16 v[242:245], v[24:27], v[226:229], 0
    v_mfma_f32_16x16x32_bf16 v[242:245], v[28:31], v[230:233], v[242:245]
    v_cvt_pk_bf16_f32 v118, v240, v241
    v_cvt_pk_bf16_f32 v134, v238, v239
    v_mfma_f32_16x16x32_bf16 v[242:245], v[32:35], v[234:237], v[242:245]
    v_mfma_f32_16x16x32_bf16 v[246:249], v[226:229], v[36:39], 0
    v_mfma_f32_16x16x32_bf16 v[246:249], v[230:233], v[40:43], v[246:249]
    v_cvt_pk_bf16_f32 v116, v242, v243
    v_cvt_pk_bf16_f32 v117, v244, v245
    v_mfma_f32_16x16x32_bf16 v[246:249], v[234:237], v[44:47], v[246:249]
    v_mfma_f32_16x16x32_bf16 v[250:253], v[226:229], v[48:51], v[166:169]
    v_mfma_f32_16x16x32_bf16 v[250:253], v[230:233], v[52:55], v[250:253]
    v_cvt_pk_bf16_f32 v66, v246, v247
    v_cvt_pk_bf16_f32 v67, v248, v249
    v_mfma_f32_16x16x32_bf16 v[250:253], v[234:237], v[56:59], v[250:253]
    s_nop 7
    v_cvt_pk_bf16_f32 v74, v250, v251
    v_cvt_pk_bf16_f32 v75, v252, v253
    s_waitcnt lgkmcnt(0)
    s_nop 0
L_Asloop:
    s_setprio 2
    v_mfma_f32_16x16x32_bf16 v[184:187], v[108:111], v[124:127], 0
    ds_read_b32 v255, v127 offset:16
    s_add_u32 s92, s92, 0x39200
    v_mfma_f32_16x16x32_bf16 v[188:191], v[112:115], v[124:127], 0
    s_setprio 0
    v_mov_b32 v97, v65
    v_mov_b32 v105, v73
    v_mfma_f32_16x16x32_bf16 v[180:183], v[116:119], v[124:127], 0
    v_mfma_f32_16x16x32_bf16 v[192:195], v[120:123], v[124:127], v[170:173]
    v_mfma_f32_16x16x32_bf16 v[202:205], v[108:111], v[128:131], 0
    v_mfma_f32_16x16x32_bf16 v[206:209], v[112:115], v[128:131], 0
    v_mfma_f32_16x16x32_bf16 v[198:201], v[116:119], v[128:131], 0
    s_waitcnt lgkmcnt(0)
    v_readfirstlane_b32 s91, v255
    v_mfma_f32_16x16x32_bf16 v[210:213], v[120:123], v[128:131], v[170:173]
    v_mfma_f32_16x16x32_bf16 v[154:157], v[108:111], v[136:139], 0
    s_setprio 2
    s_cmp_lt_u32 s91, s92
    s_cbranch_scc1 L_sw28
L_sb28:
    v_max3_f32 v173, v184, v185, v186
    v_mfma_f32_16x16x32_bf16 v[158:161], v[112:115], v[136:139], 0
    ds_read_b128 v[214:217], v148 offset:24576
    ds_read_b128 v[218:221], v148 offset:25600
    v_mfma_f32_16x16x32_bf16 v[150:153], v[116:119], v[136:139], 0
    ds_read_b128 v[222:225], v148 offset:26624
    ds_read_b128 v[226:229], v148 offset:27648
    v_mfma_f32_16x16x32_bf16 v[162:165], v[120:123], v[136:139], v[176:179]
    ds_read_b128 v[230:233], v148 offset:28672
    ds_read_b128 v[234:237], v148 offset:29696
    v_max3_f32 v173, v173, v187, v188
    v_max3_f32 v173, v173, v189, v190
    v_max3_f32 v173, v173, v191, v180
    v_max3_f32 v173, v173, v181, v182
    v_max3_f32 v173, v173, v183, v192
    v_mov_b32 v175, v173
    s_nop 1
    v_permlane16_swap_b32 v173, v175
    v_max_f32 v173, v173, v175
    v_mov_b32 v175, v173
    s_waitcnt lgkmcnt(5)
    v_mfma_f32_16x16x32_bf16 v[238:241], v[214:217], v[36:39], 0
    s_setprio 0
    v_permlane32_swap_b32 v173, v175
    s_waitcnt lgkmcnt(4)
    v_mfma_f32_16x16x32_bf16 v[238:241], v[218:221], v[40:43], v[238:241]
    s_waitcnt lgkmcnt(2)
    v_max_f32 v173, v173, v175
    v_sub_f32 v184, v184, v173
    v_mfma_f32_16x16x32_bf16 v[238:241], v[222:225], v[44:47], v[238:241]
    v_sub_f32 v185, v185, v173
    v_sub_f32 v186, v186, v173
    v_mfma_f32_16x16x32_bf16 v[242:245], v[214:217], v[48:51], v[166:169]
    v_sub_f32 v187, v187, v173
    v_sub_f32 v188, v188, v173
    v_mfma_f32_16x16x32_bf16 v[242:245], v[218:221], v[52:55], v[242:245]
    v_cvt_pk_bf16_f32 v76, v238, v239
    v_cvt_pk_bf16_f32 v77, v240, v241
    v_mfma_f32_16x16x32_bf16 v[242:245], v[222:225], v[56:59], v[242:245]
    v_sub_f32 v189, v189, v173
    v_sub_f32 v190, v190, v173
    v_mfma_f32_16x16x32_bf16 v[246:249], v[0:3], v[214:217], 0
    v_sub_f32 v191, v191, v173
    v_sub_f32 v180, v180, v173
    v_mfma_f32_16x16x32_bf16 v[246:249], v[4:7], v[218:221], v[246:249]
    v_cvt_pk_bf16_f32 v84, v242, v243
    v_cvt_pk_bf16_f32 v85, v244, v245
    v_mfma_f32_16x16x32_bf16 v[246:249], v[8:11], v[222:225], v[246:249]
    v_sub_f32 v181, v181, v173
    v_sub_f32 v182, v182, v173
    v_mfma_f32_16x16x32_bf16 v[250:253], v[226:229], v[36:39], 0
    s_waitcnt lgkmcnt(0)
    v_sub_f32 v183, v183, v173
    v_sub_f32 v192, v192, v173
    v_mfma_f32_16x16x32_bf16 v[250:253], v[230:233], v[40:43], v[250:253]
    v_cvt_pk_bf16_f32 v124, v246, v247
    v_cvt_pk_bf16_f32 v125, v248, v249
    v_mfma_f32_16x16x32_bf16 v[250:253], v[234:237], v[44:47], v[250:253]
    v_exp_f32 v184, v184
    v_mfma_f32_16x16x32_bf16 v[238:241], v[226:229], v[48:51], v[166:169]
    v_exp_f32 v185, v185
    v_mfma_f32_16x16x32_bf16 v[238:241], v[230:233], v[52:55], v[238:241]
    v_exp_f32 v186, v186
    v_mfma_f32_16x16x32_bf16 v[238:241], v[234:237], v[56:59], v[238:241]
    v_exp_f32 v187, v187
    v_mfma_f32_16x16x32_bf16 v[242:245], v[0:3], v[226:229], 0
    v_cvt_pk_bf16_f32 v184, v184, v185
    v_cvt_pk_bf16_f32 v185, v186, v187
    v_mfma_f32_16x16x32_bf16 v[242:245], v[4:7], v[230:233], v[242:245]
    v_exp_f32 v188, v188
    v_mfma_f32_16x16x32_bf16 v[242:245], v[8:11], v[234:237], v[242:245]
    v_exp_f32 v189, v189
    v_mfma_f32_16x16x32_bf16 v[246:249], v[12:15], v[214:217], 0
    v_exp_f32 v190, v190
    v_mfma_f32_16x16x32_bf16 v[246:249], v[16:19], v[218:221], v[246:249]
    v_exp_f32 v191, v191
    v_mfma_f32_16x16x32_bf16 v[246:249], v[20:23], v[222:225], v[246:249]
    v_cvt_pk_bf16_f32 v186, v188, v189
    v_cvt_pk_bf16_f32 v187, v190, v191
    v_exp_f32 v180, v180
    s_nop 0
    v_mfma_f32_16x16x32_bf16 v[188:191], v[60:63], v[184:187], 0
    v_exp_f32 v181, v181
    v_exp_f32 v182, v182
    v_exp_f32 v183, v183
    v_cvt_pk_bf16_f32 v180, v180, v181
    v_cvt_pk_bf16_f32 v181, v182, v183
    v_exp_f32 v192, v192
    v_cvt_pk_bf16_f32 v78, v250, v251
    v_cvt_pk_bf16_f32 v179, v192, 0
    v_mfma_f32_16x16x32_bf16 v[192:195], v[68:71], v[184:187], 0
    v_cvt_pk_bf16_f32 v79, v252, v253
    v_cvt_pk_bf16_f32 v86, v238, v239
    v_mfma_f32_16x16x32_bf16 v[192:195], v[72:75], v[178:181], v[192:195]
    v_cvt_pk_bf16_f32 v87, v240, v241
    v_cvt_pk_bf16_f32 v128, v242, v243
    v_mfma_f32_16x16x32_bf16 v[188:191], v[64:67], v[178:181], v[188:191]
    v_cvt_pk_bf16_f32 v129, v244, v245
    v_cvt_pk_bf16_f32 v126, v246, v247
    v_mfma_f32_16x16x32_bf16 v[184:187], v[108:111], v[132:135], 0
    v_rcp_f32 v195, v194
    v_mfma_f32_16x16x32_bf16 v[180:183], v[116:119], v[132:135], 0
    v_mul_f32 v195, 0x3febdf1c, v195
    v_mul_f32 v188, v188, v195
    v_mfma_f32_16x16x32_bf16 v[250:253], v[24:27], v[214:217], 0
    s_setprio 2
    v_mul_f32 v189, v189, v195
    v_mul_f32 v190, v190, v195
    v_mfma_f32_16x16x32_bf16 v[250:253], v[28:31], v[218:221], v[250:253]
    ds_read_b128 v[214:217], v148 offset:30720
    ds_read_b128 v[218:221], v148 offset:31744
    v_mfma_f32_16x16x32_bf16 v[250:253], v[32:35], v[222:225], v[250:253]
    v_mul_f32 v191, v191, v195
    v_mul_f32 v192, v192, v195
    v_mfma_f32_16x16x32_bf16 v[238:241], v[12:15], v[226:229], 0
    ds_read_b128 v[222:225], v148 offset:32768
    v_mul_f32 v193, v193, v195
    v_mfma_f32_16x16x32_bf16 v[238:241], v[16:19], v[230:233], v[238:241]
    v_cvt_pk_bf16_f32 v188, v188, v189
    v_cvt_pk_bf16_f32 v189, v190, v191
    v_mfma_f32_16x16x32_bf16 v[238:241], v[20:23], v[234:237], v[238:241]
    ds_write_b64 v178, v[188:189]
    v_mfma_f32_16x16x32_bf16 v[188:191], v[112:115], v[132:135], 0
    v_cvt_pk_bf16_f32 v192, v192, v193
    v_cvt_pk_bf16_f32 v110, v248, v249
    v_mfma_f32_16x16x32_bf16 v[242:245], v[24:27], v[226:229], 0
    ds_write_b32 v196, v192
    v_mfma_f32_16x16x32_bf16 v[192:195], v[120:123], v[132:135], v[170:173]
    s_setprio 0
    v_cvt_pk_bf16_f32 v108, v250, v251
    v_cvt_pk_bf16_f32 v109, v252, v253
    v_mfma_f32_16x16x32_bf16 v[242:245], v[28:31], v[230:233], v[242:245]
    v_max3_f32 v173, v202, v203, v204
    v_max3_f32 v173, v173, v205, v206
    v_mfma_f32_16x16x32_bf16 v[242:245], v[32:35], v[234:237], v[242:245]
    s_waitcnt lgkmcnt(2)
    v_max3_f32 v173, v173, v207, v208
    v_max3_f32 v173, v173, v209, v198
    v_mfma_f32_16x16x32_bf16 v[246:249], v[0:3], v[214:217], 0
    v_max3_f32 v173, v173, v199, v200
    v_max3_f32 v173, v173, v201, v210
    v_mfma_f32_16x16x32_bf16 v[246:249], v[4:7], v[218:221], v[246:249]
    v_mov_b32 v175, v173
    v_cvt_pk_bf16_f32 v114, v240, v241
    v_mfma_f32_16x16x32_bf16 v[246:249], v[8:11], v[222:225], v[246:249]
    v_permlane16_swap_b32 v173, v175
    v_mfma_f32_16x16x32_bf16 v[250:253], v[12:15], v[214:217], 0
    v_max_f32 v173, v173, v175
    v_mov_b32 v175, v173
    v_mfma_f32_16x16x32_bf16 v[250:253], v[16:19], v[218:221], v[250:253]
    s_nop 0
    v_permlane32_swap_b32 v173, v175
    v_mfma_f32_16x16x32_bf16 v[250:253], v[20:23], v[222:225], v[250:253]
    v_max_f32 v173, v173, v175
    v_sub_f32 v202, v202, v173
    v_sub_f32 v203, v203, v173
    v_sub_f32 v204, v204, v173
    v_sub_f32 v205, v205, v173
    v_sub_f32 v206, v206, v173
    v_sub_f32 v207, v207, v173
    v_sub_f32 v208, v208, v173
    v_sub_f32 v209, v209, v173
    v_sub_f32 v198, v198, v173
    v_sub_f32 v199, v199, v173
    v_sub_f32 v200, v200, v173
    v_sub_f32 v201, v201, v173
    v_sub_f32 v210, v210, v173
    v_exp_f32 v202, v202
    v_exp_f32 v203, v203
    v_exp_f32 v204, v204
    v_exp_f32 v205, v205
    v_cvt_pk_bf16_f32 v202, v202, v203
    v_cvt_pk_bf16_f32 v203, v204, v205
    v_exp_f32 v206, v206
    v_exp_f32 v207, v207
    v_exp_f32 v208, v208
    v_exp_f32 v209, v209
    v_cvt_pk_bf16_f32 v204, v206, v207
    v_cvt_pk_bf16_f32 v205, v208, v209
    v_exp_f32 v198, v198
    s_nop 0
    v_mfma_f32_16x16x32_bf16 v[206:209], v[60:63], v[202:205], 0
    v_exp_f32 v199, v199
    v_exp_f32 v200, v200
    v_exp_f32 v201, v201
    v_cvt_pk_bf16_f32 v198, v198, v199
    v_cvt_pk_bf16_f32 v199, v200, v201
    v_exp_f32 v210, v210
    v_cvt_pk_bf16_f32 v130, v238, v239
    v_mfma_f32_16x16x32_bf16 v[238:241], v[24:27], v[214:217], 0
    v_cvt_pk_bf16_f32 v197, v210, 0
    v_cvt_pk_bf16_f32 v112, v242, v243
    v_mfma_f32_16x16x32_bf16 v[210:213], v[68:71], v[202:205], 0
    v_cvt_pk_bf16_f32 v113, v244, v245
    v_max3_f32 v173, v184, v185, v186
    v_mfma_f32_16x16x32_bf16 v[210:213], v[72:75], v[196:199], v[210:213]
    v_max3_f32 v173, v173, v187, v188
    v_max3_f32 v173, v173, v189, v190
    v_mfma_f32_16x16x32_bf16 v[206:209], v[64:67], v[196:199], v[206:209]
    v_max3_f32 v173, v173, v191, v180
    v_max3_f32 v173, v173, v181, v182
    v_mfma_f32_16x16x32_bf16 v[238:241], v[28:31], v[218:221], v[238:241]
    v_rcp_f32 v213, v212
    v_mfma_f32_16x16x32_bf16 v[238:241], v[32:35], v[222:225], v[238:241]
    v_mul_f32 v213, 0x3febdf1c, v213
    v_mul_f32 v206, v206, v213
    v_mfma_f32_16x16x32_bf16 v[242:245], v[214:217], v[36:39], 0
    v_mul_f32 v207, v207, v213
    v_mul_f32 v208, v208, v213
    v_mfma_f32_16x16x32_bf16 v[242:245], v[218:221], v[40:43], v[242:245]
    v_mul_f32 v209, v209, v213
    v_mul_f32 v210, v210, v213
    v_mfma_f32_16x16x32_bf16 v[242:245], v[222:225], v[44:47], v[242:245]
    s_setprio 2
    v_mul_f32 v211, v211, v213
    v_cvt_pk_bf16_f32 v206, v206, v207
    v_cvt_pk_bf16_f32 v207, v208, v209
    v_cvt_pk_bf16_f32 v210, v210, v211
    v_max3_f32 v173, v173, v183, v192
    v_mov_b32 v175, v173
    v_cvt_pk_bf16_f32 v132, v246, v247
    v_cvt_pk_bf16_f32 v133, v248, v249
    v_mfma_f32_16x16x32_bf16 v[246:249], v[214:217], v[48:51], v[166:169]
    ds_write_b64 v178, v[206:207] offset:3072
    v_mfma_f32_16x16x32_bf16 v[246:249], v[218:221], v[52:55], v[246:249]
    ds_write_b32 v196, v210 offset:3072
    v_mfma_f32_16x16x32_bf16 v[246:249], v[222:225], v[56:59], v[246:249]
    s_setprio 0
    v_permlane16_swap_b32 v173, v175
    v_max_f32 v173, v173, v175
    v_mov_b32 v175, v173
    v_cvt_pk_bf16_f32 v118, v252, v253
    v_cvt_pk_bf16_f32 v134, v250, v251
    v_permlane32_swap_b32 v173, v175
    v_max_f32 v173, v173, v175
    v_sub_f32 v184, v184, v173
    v_sub_f32 v185, v185, v173
    v_sub_f32 v186, v186, v173
    v_sub_f32 v187, v187, v173
    v_sub_f32 v188, v188, v173
    v_sub_f32 v189, v189, v173
    v_sub_f32 v190, v190, v173
    v_sub_f32 v191, v191, v173
    v_sub_f32 v180, v180, v173
    v_sub_f32 v181, v181, v173
    v_sub_f32 v182, v182, v173
    v_sub_f32 v183, v183, v173
    v_sub_f32 v192, v192, v173
    v_exp_f32 v184, v184
    v_exp_f32 v185, v185
    v_exp_f32 v186, v186
    v_exp_f32 v187, v187
    v_cvt_pk_bf16_f32 v184, v184, v185
    v_cvt_pk_bf16_f32 v185, v186, v187
    v_exp_f32 v188, v188
    v_exp_f32 v189, v189
    v_exp_f32 v190, v190
    v_exp_f32 v191, v191
    v_cvt_pk_bf16_f32 v186, v188, v189
    v_cvt_pk_bf16_f32 v187, v190, v191
    v_exp_f32 v180, v180
    s_nop 0
    v_mfma_f32_16x16x32_bf16 v[188:191], v[60:63], v[184:187], 0
    v_exp_f32 v181, v181
    v_exp_f32 v182, v182
    v_exp_f32 v183, v183
    v_cvt_pk_bf16_f32 v180, v180, v181
    v_cvt_pk_bf16_f32 v181, v182, v183
    v_exp_f32 v192, v192
    v_cvt_pk_bf16_f32 v116, v238, v239
    v_cvt_pk_bf16_f32 v179, v192, 0
    v_mfma_f32_16x16x32_bf16 v[192:195], v[68:71], v[184:187], 0
    v_cvt_pk_bf16_f32 v117, v240, v241
    v_cvt_pk_bf16_f32 v82, v242, v243
    v_mfma_f32_16x16x32_bf16 v[192:195], v[72:75], v[178:181], v[192:195]
    s_setprio 2
    v_cvt_pk_bf16_f32 v83, v244, v245
    v_cvt_pk_bf16_f32 v90, v246, v247
    v_mfma_f32_16x16x32_bf16 v[188:191], v[64:67], v[178:181], v[188:191]
    v_cvt_pk_bf16_f32 v91, v248, v249
    s_nop 1
    v_rcp_f32 v195, v194
    s_nop 0
    v_mul_f32 v195, 0x3febdf1c, v195
    s_nop 0
    v_mul_f32 v188, v188, v195
    v_mul_f32 v189, v189, v195
    v_mul_f32 v190, v190, v195
    v_mul_f32 v191, v191, v195
    v_mul_f32 v192, v192, v195
    v_mul_f32 v193, v193, v195
    v_cvt_pk_bf16_f32 v188, v188, v189
    v_cvt_pk_bf16_f32 v189, v190, v191
    v_cvt_pk_bf16_f32 v192, v192, v193
    ds_write_b64 v178, v[188:189] offset:6144
    ds_write_b32 v196, v192 offset:6144
    ds_add_u32 v127, v131 offset:20
    s_setprio 0
    s_setprio 2
    v_mfma_f32_16x16x32_bf16 v[184:187], v[108:111], v[124:127], 0
    ds_read_b32 v255, v127 offset:16
    s_add_u32 s92, s92, 0x39200
    v_mfma_f32_16x16x32_bf16 v[188:191], v[112:115], v[124:127], 0
    s_setprio 0
    v_mfma_f32_16x16x32_bf16 v[180:183], v[116:119], v[124:127], 0
    v_mfma_f32_16x16x32_bf16 v[192:195], v[120:123], v[124:127], v[172:175]
    v_mfma_f32_16x16x32_bf16 v[202:205], v[108:111], v[128:131], 0
    v_mfma_f32_16x16x32_bf16 v[206:209], v[112:115], v[128:131], 0
    v_mfma_f32_16x16x32_bf16 v[198:201], v[116:119], v[128:131], 0
    s_waitcnt lgkmcnt(0)
    v_readfirstlane_b32 s91, v255
    v_mfma_f32_16x16x32_bf16 v[210:213], v[120:123], v[128:131], v[172:175]
    v_mfma_f32_16x16x32_bf16 v[154:157], v[108:111], v[140:143], v[154:157]
    s_setprio 2
    s_cmp_lt_u32 s91, s92
    s_cbranch_scc1 L_sw29
L_sb29:
    v_max3_f32 v173, v184, v185, v186
    v_mfma_f32_16x16x32_bf16 v[158:161], v[112:115], v[140:143], v[158:161]
    ds_read_b128 v[214:217], v148 offset:33792
    ds_read_b128 v[218:221], v148 offset:34816
    v_mfma_f32_16x16x32_bf16 v[150:153], v[116:119], v[140:143], v[150:153]
    ds_read_b128 v[222:225], v148 offset:35840
    ds_read_b128 v[226:229], v148 offset:36864
    v_mfma_f32_16x16x32_bf16 v[162:165], v[120:123], v[140:143], v[162:165]
    ds_read_b128 v[230:233], v148 offset:37888
    ds_read_b128 v[234:237], v148 offset:38912
    v_max3_f32 v173, v173, v187, v188
    v_max3_f32 v173, v173, v189, v190
    v_max3_f32 v173, v173, v191, v180
    v_max3_f32 v173, v173, v181, v182
    v_max3_f32 v173, v173, v183, v192
    v_mov_b32 v175, v173
    s_nop 1
    v_permlane16_swap_b32 v173, v175
    v_max_f32 v173, v173, v175
    v_mov_b32 v175, v173
    s_waitcnt lgkmcnt(5)
    v_mfma_f32_16x16x32_bf16 v[238:241], v[214:217], v[36:39], 0
    s_setprio 0
    v_permlane32_swap_b32 v173, v175
    s_waitcnt lgkmcnt(4)
    v_mfma_f32_16x16x32_bf16 v[238:241], v[218:221], v[40:43], v[238:241]
    s_waitcnt lgkmcnt(2)
    v_max_f32 v173, v173, v175
    v_sub_f32 v184, v184, v173
    v_mfma_f32_16x16x32_bf16 v[238:241], v[222:225], v[44:47], v[238:241]
    v_sub_f32 v185, v185, v173
    v_sub_f32 v186, v186, v173
    v_mfma_f32_16x16x32_bf16 v[242:245], v[214:217], v[48:51], v[166:169]
    v_sub_f32 v187, v187, v173
    v_sub_f32 v188, v188, v173
    v_mfma_f32_16x16x32_bf16 v[242:245], v[218:221], v[52:55], v[242:245]
    v_cvt_pk_bf16_f32 v92, v238, v239
    v_cvt_pk_bf16_f32 v93, v240, v241
    v_mfma_f32_16x16x32_bf16 v[242:245], v[222:225], v[56:59], v[242:245]
    v_sub_f32 v189, v189, v173
    v_sub_f32 v190, v190, v173
    v_mfma_f32_16x16x32_bf16 v[246:249], v[0:3], v[214:217], 0
    v_sub_f32 v191, v191, v173
    v_sub_f32 v180, v180, v173
    v_mfma_f32_16x16x32_bf16 v[246:249], v[4:7], v[218:221], v[246:249]
    v_cvt_pk_bf16_f32 v100, v242, v243
    v_cvt_pk_bf16_f32 v101, v244, v245
    v_mfma_f32_16x16x32_bf16 v[246:249], v[8:11], v[222:225], v[246:249]
    v_sub_f32 v181, v181, v173
    v_sub_f32 v182, v182, v173
    v_mfma_f32_16x16x32_bf16 v[250:253], v[226:229], v[36:39], 0
    s_waitcnt lgkmcnt(0)
    v_sub_f32 v183, v183, v173
    v_sub_f32 v192, v192, v173
    v_mfma_f32_16x16x32_bf16 v[250:253], v[230:233], v[40:43], v[250:253]
    v_cvt_pk_bf16_f32 v124, v246, v247
    v_cvt_pk_bf16_f32 v125, v248, v249
    v_mfma_f32_16x16x32_bf16 v[250:253], v[234:237], v[44:47], v[250:253]
    v_exp_f32 v184, v184
    v_mfma_f32_16x16x32_bf16 v[238:241], v[226:229], v[48:51], v[166:169]
    v_exp_f32 v185, v185
    v_mfma_f32_16x16x32_bf16 v[238:241], v[230:233], v[52:55], v[238:241]
    v_exp_f32 v186, v186
    v_mfma_f32_16x16x32_bf16 v[238:241], v[234:237], v[56:59], v[238:241]
    v_exp_f32 v187, v187
    v_mfma_f32_16x16x32_bf16 v[242:245], v[0:3], v[226:229], 0
    v_cvt_pk_bf16_f32 v184, v184, v185
    v_cvt_pk_bf16_f32 v185, v186, v187
    v_mfma_f32_16x16x32_bf16 v[242:245], v[4:7], v[230:233], v[242:245]
    v_exp_f32 v188, v188
    v_mfma_f32_16x16x32_bf16 v[242:245], v[8:11], v[234:237], v[242:245]
    v_exp_f32 v189, v189
    v_mfma_f32_16x16x32_bf16 v[246:249], v[12:15], v[214:217], 0
    v_exp_f32 v190, v190
    v_mfma_f32_16x16x32_bf16 v[246:249], v[16:19], v[218:221], v[246:249]
    v_exp_f32 v191, v191
    v_mfma_f32_16x16x32_bf16 v[246:249], v[20:23], v[222:225], v[246:249]
    v_cvt_pk_bf16_f32 v186, v188, v189
    v_cvt_pk_bf16_f32 v187, v190, v191
    v_exp_f32 v180, v180
    s_nop 0
    v_mfma_f32_16x16x32_bf16 v[188:191], v[76:79], v[184:187], 0
    v_exp_f32 v181, v181
    v_exp_f32 v182, v182
    v_exp_f32 v183, v183
    v_cvt_pk_bf16_f32 v180, v180, v181
    v_cvt_pk_bf16_f32 v181, v182, v183
    v_exp_f32 v192, v192
    v_cvt_pk_bf16_f32 v94, v250, v251
    v_cvt_pk_bf16_f32 v179, v192, 0
    v_mfma_f32_16x16x32_bf16 v[192:195], v[84:87], v[184:187], 0
    v_cvt_pk_bf16_f32 v95, v252, v253
    v_cvt_pk_bf16_f32 v102, v238, v239
    v_mfma_f32_16x16x32_bf16 v[192:195], v[88:91], v[178:181], v[192:195]
    v_cvt_pk_bf16_f32 v103, v240, v241
    v_cvt_pk_bf16_f32 v128, v242, v243
    v_mfma_f32_16x16x32_bf16 v[188:191], v[80:83], v[178:181], v[188:191]
    v_cvt_pk_bf16_f32 v129, v244, v245
    v_cvt_pk_bf16_f32 v126, v246, v247
    v_mfma_f32_16x16x32_bf16 v[184:187], v[108:111], v[132:135], 0
    v_rcp_f32 v195, v194
    v_mfma_f32_16x16x32_bf16 v[180:183], v[116:119], v[132:135], 0
    v_mul_f32 v195, 0x3febdf1c, v195
    v_mul_f32 v188, v188, v195
    v_mfma_f32_16x16x32_bf16 v[250:253], v[24:27], v[214:217], 0
    s_setprio 2
    v_mul_f32 v189, v189, v195
    v_mul_f32 v190, v190, v195
    v_mfma_f32_16x16x32_bf16 v[250:253], v[28:31], v[218:221], v[250:253]
    ds_read_b128 v[214:217], v148 offset:39936
    ds_read_b128 v[218:221], v148 offset:40960
    v_mfma_f32_16x16x32_bf16 v[250:253], v[32:35], v[222:225], v[250:253]
    v_mul_f32 v191, v191, v195
    v_mul_f32 v192, v192, v195
    v_mfma_f32_16x16x32_bf16 v[238:241], v[12:15], v[226:229], 0
    ds_read_b128 v[222:225], v148 offset:41984
    v_mul_f32 v193, v193, v195
    v_mfma_f32_16x16x32_bf16 v[238:241], v[16:19], v[230:233], v[238:241]
    v_cvt_pk_bf16_f32 v188, v188, v189
    v_cvt_pk_bf16_f32 v189, v190, v191
    v_mfma_f32_16x16x32_bf16 v[238:241], v[20:23], v[234:237], v[238:241]
    ds_write_b64 v178, v[188:189] offset:9216
    v_mfma_f32_16x16x32_bf16 v[188:191], v[112:115], v[132:135], 0
    v_cvt_pk_bf16_f32 v192, v192, v193
    v_cvt_pk_bf16_f32 v110, v248, v249
    v_mfma_f32_16x16x32_bf16 v[242:245], v[24:27], v[226:229], 0
    ds_write_b32 v196, v192 offset:9216
    v_mfma_f32_16x16x32_bf16 v[192:195], v[120:123], v[132:135], v[172:175]
    s_setprio 0
    v_cvt_pk_bf16_f32 v108, v250, v251
    v_cvt_pk_bf16_f32 v109, v252, v253
    v_mfma_f32_16x16x32_bf16 v[242:245], v[28:31], v[230:233], v[242:245]
    v_max3_f32 v173, v202, v203, v204
    v_max3_f32 v173, v173, v205, v206
    v_mfma_f32_16x16x32_bf16 v[242:245], v[32:35], v[234:237], v[242:245]
    s_waitcnt lgkmcnt(2)
    v_max3_f32 v173, v173, v207, v208
    v_max3_f32 v173, v173, v209, v198
    v_mfma_f32_16x16x32_bf16 v[246:249], v[0:3], v[214:217], 0
    v_max3_f32 v173, v173, v199, v200
    v_max3_f32 v173, v173, v201, v210
    v_mfma_f32_16x16x32_bf16 v[246:249], v[4:7], v[218:221], v[246:249]
    v_mov_b32 v175, v173
    v_cvt_pk_bf16_f32 v114, v240, v241
    v_mfma_f32_16x16x32_bf16 v[246:249], v[8:11], v[222:225], v[246:249]
    v_permlane16_swap_b32 v173, v175
    v_mfma_f32_16x16x32_bf16 v[250:253], v[12:15], v[214:217], 0
    v_max_f32 v173, v173, v175
    v_mov_b32 v175, v173
    v_mfma_f32_16x16x32_bf16 v[250:253], v[16:19], v[218:221], v[250:253]
    s_nop 0
    v_permlane32_swap_b32 v173, v175
    v_mfma_f32_16x16x32_bf16 v[250:253], v[20:23], v[222:225], v[250:253]
    v_max_f32 v173, v173, v175
    v_sub_f32 v202, v202, v173
    v_sub_f32 v203, v203, v173
    v_sub_f32 v204, v204, v173
    v_sub_f32 v205, v205, v173
    v_sub_f32 v206, v206, v173
    v_sub_f32 v207, v207, v173
    v_sub_f32 v208, v208, v173
    v_sub_f32 v209, v209, v173
    v_sub_f32 v198, v198, v173
    v_sub_f32 v199, v199, v173
    v_sub_f32 v200, v200, v173
    v_sub_f32 v201, v201, v173
    v_sub_f32 v210, v210, v173
    v_exp_f32 v202, v202
    v_exp_f32 v203, v203
    v_exp_f32 v204, v204
    v_exp_f32 v205, v205
    v_cvt_pk_bf16_f32 v202, v202, v203
    v_cvt_pk_bf16_f32 v203, v204, v205
    v_exp_f32 v206, v206
    v_exp_f32 v207, v207
    v_exp_f32 v208, v208
    v_exp_f32 v209, v209
    v_cvt_pk_bf16_f32 v204, v206, v207
    v_cvt_pk_bf16_f32 v205, v208, v209
    v_exp_f32 v198, v198
    s_nop 0
    v_mfma_f32_16x16x32_bf16 v[206:209], v[76:79], v[202:205], 0
    v_exp_f32 v199, v199
    v_exp_f32 v200, v200
    v_exp_f32 v201, v201
    v_cvt_pk_bf16_f32 v198, v198, v199
    v_cvt_pk_bf16_f32 v199, v200, v201
    v_exp_f32 v210, v210
    v_cvt_pk_bf16_f32 v130, v238, v239
    v_mfma_f32_16x16x32_bf16 v[238:241], v[24:27], v[214:217], 0
    v_cvt_pk_bf16_f32 v197, v210, 0
    v_cvt_pk_bf16_f32 v112, v242, v243
    v_mfma_f32_16x16x32_bf16 v[210:213], v[84:87], v[202:205], 0
    v_cvt_pk_bf16_f32 v113, v244, v245
    v_max3_f32 v173, v184, v185, v186
    v_mfma_f32_16x16x32_bf16 v[210:213], v[88:91], v[196:199], v[210:213]
    v_max3_f32 v173, v173, v187, v188
    v_max3_f32 v173, v173, v189, v190
    v_mfma_f32_16x16x32_bf16 v[206:209], v[80:83], v[196:199], v[206:209]
    v_max3_f32 v173, v173, v191, v180
    v_max3_f32 v173, v173, v181, v182
    v_mfma_f32_16x16x32_bf16 v[238:241], v[28:31], v[218:221], v[238:241]
    v_rcp_f32 v213, v212
    v_mfma_f32_16x16x32_bf16 v[238:241], v[32:35], v[222:225], v[238:241]
    v_mul_f32 v213, 0x3febdf1c, v213
    v_mul_f32 v206, v206, v213
    v_mfma_f32_16x16x32_bf16 v[242:245], v[214:217], v[36:39], 0
    v_mul_f32 v207, v207, v213
    v_mul_f32 v208, v208, v213
    v_mfma_f32_16x16x32_bf16 v[242:245], v[218:221], v[40:43], v[242:245]
    v_mul_f32 v209, v209, v213
    v_mul_f32 v210, v210, v213
    v_mfma_f32_16x16x32_bf16 v[242:245], v[222:225], v[44:47], v[242:245]
    s_setprio 2
    v_mul_f32 v211, v211, v213
    v_cvt_pk_bf16_f32 v206, v206, v207
    v_cvt_pk_bf16_f32 v207, v208, v209
    v_cvt_pk_bf16_f32 v210, v210, v211
    v_max3_f32 v173, v173, v183, v192
    v_mov_b32 v175, v173
    v_cvt_pk_bf16_f32 v132, v246, v247
    v_cvt_pk_bf16_f32 v133, v248, v249
    v_mfma_f32_16x16x32_bf16 v[246:249], v[214:217], v[48:51], v[166:169]
    ds_write_b64 v178, v[206:207] offset:12288
    v_mfma_f32_16x16x32_bf16 v[246:249], v[218:221], v[52:55], v[246:249]
    ds_write_b32 v196, v210 offset:12288
    v_mfma_f32_16x16x32_bf16 v[246:249], v[222:225], v[56:59], v[246:249]
    s_setprio 0
    v_permlane16_swap_b32 v173, v175
    v_max_f32 v173, v173, v175
    v_mov_b32 v175, v173
    v_cvt_pk_bf16_f32 v118, v252, v253
    v_cvt_pk_bf16_f32 v134, v250, v251
    v_permlane32_swap_b32 v173, v175
    v_max_f32 v173, v173, v175
    v_sub_f32 v184, v184, v173
    v_sub_f32 v185, v185, v173
    v_sub_f32 v186, v186, v173
    v_sub_f32 v187, v187, v173
    v_sub_f32 v188, v188, v173
    v_sub_f32 v189, v189, v173
    v_sub_f32 v190, v190, v173
    v_sub_f32 v191, v191, v173
    v_sub_f32 v180, v180, v173
    v_sub_f32 v181, v181, v173
    v_sub_f32 v182, v182, v173
    v_sub_f32 v183, v183, v173
    v_sub_f32 v192, v192, v173
    v_exp_f32 v184, v184
    v_exp_f32 v185, v185
    v_exp_f32 v186, v186
    v_exp_f32 v187, v187
    v_cvt_pk_bf16_f32 v184, v184, v185
    v_cvt_pk_bf16_f32 v185, v186, v187
    v_exp_f32 v188, v188
    v_exp_f32 v189, v189
    v_exp_f32 v190, v190
    v_exp_f32 v191, v191
    v_cvt_pk_bf16_f32 v186, v188, v189
    v_cvt_pk_bf16_f32 v187, v190, v191
    v_exp_f32 v180, v180
    s_nop 0
    v_mfma_f32_16x16x32_bf16 v[188:191], v[76:79], v[184:187], 0
    v_exp_f32 v181, v181
    v_exp_f32 v182, v182
    v_exp_f32 v183, v183
    v_cvt_pk_bf16_f32 v180, v180, v181
    v_cvt_pk_bf16_f32 v181, v182, v183
    v_exp_f32 v192, v192
    v_cvt_pk_bf16_f32 v116, v238, v239
    v_cvt_pk_bf16_f32 v179, v192, 0
    v_mfma_f32_16x16x32_bf16 v[192:195], v[84:87], v[184:187], 0
    v_cvt_pk_bf16_f32 v117, v240, v241
    v_cvt_pk_bf16_f32 v98, v242, v243
    v_mfma_f32_16x16x32_bf16 v[192:195], v[88:91], v[178:181], v[192:195]
    s_setprio 2
    v_cvt_pk_bf16_f32 v99, v244, v245
    v_cvt_pk_bf16_f32 v106, v246, v247
    v_mfma_f32_16x16x32_bf16 v[188:191], v[80:83], v[178:181], v[188:191]
    v_cvt_pk_bf16_f32 v107, v248, v249
    s_nop 1
    v_rcp_f32 v195, v194
    s_nop 0
    v_mul_f32 v195, 0x3febdf1c, v195
    s_nop 0
    v_mul_f32 v188, v188, v195
    v_mul_f32 v189, v189, v195
    v_mul_f32 v190, v190, v195
    v_mul_f32 v191, v191, v195
    v_mul_f32 v192, v192, v195
    v_mul_f32 v193, v193, v195
    v_cvt_pk_bf16_f32 v188, v188, v189
    v_cvt_pk_bf16_f32 v189, v190, v191
    v_cvt_pk_bf16_f32 v192, v192, v193
    ds_write_b64 v178, v[188:189] offset:15360
    ds_write_b32 v196, v192 offset:15360
    ds_add_u32 v127, v131 offset:20
    s_setprio 0
    s_add_u32 s37, s37, 1
    s_cmp_eq_u32 s37, 7
    s_cbranch_scc1 L_Aslast
    s_setprio 2
    v_mfma_f32_16x16x32_bf16 v[184:187], v[108:111], v[124:127], 0
    ds_read_b32 v255, v127 offset:16
    s_add_u32 s92, s92, 0x39200
    v_mfma_f32_16x16x32_bf16 v[188:191], v[112:115], v[124:127], 0
    s_setprio 0
    v_mfma_f32_16x16x32_bf16 v[180:183], v[116:119], v[124:127], 0
    v_max3_f32 v173, v184, v185, v186
    v_mfma_f32_16x16x32_bf16 v[192:195], v[120:123], v[124:127], v[174:177]
    v_max3_f32 v173, v173, v187, v188
    v_max3_f32 v173, v173, v189, v190
    v_mfma_f32_16x16x32_bf16 v[154:157], v[108:111], v[144:147], v[154:157]
    v_max3_f32 v173, v173, v191, v180
    v_max3_f32 v173, v173, v181, v182
    v_mfma_f32_16x16x32_bf16 v[158:161], v[112:115], v[144:147], v[158:161]
    v_max3_f32 v173, v173, v183, v192
    v_mfma_f32_16x16x32_bf16 v[150:153], v[116:119], v[144:147], v[150:153]
    s_waitcnt lgkmcnt(0)
    v_readfirstlane_b32 s91, v255
    v_mfma_f32_16x16x32_bf16 v[162:165], v[120:123], v[144:147], v[162:165]
    v_mfma_f32_16x16x32_bf16 v[202:205], v[108:111], v[128:131], 0
    s_setprio 2
    s_cmp_lt_u32 s91, s92
    s_cbranch_scc1 L_sw30
L_sb30:
    v_mfma_f32_16x16x32_bf16 v[206:209], v[112:115], v[128:131], 0
    ds_read_b128 v[214:217], v148 offset:6144
    ds_read_b128 v[218:221], v148 offset:7168
    v_mfma_f32_16x16x32_bf16 v[198:201], v[116:119], v[128:131], 0
    ds_read_b128 v[222:225], v148 offset:8192
    ds_read_b128 v[226:229], v148 offset:9216
    v_mfma_f32_16x16x32_bf16 v[210:213], v[120:123], v[128:131], v[174:177]
    ds_read_b128 v[230:233], v148 offset:10240
    ds_read_b128 v[234:237], v148 offset:11264
    s_nop 0
    v_mov_b32 v175, v173
    s_nop 1
    v_permlane16_swap_b32 v173, v175
    v_max_f32 v173, v173, v175
    v_mov_b32 v175, v173
    s_nop 1
    v_permlane32_swap_b32 v173, v175
    v_max_f32 v173, v173, v175
    v_sub_f32 v184, v184, v173
    s_waitcnt lgkmcnt(5)
    v_mfma_f32_16x16x32_bf16 v[238:241], v[0:3], v[214:217], 0
    s_setprio 0
    v_sub_f32 v185, v185, v173
    v_sub_f32 v186, v186, v173
    s_waitcnt lgkmcnt(4)
    v_mfma_f32_16x16x32_bf16 v[238:241], v[4:7], v[218:221], v[238:241]
    s_waitcnt lgkmcnt(1)
    v_sub_f32 v187, v187, v173
    v_sub_f32 v188, v188, v173
    v_mfma_f32_16x16x32_bf16 v[238:241], v[8:11], v[222:225], v[238:241]
    v_sub_f32 v189, v189, v173
    v_sub_f32 v190, v190, v173
    v_mfma_f32_16x16x32_bf16 v[242:245], v[0:3], v[226:229], 0
    v_sub_f32 v191, v191, v173
    v_sub_f32 v180, v180, v173
    v_mfma_f32_16x16x32_bf16 v[242:245], v[4:7], v[230:233], v[242:245]
    s_waitcnt lgkmcnt(0)
    v_cvt_pk_bf16_f32 v124, v238, v239
    v_cvt_pk_bf16_f32 v125, v240, v241
    v_mfma_f32_16x16x32_bf16 v[242:245], v[8:11], v[234:237], v[242:245]
    v_sub_f32 v181, v181, v173
    v_sub_f32 v182, v182, v173
    v_sub_f32 v183, v183, v173
    v_sub_f32 v192, v192, v173
    v_exp_f32 v184, v184
    v_exp_f32 v185, v185
    v_cvt_pk_bf16_f32 v128, v242, v243
    v_cvt_pk_bf16_f32 v129, v244, v245
    v_exp_f32 v186, v186
    v_exp_f32 v187, v187
    v_cvt_pk_bf16_f32 v184, v184, v185
    v_cvt_pk_bf16_f32 v185, v186, v187
    v_exp_f32 v188, v188
    v_exp_f32 v189, v189
    v_exp_f32 v190, v190
    v_exp_f32 v191, v191
    v_cvt_pk_bf16_f32 v186, v188, v189
    v_cvt_pk_bf16_f32 v187, v190, v191
    v_exp_f32 v180, v180
    s_nop 0
    v_mfma_f32_16x16x32_bf16 v[188:191], v[92:95], v[184:187], 0
    v_exp_f32 v181, v181
    v_exp_f32 v182, v182
    v_exp_f32 v183, v183
    v_cvt_pk_bf16_f32 v180, v180, v181
    v_cvt_pk_bf16_f32 v181, v182, v183
    v_exp_f32 v192, v192
    v_max3_f32 v173, v154, v155, v156
    v_cvt_pk_bf16_f32 v179, v192, 0
    v_mfma_f32_16x16x32_bf16 v[192:195], v[100:103], v[184:187], 0
    v_max3_f32 v173, v173, v157, v158
    v_max3_f32 v173, v173, v159, v160
    v_mfma_f32_16x16x32_bf16 v[192:195], v[104:107], v[178:181], v[192:195]
    v_max3_f32 v173, v173, v161, v150
    v_max3_f32 v173, v173, v151, v152
    v_mfma_f32_16x16x32_bf16 v[188:191], v[96:99], v[178:181], v[188:191]
    v_max3_f32 v173, v173, v153, v162
    v_mfma_f32_16x16x32_bf16 v[184:187], v[108:111], v[132:135], 0
    s_setprio 2
    v_rcp_f32 v195, v194
    v_mfma_f32_16x16x32_bf16 v[180:183], v[116:119], v[132:135], 0
    v_mul_f32 v195, 0x3febdf1c, v195
    v_mul_f32 v188, v188, v195
    v_mul_f32 v189, v189, v195
    v_mul_f32 v190, v190, v195
    v_mul_f32 v191, v191, v195
    v_mul_f32 v192, v192, v195
    v_mul_f32 v193, v193, v195
    v_cvt_pk_bf16_f32 v188, v188, v189
    v_cvt_pk_bf16_f32 v189, v190, v191
    v_cvt_pk_bf16_f32 v192, v192, v193
    ds_write_b64 v178, v[188:189] offset:18432
    v_mfma_f32_16x16x32_bf16 v[188:191], v[112:115], v[132:135], 0
    ds_write_b32 v196, v192 offset:18432
    v_mfma_f32_16x16x32_bf16 v[192:195], v[120:123], v[132:135], v[174:177]
    s_setprio 0
    s_nop 1
    v_mov_b32 v175, v173
    s_nop 1
    v_permlane16_swap_b32 v173, v175
    v_max_f32 v173, v173, v175
    v_mov_b32 v175, v173
    s_nop 1
    v_permlane32_swap_b32 v173, v175
    v_max_f32 v173, v173, v175
    v_sub_f32 v154, v154, v173
    v_sub_f32 v155, v155, v173
    v_sub_f32 v156, v156, v173
    v_sub_f32 v157, v157, v173
    v_sub_f32 v158, v158, v173
    v_sub_f32 v159, v159, v173
    v_sub_f32 v160, v160, v173
    v_sub_f32 v161, v161, v173
    v_sub_f32 v150, v150, v173
    v_sub_f32 v151, v151, v173
    v_sub_f32 v152, v152, v173
    v_sub_f32 v153, v153, v173
    v_sub_f32 v162, v162, v173
    v_exp_f32 v154, v154
    v_exp_f32 v155, v155
    v_exp_f32 v156, v156
    v_exp_f32 v157, v157
    v_cvt_pk_bf16_f32 v154, v154, v155
    v_cvt_pk_bf16_f32 v155, v156, v157
    v_exp_f32 v158, v158
    v_exp_f32 v159, v159
    v_exp_f32 v160, v160
    v_exp_f32 v161, v161
    v_cvt_pk_bf16_f32 v156, v158, v159
    v_cvt_pk_bf16_f32 v157, v160, v161
    v_exp_f32 v150, v150
    s_nop 0
    v_mfma_f32_16x16x32_bf16 v[158:161], v[60:63], v[154:157], 0
    v_exp_f32 v151, v151
    v_mfma_f32_16x16x32_bf16 v[246:249], v[84:87], v[154:157], 0
    v_exp_f32 v152, v152
    v_mfma_f32_16x16x32_bf16 v[250:253], v[76:79], v[154:157], 0
    v_exp_f32 v153, v153
    v_mfma_f32_16x16x32_bf16 v[238:241], v[100:103], v[154:157], 0
    v_cvt_pk_bf16_f32 v150, v150, v151
    v_cvt_pk_bf16_f32 v151, v152, v153
    v_mfma_f32_16x16x32_bf16 v[242:245], v[92:95], v[154:157], 0
    v_exp_f32 v162, v162
    v_max3_f32 v173, v202, v203, v204
    v_cvt_pk_bf16_f32 v149, v162, 0
    v_mfma_f32_16x16x32_bf16 v[162:165], v[68:71], v[154:157], 0
    v_max3_f32 v173, v173, v205, v206
    v_max3_f32 v173, v173, v207, v208
    v_mfma_f32_16x16x32_bf16 v[162:165], v[72:75], v[148:151], v[162:165]
    v_max3_f32 v173, v173, v209, v198
    v_max3_f32 v173, v173, v199, v200
    v_mfma_f32_16x16x32_bf16 v[158:161], v[64:67], v[148:151], v[158:161]
    v_max3_f32 v173, v173, v201, v210
    v_mov_b32 v175, v173
    v_mfma_f32_16x16x32_bf16 v[246:249], v[88:91], v[148:151], v[246:249]
    s_nop 0
    v_permlane16_swap_b32 v173, v175
    v_mfma_f32_16x16x32_bf16 v[250:253], v[80:83], v[148:151], v[250:253]
    v_max_f32 v173, v173, v175
    v_mov_b32 v175, v173
    v_mfma_f32_16x16x32_bf16 v[238:241], v[104:107], v[148:151], v[238:241]
    v_cndmask_b32 v162, v162, v246, s[62:63]
    v_cndmask_b32 v163, v163, v247, s[62:63]
    v_mfma_f32_16x16x32_bf16 v[242:245], v[96:99], v[148:151], v[242:245]
    v_cndmask_b32 v164, v164, v248, s[62:63]
    v_cndmask_b32 v158, v158, v250, s[62:63]
    v_mfma_f32_16x16x32_bf16 v[246:249], v[12:15], v[214:217], 0
    v_cndmask_b32 v159, v159, v251, s[62:63]
    v_cndmask_b32 v160, v160, v252, s[62:63]
    v_mfma_f32_16x16x32_bf16 v[246:249], v[16:19], v[218:221], v[246:249]
    v_cndmask_b32 v161, v161, v253, s[62:63]
    v_cndmask_b32 v162, v162, v238, s[64:65]
    v_mfma_f32_16x16x32_bf16 v[246:249], v[20:23], v[222:225], v[246:249]
    v_cndmask_b32 v163, v163, v239, s[64:65]
    v_cndmask_b32 v164, v164, v240, s[64:65]
    v_mfma_f32_16x16x32_bf16 v[250:253], v[24:27], v[214:217], 0
    v_cndmask_b32 v158, v158, v242, s[64:65]
    v_cndmask_b32 v159, v159, v243, s[64:65]
    v_mfma_f32_16x16x32_bf16 v[250:253], v[28:31], v[218:221], v[250:253]
    v_cndmask_b32 v160, v160, v244, s[64:65]
    v_cndmask_b32 v161, v161, v245, s[64:65]
    v_mfma_f32_16x16x32_bf16 v[250:253], v[32:35], v[222:225], v[250:253]
    v_rcp_f32 v165, v164
    v_mfma_f32_16x16x32_bf16 v[238:241], v[214:217], v[36:39], 0
    v_mul_f32 v165, 0x3febdf1c, v165
    v_mul_f32 v158, v158, v165
    v_mfma_f32_16x16x32_bf16 v[238:241], v[218:221], v[40:43], v[238:241]
    v_mul_f32 v159, v159, v165
    v_mul_f32 v160, v160, v165
    v_mfma_f32_16x16x32_bf16 v[238:241], v[222:225], v[44:47], v[238:241]
    v_mul_f32 v161, v161, v165
    v_mul_f32 v162, v162, v165
    v_mfma_f32_16x16x32_bf16 v[242:245], v[214:217], v[48:51], v[166:169]
    s_setprio 2
    v_mul_f32 v163, v163, v165
    v_cvt_pk_bf16_f32 v158, v158, v159
    v_mfma_f32_16x16x32_bf16 v[242:245], v[218:221], v[52:55], v[242:245]
    ds_read_b128 v[214:217], v148 offset:12288
    ds_read_b128 v[218:221], v148 offset:13312
    v_mfma_f32_16x16x32_bf16 v[242:245], v[222:225], v[56:59], v[242:245]
    ds_read_b128 v[222:225], v148 offset:14336
    v_cvt_pk_bf16_f32 v159, v160, v161
    v_cvt_pk_bf16_f32 v162, v162, v163
    v_cvt_pk_bf16_f32 v110, v248, v249
    v_cvt_pk_bf16_f32 v126, v246, v247
    v_mfma_f32_16x16x32_bf16 v[246:249], v[12:15], v[226:229], 0
    ds_write_b64 v178, v[158:159] offset:27648
    v_mfma_f32_16x16x32_bf16 v[246:249], v[16:19], v[230:233], v[246:249]
    ds_write_b32 v196, v162 offset:27648
    v_mfma_f32_16x16x32_bf16 v[246:249], v[20:23], v[234:237], v[246:249]
    s_setprio 0
    v_cvt_pk_bf16_f32 v108, v250, v251
    v_cvt_pk_bf16_f32 v109, v252, v253
    v_mfma_f32_16x16x32_bf16 v[250:253], v[24:27], v[226:229], 0
    v_cvt_pk_bf16_f32 v60, v238, v239
    v_cvt_pk_bf16_f32 v61, v240, v241
    v_mfma_f32_16x16x32_bf16 v[250:253], v[28:31], v[230:233], v[250:253]
    v_cvt_pk_bf16_f32 v68, v242, v243
    v_cvt_pk_bf16_f32 v69, v244, v245
    v_mfma_f32_16x16x32_bf16 v[250:253], v[32:35], v[234:237], v[250:253]
    v_permlane32_swap_b32 v173, v175
    v_mfma_f32_16x16x32_bf16 v[238:241], v[226:229], v[36:39], 0
    v_max_f32 v173, v173, v175
    v_sub_f32 v202, v202, v173
    v_mfma_f32_16x16x32_bf16 v[238:241], v[230:233], v[40:43], v[238:241]
    v_sub_f32 v203, v203, v173
    v_sub_f32 v204, v204, v173
    v_mfma_f32_16x16x32_bf16 v[238:241], v[234:237], v[44:47], v[238:241]
    v_sub_f32 v205, v205, v173
    v_sub_f32 v206, v206, v173
    v_mfma_f32_16x16x32_bf16 v[242:245], v[226:229], v[48:51], v[166:169]
    s_setprio 2
    v_sub_f32 v207, v207, v173
    v_sub_f32 v208, v208, v173
    v_mfma_f32_16x16x32_bf16 v[242:245], v[230:233], v[52:55], v[242:245]
    ds_read_b128 v[226:229], v148
    ds_read_b128 v[230:233], v148 offset:1024
    v_mfma_f32_16x16x32_bf16 v[242:245], v[234:237], v[56:59], v[242:245]
    ds_read_b128 v[234:237], v148 offset:2048
    v_sub_f32 v209, v209, v173
    v_sub_f32 v198, v198, v173
    v_sub_f32 v199, v199, v173
    v_sub_f32 v200, v200, v173
    v_sub_f32 v201, v201, v173
    v_sub_f32 v210, v210, v173
    v_exp_f32 v202, v202
    v_exp_f32 v203, v203
    v_exp_f32 v204, v204
    v_exp_f32 v205, v205
    v_cvt_pk_bf16_f32 v202, v202, v203
    v_cvt_pk_bf16_f32 v203, v204, v205
    v_exp_f32 v206, v206
    v_exp_f32 v207, v207
    v_exp_f32 v208, v208
    v_exp_f32 v209, v209
    v_cvt_pk_bf16_f32 v204, v206, v207
    v_cvt_pk_bf16_f32 v205, v208, v209
    v_exp_f32 v198, v198
    s_nop 0
    v_mfma_f32_16x16x32_bf16 v[206:209], v[92:95], v[202:205], 0
    s_setprio 0
    v_exp_f32 v199, v199
    v_exp_f32 v200, v200
    v_exp_f32 v201, v201
    v_cvt_pk_bf16_f32 v198, v198, v199
    v_cvt_pk_bf16_f32 v199, v200, v201
    v_exp_f32 v210, v210
    v_cvt_pk_bf16_f32 v114, v248, v249
    v_cvt_pk_bf16_f32 v197, v210, 0
    v_mfma_f32_16x16x32_bf16 v[210:213], v[100:103], v[202:205], 0
    v_cvt_pk_bf16_f32 v130, v246, v247
    v_cvt_pk_bf16_f32 v112, v250, v251
    v_mfma_f32_16x16x32_bf16 v[210:213], v[104:107], v[196:199], v[210:213]
    v_cvt_pk_bf16_f32 v113, v252, v253
    v_cvt_pk_bf16_f32 v62, v238, v239
    v_mfma_f32_16x16x32_bf16 v[206:209], v[96:99], v[196:199], v[206:209]
    s_waitcnt lgkmcnt(0)
    v_cvt_pk_bf16_f32 v63, v240, v241
    v_cvt_pk_bf16_f32 v70, v242, v243
    v_mfma_f32_16x16x32_bf16 v[246:249], v[0:3], v[214:217], 0
    v_rcp_f32 v213, v212
    v_mfma_f32_16x16x32_bf16 v[246:249], v[4:7], v[218:221], v[246:249]
    v_mul_f32 v213, 0x3febdf1c, v213
    v_mul_f32 v206, v206, v213
    v_mfma_f32_16x16x32_bf16 v[246:249], v[8:11], v[222:225], v[246:249]
    v_mul_f32 v207, v207, v213
    v_mul_f32 v208, v208, v213
    v_mfma_f32_16x16x32_bf16 v[250:253], v[12:15], v[214:217], 0
    v_mul_f32 v209, v209, v213
    v_mul_f32 v210, v210, v213
    v_mfma_f32_16x16x32_bf16 v[250:253], v[16:19], v[218:221], v[250:253]
    v_mul_f32 v211, v211, v213
    v_cvt_pk_bf16_f32 v206, v206, v207
    v_mfma_f32_16x16x32_bf16 v[250:253], v[20:23], v[222:225], v[250:253]
    s_setprio 2
    v_cvt_pk_bf16_f32 v207, v208, v209
    v_cvt_pk_bf16_f32 v210, v210, v211
    v_mfma_f32_16x16x32_bf16 v[238:241], v[24:27], v[214:217], 0
    ds_write_b64 v178, v[206:207] offset:21504
    v_mfma_f32_16x16x32_bf16 v[238:241], v[28:31], v[218:221], v[238:241]
    ds_write_b32 v196, v210 offset:21504
    v_mfma_f32_16x16x32_bf16 v[238:241], v[32:35], v[222:225], v[238:241]
    s_setprio 0
    v_cvt_pk_bf16_f32 v71, v244, v245
    v_max3_f32 v173, v184, v185, v186
    v_mfma_f32_16x16x32_bf16 v[242:245], v[214:217], v[36:39], 0
    v_max3_f32 v173, v173, v187, v188
    v_max3_f32 v173, v173, v189, v190
    v_mfma_f32_16x16x32_bf16 v[242:245], v[218:221], v[40:43], v[242:245]
    v_max3_f32 v173, v173, v191, v180
    v_max3_f32 v173, v173, v181, v182
    v_mfma_f32_16x16x32_bf16 v[242:245], v[222:225], v[44:47], v[242:245]
    v_max3_f32 v173, v173, v183, v192
    v_mov_b32 v175, v173
    v_cvt_pk_bf16_f32 v132, v246, v247
    v_cvt_pk_bf16_f32 v133, v248, v249
    v_mfma_f32_16x16x32_bf16 v[246:249], v[214:217], v[48:51], v[166:169]
    v_permlane16_swap_b32 v173, v175
    v_mfma_f32_16x16x32_bf16 v[246:249], v[218:221], v[52:55], v[246:249]
    v_max_f32 v173, v173, v175
    v_mov_b32 v175, v173
    v_mfma_f32_16x16x32_bf16 v[246:249], v[222:225], v[56:59], v[246:249]
    s_nop 0
    v_permlane32_swap_b32 v173, v175
    v_max_f32 v173, v173, v175
    v_sub_f32 v184, v184, v173
    v_sub_f32 v185, v185, v173
    v_sub_f32 v186, v186, v173
    v_sub_f32 v187, v187, v173
    v_sub_f32 v188, v188, v173
    v_sub_f32 v189, v189, v173
    v_sub_f32 v190, v190, v173
    v_sub_f32 v191, v191, v173
    v_sub_f32 v180, v180, v173
    v_sub_f32 v181, v181, v173
    v_sub_f32 v182, v182, v173
    v_sub_f32 v183, v183, v173
    v_sub_f32 v192, v192, v173
    v_exp_f32 v184, v184
    v_exp_f32 v185, v185
    v_exp_f32 v186, v186
    v_exp_f32 v187, v187
    v_cvt_pk_bf16_f32 v184, v184, v185
    v_cvt_pk_bf16_f32 v185, v186, v187
    v_exp_f32 v188, v188
    v_exp_f32 v189, v189
    v_exp_f32 v190, v190
    v_exp_f32 v191, v191
    v_cvt_pk_bf16_f32 v186, v188, v189
    v_cvt_pk_bf16_f32 v187, v190, v191
    v_exp_f32 v180, v180
    s_nop 0
    v_mfma_f32_16x16x32_bf16 v[188:191], v[92:95], v[184:187], 0
    v_exp_f32 v181, v181
    v_exp_f32 v182, v182
    v_exp_f32 v183, v183
    v_cvt_pk_bf16_f32 v180, v180, v181
    v_cvt_pk_bf16_f32 v181, v182, v183
    v_exp_f32 v192, v192
    v_cvt_pk_bf16_f32 v118, v252, v253
    v_cvt_pk_bf16_f32 v179, v192, 0
    v_mfma_f32_16x16x32_bf16 v[192:195], v[100:103], v[184:187], 0
    v_cvt_pk_bf16_f32 v134, v250, v251
    v_cvt_pk_bf16_f32 v116, v238, v239
    v_mfma_f32_16x16x32_bf16 v[192:195], v[104:107], v[178:181], v[192:195]
    v_cvt_pk_bf16_f32 v117, v240, v241
    v_cvt_pk_bf16_f32 v66, v242, v243
    v_mfma_f32_16x16x32_bf16 v[188:191], v[96:99], v[178:181], v[188:191]
    v_cvt_pk_bf16_f32 v67, v244, v245
    v_cvt_pk_bf16_f32 v74, v246, v247
    v_mfma_f32_16x16x32_bf16 v[250:253], v[0:3], v[226:229], 0
    v_rcp_f32 v195, v194
    v_mfma_f32_16x16x32_bf16 v[250:253], v[4:7], v[230:233], v[250:253]
    v_mul_f32 v195, 0x3febdf1c, v195
    v_mul_f32 v188, v188, v195
    v_mfma_f32_16x16x32_bf16 v[250:253], v[8:11], v[234:237], v[250:253]
    v_mul_f32 v189, v189, v195
    v_mul_f32 v190, v190, v195
    v_mfma_f32_16x16x32_bf16 v[238:241], v[12:15], v[226:229], 0
    v_mul_f32 v191, v191, v195
    v_mul_f32 v192, v192, v195
    v_mfma_f32_16x16x32_bf16 v[238:241], v[16:19], v[230:233], v[238:241]
    v_mul_f32 v193, v193, v195
    v_cvt_pk_bf16_f32 v188, v188, v189
    v_mfma_f32_16x16x32_bf16 v[238:241], v[20:23], v[234:237], v[238:241]
    s_setprio 2
    v_cvt_pk_bf16_f32 v189, v190, v191
    v_cvt_pk_bf16_f32 v192, v192, v193
    v_mfma_f32_16x16x32_bf16 v[242:245], v[24:27], v[226:229], 0
    ds_write_b64 v178, v[188:189] offset:24576
    v_mfma_f32_16x16x32_bf16 v[242:245], v[28:31], v[230:233], v[242:245]
    ds_write_b32 v196, v192 offset:24576
    v_mfma_f32_16x16x32_bf16 v[242:245], v[32:35], v[234:237], v[242:245]
    v_cvt_pk_bf16_f32 v75, v248, v249
    v_cvt_pk_bf16_f32 v250, v250, v251
    v_mfma_f32_16x16x32_bf16 v[246:249], v[226:229], v[36:39], 0
    ds_add_u32 v127, v131 offset:20
    v_mfma_f32_16x16x32_bf16 v[246:249], v[230:233], v[40:43], v[246:249]
    s_setprio 0
    v_cndmask_b32 v136, 0, v250, s[60:61]
    v_cndmask_b32 v140, 0, v250, s[62:63]
    v_mfma_f32_16x16x32_bf16 v[246:249], v[234:237], v[44:47], v[246:249]
    v_cndmask_b32 v144, 0, v250, s[64:65]
    v_cvt_pk_bf16_f32 v252, v252, v253
    v_cndmask_b32 v137, 0, v252, s[60:61]
    v_cndmask_b32 v141, 0, v252, s[62:63]
    v_cndmask_b32 v145, 0, v252, s[64:65]
    v_mfma_f32_16x16x32_bf16 v[250:253], v[226:229], v[48:51], v[166:169]
    v_cvt_pk_bf16_f32 v122, v240, v241
    v_cvt_pk_bf16_f32 v238, v238, v239
    v_mfma_f32_16x16x32_bf16 v[250:253], v[230:233], v[52:55], v[250:253]
    v_cndmask_b32 v138, 0, v238, s[60:61]
    v_cndmask_b32 v142, 0, v238, s[62:63]
    v_mfma_f32_16x16x32_bf16 v[250:253], v[234:237], v[56:59], v[250:253]
    v_cndmask_b32 v146, 0, v238, s[64:65]
    v_cvt_pk_bf16_f32 v120, v242, v243
    v_cvt_pk_bf16_f32 v121, v244, v245
    v_cvt_pk_bf16_f32 v65, v246, v247
    v_cvt_pk_bf16_f32 v81, v246, v247
    s_nop 1
    v_cvt_pk_bf16_f32 v73, v250, v251
    v_cvt_pk_bf16_f32 v89, v250, v251
    s_nop 0
    s_branch L_Asloop
L_Aslast:
    v_mfma_f32_16x16x32_bf16 v[184:187], v[108:111], v[124:127], 0
    v_mfma_f32_16x16x32_bf16 v[188:191], v[112:115], v[124:127], 0
    v_mfma_f32_16x16x32_bf16 v[180:183], v[116:119], v[124:127], 0
    v_max3_f32 v173, v184, v185, v186
    v_mfma_f32_16x16x32_bf16 v[192:195], v[120:123], v[124:127], v[174:177]
    v_max3_f32 v173, v173, v187, v188
    v_max3_f32 v173, v173, v189, v190
    v_mfma_f32_16x16x32_bf16 v[154:157], v[108:111], v[144:147], v[154:157]
    v_max3_f32 v173, v173, v191, v180
    v_max3_f32 v173, v173, v181, v182
    v_mfma_f32_16x16x32_bf16 v[158:161], v[112:115], v[144:147], v[158:161]
    v_max3_f32 v173, v173, v183, v192
    v_mfma_f32_16x16x32_bf16 v[150:153], v[116:119], v[144:147], v[150:153]
    v_mfma_f32_16x16x32_bf16 v[162:165], v[120:123], v[144:147], v[162:165]
    v_mfma_f32_16x16x32_bf16 v[202:205], v[108:111], v[128:131], 0
    v_mfma_f32_16x16x32_bf16 v[206:209], v[112:115], v[128:131], 0
    v_mfma_f32_16x16x32_bf16 v[198:201], v[116:119], v[128:131], 0
    v_mfma_f32_16x16x32_bf16 v[210:213], v[120:123], v[128:131], v[174:177]
    s_nop 2
    v_mov_b32 v175, v173
    s_nop 1
    v_permlane16_swap_b32 v173, v175
    v_max_f32 v173, v173, v175
    v_mov_b32 v175, v173
    s_nop 1
    v_permlane32_swap_b32 v173, v175
    v_max_f32 v173, v173, v175
    v_sub_f32 v184, v184, v173
    v_sub_f32 v185, v185, v173
    v_sub_f32 v186, v186, v173
    v_sub_f32 v187, v187, v173
    v_sub_f32 v188, v188, v173
    v_sub_f32 v189, v189, v173
    v_sub_f32 v190, v190, v173
    v_sub_f32 v191, v191, v173
    v_sub_f32 v180, v180, v173
    v_sub_f32 v181, v181, v173
    v_sub_f32 v182, v182, v173
    v_sub_f32 v183, v183, v173
    v_sub_f32 v192, v192, v173
    v_exp_f32 v184, v184
    v_exp_f32 v185, v185
    v_exp_f32 v186, v186
    v_exp_f32 v187, v187
    v_cvt_pk_bf16_f32 v184, v184, v185
    v_cvt_pk_bf16_f32 v185, v186, v187
    v_exp_f32 v188, v188
    v_exp_f32 v189, v189
    v_exp_f32 v190, v190
    v_exp_f32 v191, v191
    v_cvt_pk_bf16_f32 v186, v188, v189
    v_cvt_pk_bf16_f32 v187, v190, v191
    v_exp_f32 v180, v180
    s_nop 0
    v_mfma_f32_16x16x32_bf16 v[188:191], v[92:95], v[184:187], 0
    v_exp_f32 v181, v181
    v_exp_f32 v182, v182
    v_exp_f32 v183, v183
    v_cvt_pk_bf16_f32 v180, v180, v181
    v_cvt_pk_bf16_f32 v181, v182, v183
    v_exp_f32 v192, v192
    v_max3_f32 v173, v154, v155, v156
    v_cvt_pk_bf16_f32 v179, v192, 0
    v_mfma_f32_16x16x32_bf16 v[192:195], v[100:103], v[184:187], 0
    v_max3_f32 v173, v173, v157, v158
    v_max3_f32 v173, v173, v159, v160
    v_mfma_f32_16x16x32_bf16 v[192:195], v[104:107], v[178:181], v[192:195]
    v_max3_f32 v173, v173, v161, v150
    v_max3_f32 v173, v173, v151, v152
    v_mfma_f32_16x16x32_bf16 v[188:191], v[96:99], v[178:181], v[188:191]
    v_max3_f32 v173, v173, v153, v162
    v_mfma_f32_16x16x32_bf16 v[184:187], v[108:111], v[132:135], 0
    s_setprio 2
    v_rcp_f32 v195, v194
    v_mfma_f32_16x16x32_bf16 v[180:183], v[116:119], v[132:135], 0
    v_mul_f32 v195, 0x3febdf1c, v195
    v_mul_f32 v188, v188, v195
    v_mul_f32 v189, v189, v195
    v_mul_f32 v190, v190, v195
    v_mul_f32 v191, v191, v195
    v_mul_f32 v192, v192, v195
    v_mul_f32 v193, v193, v195
    v_cvt_pk_bf16_f32 v188, v188, v189
    v_cvt_pk_bf16_f32 v189, v190, v191
    v_cvt_pk_bf16_f32 v192, v192, v193
    ds_write_b64 v178, v[188:189] offset:18432
    v_mfma_f32_16x16x32_bf16 v[188:191], v[112:115], v[132:135], 0
    ds_write_b32 v196, v192 offset:18432
    v_mfma_f32_16x16x32_bf16 v[192:195], v[120:123], v[132:135], v[174:177]
    s_setprio 0
    s_nop 1
    v_mov_b32 v175, v173
    s_nop 1
    v_permlane16_swap_b32 v173, v175
    v_max_f32 v173, v173, v175
    v_mov_b32 v175, v173
    s_nop 1
    v_permlane32_swap_b32 v173, v175
    v_max_f32 v173, v173, v175
    v_sub_f32 v154, v154, v173
    v_sub_f32 v155, v155, v173
    v_sub_f32 v156, v156, v173
    v_sub_f32 v157, v157, v173
    v_sub_f32 v158, v158, v173
    v_sub_f32 v159, v159, v173
    v_sub_f32 v160, v160, v173
    v_sub_f32 v161, v161, v173
    v_sub_f32 v150, v150, v173
    v_sub_f32 v151, v151, v173
    v_sub_f32 v152, v152, v173
    v_sub_f32 v153, v153, v173
    v_sub_f32 v162, v162, v173
    v_exp_f32 v154, v154
    v_exp_f32 v155, v155
    v_exp_f32 v156, v156
    v_exp_f32 v157, v157
    v_cvt_pk_bf16_f32 v154, v154, v155
    v_cvt_pk_bf16_f32 v155, v156, v157
    v_exp_f32 v158, v158
    v_exp_f32 v159, v159
    v_exp_f32 v160, v160
    v_exp_f32 v161, v161
    v_cvt_pk_bf16_f32 v156, v158, v159
    v_cvt_pk_bf16_f32 v157, v160, v161
    v_exp_f32 v150, v150
    s_nop 0
    v_mfma_f32_16x16x32_bf16 v[158:161], v[60:63], v[154:157], 0
    v_exp_f32 v151, v151
    v_mfma_f32_16x16x32_bf16 v[238:241], v[84:87], v[154:157], 0
    v_exp_f32 v152, v152
    v_mfma_f32_16x16x32_bf16 v[242:245], v[76:79], v[154:157], 0
    v_exp_f32 v153, v153
    v_mfma_f32_16x16x32_bf16 v[246:249], v[100:103], v[154:157], 0
    v_cvt_pk_bf16_f32 v150, v150, v151
    v_cvt_pk_bf16_f32 v151, v152, v153
    v_mfma_f32_16x16x32_bf16 v[250:253], v[92:95], v[154:157], 0
    v_exp_f32 v162, v162
    v_max3_f32 v173, v202, v203, v204
    v_cvt_pk_bf16_f32 v149, v162, 0
    v_mfma_f32_16x16x32_bf16 v[162:165], v[68:71], v[154:157], 0
    v_max3_f32 v173, v173, v205, v206
    v_max3_f32 v173, v173, v207, v208
    v_mfma_f32_16x16x32_bf16 v[162:165], v[72:75], v[148:151], v[162:165]
    v_max3_f32 v173, v173, v209, v198
    v_max3_f32 v173, v173, v199, v200
    v_mfma_f32_16x16x32_bf16 v[158:161], v[64:67], v[148:151], v[158:161]
    v_max3_f32 v173, v173, v201, v210
    v_mov_b32 v175, v173
    v_mfma_f32_16x16x32_bf16 v[238:241], v[88:91], v[148:151], v[238:241]
    s_nop 0
    v_permlane16_swap_b32 v173, v175
    v_mfma_f32_16x16x32_bf16 v[242:245], v[80:83], v[148:151], v[242:245]
    v_max_f32 v173, v173, v175
    v_mov_b32 v175, v173
    v_mfma_f32_16x16x32_bf16 v[246:249], v[104:107], v[148:151], v[246:249]
    v_cndmask_b32 v162, v162, v238, s[62:63]
    v_cndmask_b32 v163, v163, v239, s[62:63]
    v_mfma_f32_16x16x32_bf16 v[250:253], v[96:99], v[148:151], v[250:253]
    s_setprio 2
    v_cndmask_b32 v164, v164, v240, s[62:63]
    v_cndmask_b32 v158, v158, v242, s[62:63]
    v_cndmask_b32 v159, v159, v243, s[62:63]
    v_cndmask_b32 v160, v160, v244, s[62:63]
    v_cndmask_b32 v161, v161, v245, s[62:63]
    v_cndmask_b32 v162, v162, v246, s[64:65]
    v_cndmask_b32 v163, v163, v247, s[64:65]
    v_cndmask_b32 v164, v164, v248, s[64:65]
    v_cndmask_b32 v158, v158, v250, s[64:65]
    v_cndmask_b32 v159, v159, v251, s[64:65]
    v_cndmask_b32 v160, v160, v252, s[64:65]
    v_cndmask_b32 v161, v161, v253, s[64:65]
    v_rcp_f32 v165, v164
    v_permlane32_swap_b32 v173, v175
    v_mul_f32 v165, 0x3febdf1c, v165
    v_mul_f32 v158, v158, v165
    v_mul_f32 v159, v159, v165
    v_mul_f32 v160, v160, v165
    v_mul_f32 v161, v161, v165
    v_mul_f32 v162, v162, v165
    v_mul_f32 v163, v163, v165
    v_cvt_pk_bf16_f32 v158, v158, v159
    v_cvt_pk_bf16_f32 v159, v160, v161
    v_cvt_pk_bf16_f32 v162, v162, v163
    v_max_f32 v173, v173, v175
    v_sub_f32 v202, v202, v173
    v_sub_f32 v203, v203, v173
    v_sub_f32 v204, v204, v173
    v_sub_f32 v205, v205, v173
    v_sub_f32 v206, v206, v173
    v_sub_f32 v207, v207, v173
    v_sub_f32 v208, v208, v173
    v_sub_f32 v209, v209, v173
    v_sub_f32 v198, v198, v173
    v_sub_f32 v199, v199, v173
    v_sub_f32 v200, v200, v173
    v_sub_f32 v201, v201, v173
    v_sub_f32 v210, v210, v173
    v_exp_f32 v202, v202
    v_exp_f32 v203, v203
    v_exp_f32 v204, v204
    v_exp_f32 v205, v205
    v_cvt_pk_bf16_f32 v202, v202, v203
    v_cvt_pk_bf16_f32 v203, v204, v205
    v_exp_f32 v206, v206
    v_exp_f32 v207, v207
    v_exp_f32 v208, v208
    v_exp_f32 v209, v209
    v_cvt_pk_bf16_f32 v204, v206, v207
    v_cvt_pk_bf16_f32 v205, v208, v209
    v_exp_f32 v198, v198
    s_nop 0
    v_mfma_f32_16x16x32_bf16 v[206:209], v[92:95], v[202:205], 0
    ds_write_b64 v178, v[158:159] offset:27648
    ds_write_b32 v196, v162 offset:27648
    v_exp_f32 v199, v199
    v_exp_f32 v200, v200
    v_exp_f32 v201, v201
    v_cvt_pk_bf16_f32 v198, v198, v199
    v_cvt_pk_bf16_f32 v199, v200, v201
    v_exp_f32 v210, v210
    v_max3_f32 v173, v184, v185, v186
    v_cvt_pk_bf16_f32 v197, v210, 0
    v_mfma_f32_16x16x32_bf16 v[210:213], v[100:103], v[202:205], 0
    s_setprio 0
    v_max3_f32 v173, v173, v187, v188
    v_max3_f32 v173, v173, v189, v190
    v_mfma_f32_16x16x32_bf16 v[210:213], v[104:107], v[196:199], v[210:213]
    s_setprio 2
    v_max3_f32 v173, v173, v191, v180
    v_max3_f32 v173, v173, v181, v182
    v_mfma_f32_16x16x32_bf16 v[206:209], v[96:99], v[196:199], v[206:209]
    v_max3_f32 v173, v173, v183, v192
    v_mov_b32 v175, v173
    s_nop 0
    v_rcp_f32 v213, v212
    v_permlane16_swap_b32 v173, v175
    v_mul_f32 v213, 0x3febdf1c, v213
    v_mul_f32 v206, v206, v213
    v_mul_f32 v207, v207, v213
    v_mul_f32 v208, v208, v213
    v_mul_f32 v209, v209, v213
    v_mul_f32 v210, v210, v213
    v_mul_f32 v211, v211, v213
    v_cvt_pk_bf16_f32 v206, v206, v207
    v_cvt_pk_bf16_f32 v207, v208, v209
    v_cvt_pk_bf16_f32 v210, v210, v211
    v_max_f32 v173, v173, v175
    v_mov_b32 v175, v173
    ds_write_b64 v178, v[206:207] offset:21504
    ds_write_b32 v196, v210 offset:21504
    v_permlane32_swap_b32 v173, v175
    v_max_f32 v173, v173, v175
    v_sub_f32 v184, v184, v173
    v_sub_f32 v185, v185, v173
    v_sub_f32 v186, v186, v173
    v_sub_f32 v187, v187, v173
    v_sub_f32 v188, v188, v173
    v_sub_f32 v189, v189, v173
    v_sub_f32 v190, v190, v173
    v_sub_f32 v191, v191, v173
    v_sub_f32 v180, v180, v173
    v_sub_f32 v181, v181, v173
    v_sub_f32 v182, v182, v173
    v_sub_f32 v183, v183, v173
    v_sub_f32 v192, v192, v173
    v_exp_f32 v184, v184
    v_exp_f32 v185, v185
    v_exp_f32 v186, v186
    v_exp_f32 v187, v187
    v_cvt_pk_bf16_f32 v184, v184, v185
    v_cvt_pk_bf16_f32 v185, v186, v187
    v_exp_f32 v188, v188
    v_exp_f32 v189, v189
    v_exp_f32 v190, v190
    v_exp_f32 v191, v191
    v_cvt_pk_bf16_f32 v186, v188, v189
    v_cvt_pk_bf16_f32 v187, v190, v191
    v_exp_f32 v180, v180
    s_nop 0
    v_mfma_f32_16x16x32_bf16 v[188:191], v[92:95], v[184:187], 0
    s_setprio 0
    v_exp_f32 v181, v181
    v_exp_f32 v182, v182
    v_exp_f32 v183, v183
    v_cvt_pk_bf16_f32 v180, v180, v181
    v_cvt_pk_bf16_f32 v181, v182, v183
    v_exp_f32 v192, v192
    s_nop 0
    v_cvt_pk_bf16_f32 v179, v192, 0
    v_mfma_f32_16x16x32_bf16 v[192:195], v[100:103], v[184:187], 0
    s_nop 0
    v_mfma_f32_16x16x32_bf16 v[192:195], v[104:107], v[178:181], v[192:195]
    s_setprio 2
    v_mfma_f32_16x16x32_bf16 v[188:191], v[96:99], v[178:181], v[188:191]
    s_nop 3
    v_rcp_f32 v195, v194
    s_nop 0
    v_mul_f32 v195, 0x3febdf1c, v195
    s_nop 0
    v_mul_f32 v188, v188, v195
    v_mul_f32 v189, v189, v195
    v_mul_f32 v190, v190, v195
    v_mul_f32 v191, v191, v195
    v_mul_f32 v192, v192, v195
    v_mul_f32 v193, v193, v195
    v_cvt_pk_bf16_f32 v188, v188, v189
    v_cvt_pk_bf16_f32 v189, v190, v191
    v_cvt_pk_bf16_f32 v192, v192, v193
    ds_write_b64 v178, v[188:189] offset:24576
    ds_write_b32 v196, v192 offset:24576
    ds_add_u32 v127, v131 offset:20
    s_setprio 0
    s_waitcnt lgkmcnt(0)
    s_barrier
    s_endpgm
L_sw28:
    s_sleep 2
    ds_read_b32 v255, v127 offset:16
    s_waitcnt lgkmcnt(0)
    v_readfirstlane_b32 s91, v255
    s_nop 1
    s_cmp_lt_u32 s91, s92
    s_nop 0
    s_cbranch_scc1 L_sw28
    s_branch L_sb28
L_sw29:
    s_sleep 2
    ds_read_b32 v255, v127 offset:16
    s_waitcnt lgkmcnt(0)
    v_readfirstlane_b32 s91, v255
    s_nop 1
    s_cmp_lt_u32 s91, s92
    s_nop 0
    s_cbranch_scc1 L_sw29
    s_branch L_sb29
L_sw30:
    s_sleep 2
    ds_read_b32 v255, v127 offset:16
    s_waitcnt lgkmcnt(0)
    v_readfirstlane_b32 s91, v255
    s_nop 1
    s_cmp_lt_u32 s91, s92
    s_nop 0
    s_cbranch_scc1 L_sw30
    s_branch L_sb30
.section .rodata,"a"
.p2align 6
.amdhsa_kernel standalone__window_attn_davit__vision_kernel
  .amdhsa_next_free_vgpr 256
  .amdhsa_next_free_sgpr 96
  .amdhsa_accum_offset 256
  .amdhsa_group_segment_fixed_size 0
  .amdhsa_kernarg_size 56
  .amdhsa_user_sgpr_count 2
  .amdhsa_user_sgpr_kernarg_segment_ptr 1
  .amdhsa_system_sgpr_workgroup_id_x 1
.end_amdhsa_kernel
```
